```python
import torch

def _softmax(x, axis=-1):
    return torch.softmax(x, dim=axis)

def _gelu(x):
    return torch.nn.functional.gelu(x, approximate='tanh')

def _silu(x):
    return torch.nn.functional.silu(x)

def _sigmoid(x):
    return torch.sigmoid(x)

def _layernorm(x, axis=-1, eps=1e-05):
    m = x.mean(dim=axis, keepdim=True)
    v = x.var(dim=axis, keepdim=True, unbiased=False)
    return (x - m) / torch.sqrt(v + eps)

def _scatter_add(tgt, idx, src, axis=0):
    return tgt.clone().index_add_(axis, idx, src)

def _segment_sum(src, seg, n):
    out = torch.zeros((n,) + src.shape[1:], dtype=src.dtype)
    return out.index_add_(0, seg, src)

def _pad(x, pw):
    flat = tuple((v for pair in reversed(pw) for v in pair))
    return torch.nn.functional.pad(x, flat)
kernel_name = 'standalone__conformer_family_e_branchformer__speech'

def setup_inputs():

    _w = lambda a: (lambda t: t.to(torch.bfloat16) if t.is_floating_point() else t)(torch.as_tensor(a))
    B, T, D, K = (2, 1000, 512, 31)
    return {'x': _w((lambda *s: torch.randn(*s, dtype=torch.bfloat16) * 0.05)(B, T, D)), 'w_qkv': _w((lambda *s: torch.randn(*s, dtype=torch.bfloat16) * 0.05)(D, 3 * D)), 'w_att_out': _w((lambda *s: torch.randn(*s, dtype=torch.bfloat16) * 0.05)(D, D)), 'w_mlp_in': _w((lambda *s: torch.randn(*s, dtype=torch.bfloat16) * 0.05)(D, 2 * D)), 'dw_csgu': _w((lambda *s: torch.randn(*s, dtype=torch.bfloat16) * 0.05)(K, D)), 'w_mlp_out': _w((lambda *s: torch.randn(*s, dtype=torch.bfloat16) * 0.05)(D, D)), 'dw_merge': _w((lambda *s: torch.randn(*s, dtype=torch.bfloat16) * 0.05)(K, 2 * D)), 'w_merge': _w((lambda *s: torch.randn(*s, dtype=torch.bfloat16) * 0.05)(2 * D, D))}

def reference(x, w_qkv, w_att_out, w_mlp_in, dw_csgu, w_mlp_out, dw_merge, w_merge):
    B, T, D = x.shape
    K = dw_csgu.shape[0]
    pad = K // 2
    xa = _layernorm(x, axis=-1)
    qkv = torch.einsum('btd,de->bte', xa, w_qkv)
    q, k, v = (qkv[..., :D].clone(), qkv[..., D:2 * D].clone(), qkv[..., 2 * D:].clone())
    scores = torch.einsum('btd,bsd->bts', q, k) * D ** (-0.5)
    p = _softmax(scores, axis=-1)
    attn = torch.einsum('bts,bsd->btd', p, v)
    glob = torch.einsum('btd,de->bte', attn, w_att_out)
    xc = _layernorm(x, axis=-1)
    h = _gelu(torch.einsum('btd,de->bte', xc, w_mlp_in))
    u, g = (h[..., :D].clone(), h[..., D:].clone())
    g = _layernorm(g, axis=-1)
    gp = _pad(g, ((0, 0), (pad, pad), (0, 0)))
    gc = torch.zeros_like(g)
    for i in range(K):
        gc = gc + gp[:, i:i + T, :] * dw_csgu[i][None, None, :]
    loc = torch.einsum('btd,de->bte', u * gc, w_mlp_out)
    m = torch.concatenate([glob, loc], axis=-1)
    mp = _pad(m, ((0, 0), (pad, pad), (0, 0)))
    mc = torch.zeros_like(m)
    for i in range(K):
        mc = mc + mp[:, i:i + T, :] * dw_merge[i][None, None, :]
    m = m + mc
    return x + torch.einsum('btc,cd->btd', m, w_merge)
```

```asm
; @launch kernel=k1_kernel grid=(256,1,1) block=(512,1,1) lds=132864
; @launch kernel=k2_kernel grid=(256,1,1) block=(512,1,1) lds=162048
; @launch kernel=k3_kernel grid=(256,1,1) block=(512,1,1) lds=153856
; @launch kernel=k4_kernel grid=(256,1,1) block=(512,1,1) lds=81920
.amdgcn_target "amdgcn-amd-amdhsa--gfx950"
.text
.globl k1_kernel
.p2align 8
.type k1_kernel,@function
k1_kernel:
    s_cmp_ge_u32 s2, 256
    s_cbranch_scc1 k1_exit
    s_load_dwordx4 s[4:7], s[0:1], 0
    s_load_dwordx2 s[28:29], s[0:1], 24
    s_load_dwordx4 s[40:43], s[0:1], 72
    v_lshrrev_b32 v1, 6, v0
    s_and_b32 s32, s2, 7
    s_lshr_b32 s33, s2, 3
    v_readfirstlane_b32 s20, v1
    s_and_b32 s34, s33, 7
    s_and_b32 s21, s32, 1
    s_lshl_b32 s21, s21, 3
    s_add_u32 s21, s21, s34
    s_lshr_b32 s35, s33, 3
    s_lshl_b32 s23, s35, 1
    s_add_u32 s23, s23, s34
    s_and_b32 s23, s23, 7
    s_lshr_b32 s36, s32, 1
    s_lshl_b32 s22, s36, 1
    s_and_b32 s37, s35, 1
    s_add_u32 s22, s22, s37
    s_cmp_ge_u32 s35, 2
    s_cbranch_scc1 k1_typeB
    s_mul_i32 s26, s21, 125
    s_mul_i32 s27, s26, 5120
    s_mul_i32 s99, s22, 384
    s_add_u32 s27, s27, s99
    s_add_u32 s27, s27, 0
    s_and_b32 s25, s20, 3
    s_cmp_ge_u32 s20, 4
    s_cbranch_scc1 k1A_loader
    v_and_b32 v1, 63, v0
    s_and_b32 s60, s20, 1
    s_lshr_b32 s61, s20, 1
    s_mul_i32 s62, s60, 3
    v_bfe_u32 v4, v1, 2, 2
    v_lshrrev_b32 v5, 5, v1
    v_lshl_add_u32 v4, v5, 3, v4
    v_bfe_u32 v5, v4, 1, 1
    v_mul_u32_u24 v4, 384, v4
    v_bfe_u32 v6, v1, 4, 1
    v_lshl_add_u32 v4, v6, 5, v4
    v_and_b32 v6, 3, v1
    v_lshl_add_u32 v4, v6, 3, v4
    s_add_u32 s99, s62, 0
    v_xor_b32 v7, s99, v5
    v_lshl_add_u32 v7, v7, 6, v4
    v_add_u32 v12, 0, v7
    v_add_u32 v15, 40960, v7
    v_add_u32 v18, 81920, v7
    s_add_u32 s99, s62, 1
    v_xor_b32 v7, s99, v5
    v_lshl_add_u32 v7, v7, 6, v4
    v_add_u32 v13, 0, v7
    v_add_u32 v16, 40960, v7
    v_add_u32 v19, 81920, v7
    s_add_u32 s99, s62, 2
    v_xor_b32 v7, s99, v5
    v_lshl_add_u32 v7, v7, 6, v4
    v_add_u32 v14, 0, v7
    v_add_u32 v17, 40960, v7
    v_add_u32 v20, 81920, v7
    v_and_b32 v4, 31, v1
    s_lshl_b32 s99, s61, 6
    v_add_u32 v180, s99, v4
    v_bfe_u32 v4, v180, 1, 3
    v_lshrrev_b32 v5, 5, v1
    v_xor_b32 v4, v4, v5
    v_lshlrev_b32 v4, 4, v4
    v_lshl_add_u32 v4, v180, 7, v4
    v_add_u32 v21, 24576, v4
    v_add_u32 v25, 65536, v4
    v_add_u32 v29, 106496, v4
    v_xor_b32 v5, 32, v4
    v_add_u32 v22, 24576, v5
    v_add_u32 v26, 65536, v5
    v_add_u32 v30, 106496, v5
    v_xor_b32 v5, 64, v4
    v_add_u32 v23, 24576, v5
    v_add_u32 v27, 65536, v5
    v_add_u32 v31, 106496, v5
    v_xor_b32 v5, 96, v4
    v_add_u32 v24, 24576, v5
    v_add_u32 v28, 65536, v5
    v_add_u32 v32, 106496, v5
    v_lshrrev_b32 v204, 2, v0
    v_and_b32 v205, 3, v0
    v_bfe_u32 v206, v204, 1, 1
    v_lshlrev_b32 v205, 1, v205
    v_xor_b32 v205, v205, v206
    v_lshlrev_b32 v204, 7, v204
    v_lshl_add_u32 v204, v205, 4, v204
    v_add_u32 v181, 24576, v204
    v_xor_b32 v182, 16, v204
    v_add_u32 v182, 24576, v182
    v_mov_b32 v184, 0
    v_mov_b32 v185, 0
    v_mov_b32 v186, 0
    v_mov_b32 v187, 0
    v_lshrrev_b32 v4, 5, v1
    v_lshlrev_b32 v210, 4, v4
    s_mul_i32 s99, s60, 384
    s_add_u32 s99, s99, 122880
    v_add_u32 v210, s99, v210
    v_lshlrev_b32 v211, 3, v180
    v_add_u32 v211, 123648, v211
    v_mul_u32_u24 v212, 400, v180
    v_lshl_add_u32 v212, v4, 3, v212
    s_mul_i32 s99, s60, 192
    v_add_u32 v212, s99, v212
    s_waitcnt lgkmcnt(0)
    s_mov_b32 s30, s42
    s_mov_b32 s31, s43
    s_mov_b32 s16, s30
    s_mov_b32 s17, s31
    s_mov_b32 s18, 10240000
    s_mov_b32 s19, 0x20000
    s_barrier
    ds_read_b128 v[144:147], v21 offset:0
    ds_read_b128 v[148:151], v21 offset:4096
    ds_read_b64_tr_b16 v[132:133], v12 offset:0
    ds_read_b64_tr_b16 v[134:135], v12 offset:1536
    ds_read_b64_tr_b16 v[136:137], v13 offset:0
    ds_read_b64_tr_b16 v[138:139], v13 offset:1536
    ds_read_b64_tr_b16 v[140:141], v14 offset:0
    ds_read_b64_tr_b16 v[142:143], v14 offset:1536
    s_waitcnt lgkmcnt(0)
    v_mfma_f32_32x32x16_bf16 v[36:51], v[132:135], v[144:147], 0
    ds_read_b128 v[164:167], v22 offset:0
    ds_read_b128 v[168:171], v22 offset:4096
    ds_read_b64_tr_b16 v[152:153], v12 offset:6144
    ds_read_b128 v[188:191], v181 offset:0
    v_mfma_f32_32x32x16_bf16 v[52:67], v[132:135], v[148:151], 0
    ds_read_b64_tr_b16 v[154:155], v12 offset:7680
    ds_read_b64_tr_b16 v[156:157], v13 offset:6144
    ds_read_b64_tr_b16 v[158:159], v13 offset:7680
    ds_read_b128 v[192:195], v182 offset:0
    v_mfma_f32_32x32x16_bf16 v[68:83], v[136:139], v[144:147], 0
    ds_read_b64_tr_b16 v[160:161], v14 offset:6144
    ds_read_b64_tr_b16 v[162:163], v14 offset:7680
    v_mfma_f32_32x32x16_bf16 v[84:99], v[136:139], v[148:151], 0
    v_mfma_f32_32x32x16_bf16 v[100:115], v[140:143], v[144:147], 0
    v_mfma_f32_32x32x16_bf16 v[116:131], v[140:143], v[148:151], 0
    s_waitcnt lgkmcnt(0)
    v_mfma_f32_32x32x16_bf16 v[36:51], v[152:155], v[164:167], v[36:51]
    ds_read_b128 v[144:147], v23 offset:0
    ds_read_b128 v[148:151], v23 offset:4096
    ds_read_b64_tr_b16 v[132:133], v12 offset:12288
    v_lshlrev_b32 v196, 16, v188
    v_and_b32 v197, 0xffff0000, v188
    v_lshlrev_b32 v198, 16, v189
    v_mfma_f32_32x32x16_bf16 v[52:67], v[152:155], v[168:171], v[52:67]
    ds_read_b64_tr_b16 v[134:135], v12 offset:13824
    ds_read_b64_tr_b16 v[136:137], v13 offset:12288
    ds_read_b64_tr_b16 v[138:139], v13 offset:13824
    v_and_b32 v199, 0xffff0000, v189
    v_lshlrev_b32 v200, 16, v190
    v_and_b32 v201, 0xffff0000, v190
    v_mfma_f32_32x32x16_bf16 v[68:83], v[156:159], v[164:167], v[68:83]
    ds_read_b64_tr_b16 v[140:141], v14 offset:12288
    ds_read_b64_tr_b16 v[142:143], v14 offset:13824
    v_lshlrev_b32 v202, 16, v191
    v_and_b32 v203, 0xffff0000, v191
    v_add_f32 v184, v184, v196
    v_mfma_f32_32x32x16_bf16 v[84:99], v[156:159], v[168:171], v[84:99]
    v_add_f32 v185, v185, v197
    v_fmac_f32 v186, v196, v196
    v_fmac_f32 v187, v197, v197
    v_mfma_f32_32x32x16_bf16 v[100:115], v[160:163], v[164:167], v[100:115]
    v_add_f32 v184, v184, v198
    v_add_f32 v185, v185, v199
    v_mfma_f32_32x32x16_bf16 v[116:131], v[160:163], v[168:171], v[116:131]
    v_fmac_f32 v186, v198, v198
    v_fmac_f32 v187, v199, v199
    s_waitcnt lgkmcnt(0)
    v_mfma_f32_32x32x16_bf16 v[36:51], v[132:135], v[144:147], v[36:51]
    ds_read_b128 v[164:167], v24 offset:0
    ds_read_b128 v[168:171], v24 offset:4096
    ds_read_b64_tr_b16 v[152:153], v12 offset:18432
    v_add_f32 v184, v184, v200
    v_add_f32 v185, v185, v201
    v_fmac_f32 v186, v200, v200
    v_mfma_f32_32x32x16_bf16 v[52:67], v[132:135], v[148:151], v[52:67]
    ds_read_b64_tr_b16 v[154:155], v12 offset:19968
    ds_read_b64_tr_b16 v[156:157], v13 offset:18432
    ds_read_b64_tr_b16 v[158:159], v13 offset:19968
    v_fmac_f32 v187, v201, v201
    v_add_f32 v184, v184, v202
    v_add_f32 v185, v185, v203
    v_mfma_f32_32x32x16_bf16 v[68:83], v[136:139], v[144:147], v[68:83]
    ds_read_b64_tr_b16 v[160:161], v14 offset:18432
    ds_read_b64_tr_b16 v[162:163], v14 offset:19968
    v_fmac_f32 v186, v202, v202
    v_fmac_f32 v187, v203, v203
    v_lshlrev_b32 v196, 16, v192
    v_mfma_f32_32x32x16_bf16 v[84:99], v[136:139], v[148:151], v[84:99]
    v_and_b32 v197, 0xffff0000, v192
    v_lshlrev_b32 v198, 16, v193
    v_and_b32 v199, 0xffff0000, v193
    v_mfma_f32_32x32x16_bf16 v[100:115], v[140:143], v[144:147], v[100:115]
    v_lshlrev_b32 v200, 16, v194
    v_and_b32 v201, 0xffff0000, v194
    v_mfma_f32_32x32x16_bf16 v[116:131], v[140:143], v[148:151], v[116:131]
    v_lshlrev_b32 v202, 16, v195
    v_and_b32 v203, 0xffff0000, v195
    s_waitcnt lgkmcnt(0)
    v_mfma_f32_32x32x16_bf16 v[36:51], v[152:155], v[164:167], v[36:51]
    s_barrier
    ds_read_b128 v[144:147], v25 offset:0
    ds_read_b128 v[148:151], v25 offset:4096
    ds_read_b64_tr_b16 v[132:133], v15 offset:0
    v_add_f32 v184, v184, v196
    v_add_f32 v185, v185, v197
    v_fmac_f32 v186, v196, v196
    v_mfma_f32_32x32x16_bf16 v[52:67], v[152:155], v[168:171], v[52:67]
    ds_read_b64_tr_b16 v[134:135], v15 offset:1536
    ds_read_b64_tr_b16 v[136:137], v16 offset:0
    ds_read_b64_tr_b16 v[138:139], v16 offset:1536
    v_fmac_f32 v187, v197, v197
    v_add_f32 v184, v184, v198
    v_add_f32 v185, v185, v199
    v_mfma_f32_32x32x16_bf16 v[68:83], v[156:159], v[164:167], v[68:83]
    ds_read_b64_tr_b16 v[140:141], v17 offset:0
    ds_read_b64_tr_b16 v[142:143], v17 offset:1536
    v_fmac_f32 v186, v198, v198
    v_fmac_f32 v187, v199, v199
    v_add_f32 v184, v184, v200
    v_mfma_f32_32x32x16_bf16 v[84:99], v[156:159], v[168:171], v[84:99]
    v_add_f32 v185, v185, v201
    v_fmac_f32 v186, v200, v200
    v_fmac_f32 v187, v201, v201
    v_mfma_f32_32x32x16_bf16 v[100:115], v[160:163], v[164:167], v[100:115]
    v_add_f32 v184, v184, v202
    v_add_f32 v185, v185, v203
    v_mfma_f32_32x32x16_bf16 v[116:131], v[160:163], v[168:171], v[116:131]
    v_fmac_f32 v186, v202, v202
    v_fmac_f32 v187, v203, v203
    s_waitcnt lgkmcnt(0)
    v_mfma_f32_32x32x16_bf16 v[36:51], v[132:135], v[144:147], v[36:51]
    ds_read_b128 v[164:167], v26 offset:0
    ds_read_b128 v[168:171], v26 offset:4096
    ds_read_b64_tr_b16 v[152:153], v15 offset:6144
    v_add_u32 v204, 40960, v181
    ds_read_b128 v[188:191], v204
    v_mfma_f32_32x32x16_bf16 v[52:67], v[132:135], v[148:151], v[52:67]
    ds_read_b64_tr_b16 v[154:155], v15 offset:7680
    ds_read_b64_tr_b16 v[156:157], v16 offset:6144
    ds_read_b64_tr_b16 v[158:159], v16 offset:7680
    v_add_u32 v204, 40960, v182
    ds_read_b128 v[192:195], v204
    v_mfma_f32_32x32x16_bf16 v[68:83], v[136:139], v[144:147], v[68:83]
    ds_read_b64_tr_b16 v[160:161], v17 offset:6144
    ds_read_b64_tr_b16 v[162:163], v17 offset:7680
    v_mfma_f32_32x32x16_bf16 v[84:99], v[136:139], v[148:151], v[84:99]
    v_mfma_f32_32x32x16_bf16 v[100:115], v[140:143], v[144:147], v[100:115]
    v_mfma_f32_32x32x16_bf16 v[116:131], v[140:143], v[148:151], v[116:131]
    s_waitcnt lgkmcnt(0)
    v_mfma_f32_32x32x16_bf16 v[36:51], v[152:155], v[164:167], v[36:51]
    ds_read_b128 v[144:147], v27 offset:0
    ds_read_b128 v[148:151], v27 offset:4096
    ds_read_b64_tr_b16 v[132:133], v15 offset:12288
    v_lshlrev_b32 v196, 16, v188
    v_and_b32 v197, 0xffff0000, v188
    v_lshlrev_b32 v198, 16, v189
    v_mfma_f32_32x32x16_bf16 v[52:67], v[152:155], v[168:171], v[52:67]
    ds_read_b64_tr_b16 v[134:135], v15 offset:13824
    ds_read_b64_tr_b16 v[136:137], v16 offset:12288
    ds_read_b64_tr_b16 v[138:139], v16 offset:13824
    v_and_b32 v199, 0xffff0000, v189
    v_lshlrev_b32 v200, 16, v190
    v_and_b32 v201, 0xffff0000, v190
    v_mfma_f32_32x32x16_bf16 v[68:83], v[156:159], v[164:167], v[68:83]
    ds_read_b64_tr_b16 v[140:141], v17 offset:12288
    ds_read_b64_tr_b16 v[142:143], v17 offset:13824
    v_lshlrev_b32 v202, 16, v191
    v_and_b32 v203, 0xffff0000, v191
    v_add_f32 v184, v184, v196
    v_mfma_f32_32x32x16_bf16 v[84:99], v[156:159], v[168:171], v[84:99]
    v_add_f32 v185, v185, v197
    v_fmac_f32 v186, v196, v196
    v_fmac_f32 v187, v197, v197
    v_mfma_f32_32x32x16_bf16 v[100:115], v[160:163], v[164:167], v[100:115]
    v_add_f32 v184, v184, v198
    v_add_f32 v185, v185, v199
    v_mfma_f32_32x32x16_bf16 v[116:131], v[160:163], v[168:171], v[116:131]
    v_fmac_f32 v186, v198, v198
    v_fmac_f32 v187, v199, v199
    s_waitcnt lgkmcnt(0)
    v_mfma_f32_32x32x16_bf16 v[36:51], v[132:135], v[144:147], v[36:51]
    ds_read_b128 v[164:167], v28 offset:0
    ds_read_b128 v[168:171], v28 offset:4096
    ds_read_b64_tr_b16 v[152:153], v15 offset:18432
    v_add_f32 v184, v184, v200
    v_add_f32 v185, v185, v201
    v_fmac_f32 v186, v200, v200
    v_mfma_f32_32x32x16_bf16 v[52:67], v[132:135], v[148:151], v[52:67]
    ds_read_b64_tr_b16 v[154:155], v15 offset:19968
    ds_read_b64_tr_b16 v[156:157], v16 offset:18432
    ds_read_b64_tr_b16 v[158:159], v16 offset:19968
    v_fmac_f32 v187, v201, v201
    v_add_f32 v184, v184, v202
    v_add_f32 v185, v185, v203
    v_mfma_f32_32x32x16_bf16 v[68:83], v[136:139], v[144:147], v[68:83]
    ds_read_b64_tr_b16 v[160:161], v17 offset:18432
    ds_read_b64_tr_b16 v[162:163], v17 offset:19968
    v_fmac_f32 v186, v202, v202
    v_fmac_f32 v187, v203, v203
    v_lshlrev_b32 v196, 16, v192
    v_mfma_f32_32x32x16_bf16 v[84:99], v[136:139], v[148:151], v[84:99]
    v_and_b32 v197, 0xffff0000, v192
    v_lshlrev_b32 v198, 16, v193
    v_and_b32 v199, 0xffff0000, v193
    v_mfma_f32_32x32x16_bf16 v[100:115], v[140:143], v[144:147], v[100:115]
    v_lshlrev_b32 v200, 16, v194
    v_and_b32 v201, 0xffff0000, v194
    v_mfma_f32_32x32x16_bf16 v[116:131], v[140:143], v[148:151], v[116:131]
    v_lshlrev_b32 v202, 16, v195
    v_and_b32 v203, 0xffff0000, v195
    s_waitcnt lgkmcnt(0)
    v_mfma_f32_32x32x16_bf16 v[36:51], v[152:155], v[164:167], v[36:51]
    s_barrier
    ds_read_b128 v[144:147], v29 offset:0
    ds_read_b128 v[148:151], v29 offset:4096
    ds_read_b64_tr_b16 v[132:133], v18 offset:0
    v_add_f32 v184, v184, v196
    v_add_f32 v185, v185, v197
    v_fmac_f32 v186, v196, v196
    v_mfma_f32_32x32x16_bf16 v[52:67], v[152:155], v[168:171], v[52:67]
    ds_read_b64_tr_b16 v[134:135], v18 offset:1536
    ds_read_b64_tr_b16 v[136:137], v19 offset:0
    ds_read_b64_tr_b16 v[138:139], v19 offset:1536
    v_fmac_f32 v187, v197, v197
    v_add_f32 v184, v184, v198
    v_add_f32 v185, v185, v199
    v_mfma_f32_32x32x16_bf16 v[68:83], v[156:159], v[164:167], v[68:83]
    ds_read_b64_tr_b16 v[140:141], v20 offset:0
    ds_read_b64_tr_b16 v[142:143], v20 offset:1536
    v_fmac_f32 v186, v198, v198
    v_fmac_f32 v187, v199, v199
    v_add_f32 v184, v184, v200
    v_mfma_f32_32x32x16_bf16 v[84:99], v[156:159], v[168:171], v[84:99]
    v_add_f32 v185, v185, v201
    v_fmac_f32 v186, v200, v200
    v_fmac_f32 v187, v201, v201
    v_mfma_f32_32x32x16_bf16 v[100:115], v[160:163], v[164:167], v[100:115]
    v_add_f32 v184, v184, v202
    v_add_f32 v185, v185, v203
    v_mfma_f32_32x32x16_bf16 v[116:131], v[160:163], v[168:171], v[116:131]
    v_fmac_f32 v186, v202, v202
    v_fmac_f32 v187, v203, v203
    s_waitcnt lgkmcnt(0)
    v_mfma_f32_32x32x16_bf16 v[36:51], v[132:135], v[144:147], v[36:51]
    ds_read_b128 v[164:167], v30 offset:0
    ds_read_b128 v[168:171], v30 offset:4096
    ds_read_b64_tr_b16 v[152:153], v18 offset:6144
    v_add_u32 v204, 81920, v181
    ds_read_b128 v[188:191], v204
    v_mfma_f32_32x32x16_bf16 v[52:67], v[132:135], v[148:151], v[52:67]
    ds_read_b64_tr_b16 v[154:155], v18 offset:7680
    ds_read_b64_tr_b16 v[156:157], v19 offset:6144
    ds_read_b64_tr_b16 v[158:159], v19 offset:7680
    v_add_u32 v204, 81920, v182
    ds_read_b128 v[192:195], v204
    v_mfma_f32_32x32x16_bf16 v[68:83], v[136:139], v[144:147], v[68:83]
    ds_read_b64_tr_b16 v[160:161], v20 offset:6144
    ds_read_b64_tr_b16 v[162:163], v20 offset:7680
    v_mfma_f32_32x32x16_bf16 v[84:99], v[136:139], v[148:151], v[84:99]
    v_mfma_f32_32x32x16_bf16 v[100:115], v[140:143], v[144:147], v[100:115]
    v_mfma_f32_32x32x16_bf16 v[116:131], v[140:143], v[148:151], v[116:131]
    s_waitcnt lgkmcnt(0)
    v_mfma_f32_32x32x16_bf16 v[36:51], v[152:155], v[164:167], v[36:51]
    ds_read_b128 v[144:147], v31 offset:0
    ds_read_b128 v[148:151], v31 offset:4096
    ds_read_b64_tr_b16 v[132:133], v18 offset:12288
    v_lshlrev_b32 v196, 16, v188
    v_and_b32 v197, 0xffff0000, v188
    v_lshlrev_b32 v198, 16, v189
    v_mfma_f32_32x32x16_bf16 v[52:67], v[152:155], v[168:171], v[52:67]
    ds_read_b64_tr_b16 v[134:135], v18 offset:13824
    ds_read_b64_tr_b16 v[136:137], v19 offset:12288
    ds_read_b64_tr_b16 v[138:139], v19 offset:13824
    v_and_b32 v199, 0xffff0000, v189
    v_lshlrev_b32 v200, 16, v190
    v_and_b32 v201, 0xffff0000, v190
    v_mfma_f32_32x32x16_bf16 v[68:83], v[156:159], v[164:167], v[68:83]
    ds_read_b64_tr_b16 v[140:141], v20 offset:12288
    ds_read_b64_tr_b16 v[142:143], v20 offset:13824
    v_lshlrev_b32 v202, 16, v191
    v_and_b32 v203, 0xffff0000, v191
    v_add_f32 v184, v184, v196
    v_mfma_f32_32x32x16_bf16 v[84:99], v[156:159], v[168:171], v[84:99]
    v_add_f32 v185, v185, v197
    v_fmac_f32 v186, v196, v196
    v_fmac_f32 v187, v197, v197
    v_mfma_f32_32x32x16_bf16 v[100:115], v[160:163], v[164:167], v[100:115]
    v_add_f32 v184, v184, v198
    v_add_f32 v185, v185, v199
    v_mfma_f32_32x32x16_bf16 v[116:131], v[160:163], v[168:171], v[116:131]
    v_fmac_f32 v186, v198, v198
    v_fmac_f32 v187, v199, v199
    s_waitcnt lgkmcnt(0)
    v_mfma_f32_32x32x16_bf16 v[36:51], v[132:135], v[144:147], v[36:51]
    ds_read_b128 v[164:167], v32 offset:0
    ds_read_b128 v[168:171], v32 offset:4096
    ds_read_b64_tr_b16 v[152:153], v18 offset:18432
    v_add_f32 v184, v184, v200
    v_add_f32 v185, v185, v201
    v_fmac_f32 v186, v200, v200
    v_mfma_f32_32x32x16_bf16 v[52:67], v[132:135], v[148:151], v[52:67]
    ds_read_b64_tr_b16 v[154:155], v18 offset:19968
    ds_read_b64_tr_b16 v[156:157], v19 offset:18432
    ds_read_b64_tr_b16 v[158:159], v19 offset:19968
    v_fmac_f32 v187, v201, v201
    v_add_f32 v184, v184, v202
    v_add_f32 v185, v185, v203
    v_mfma_f32_32x32x16_bf16 v[68:83], v[136:139], v[144:147], v[68:83]
    ds_read_b64_tr_b16 v[160:161], v20 offset:18432
    ds_read_b64_tr_b16 v[162:163], v20 offset:19968
    v_fmac_f32 v186, v202, v202
    v_fmac_f32 v187, v203, v203
    v_lshlrev_b32 v196, 16, v192
    v_mfma_f32_32x32x16_bf16 v[84:99], v[136:139], v[148:151], v[84:99]
    v_and_b32 v197, 0xffff0000, v192
    v_lshlrev_b32 v198, 16, v193
    v_and_b32 v199, 0xffff0000, v193
    v_mfma_f32_32x32x16_bf16 v[100:115], v[140:143], v[144:147], v[100:115]
    v_lshlrev_b32 v200, 16, v194
    v_and_b32 v201, 0xffff0000, v194
    v_mfma_f32_32x32x16_bf16 v[116:131], v[140:143], v[148:151], v[116:131]
    v_lshlrev_b32 v202, 16, v195
    v_and_b32 v203, 0xffff0000, v195
    s_waitcnt lgkmcnt(0)
    v_mfma_f32_32x32x16_bf16 v[36:51], v[152:155], v[164:167], v[36:51]
    s_barrier
    ds_read_b128 v[144:147], v21 offset:0
    ds_read_b128 v[148:151], v21 offset:4096
    ds_read_b64_tr_b16 v[132:133], v12 offset:0
    v_add_f32 v184, v184, v196
    v_add_f32 v185, v185, v197
    v_fmac_f32 v186, v196, v196
    v_mfma_f32_32x32x16_bf16 v[52:67], v[152:155], v[168:171], v[52:67]
    ds_read_b64_tr_b16 v[134:135], v12 offset:1536
    ds_read_b64_tr_b16 v[136:137], v13 offset:0
    ds_read_b64_tr_b16 v[138:139], v13 offset:1536
    v_fmac_f32 v187, v197, v197
    v_add_f32 v184, v184, v198
    v_add_f32 v185, v185, v199
    v_mfma_f32_32x32x16_bf16 v[68:83], v[156:159], v[164:167], v[68:83]
    ds_read_b64_tr_b16 v[140:141], v14 offset:0
    ds_read_b64_tr_b16 v[142:143], v14 offset:1536
    v_fmac_f32 v186, v198, v198
    v_fmac_f32 v187, v199, v199
    v_add_f32 v184, v184, v200
    v_mfma_f32_32x32x16_bf16 v[84:99], v[156:159], v[168:171], v[84:99]
    v_add_f32 v185, v185, v201
    v_fmac_f32 v186, v200, v200
    v_fmac_f32 v187, v201, v201
    v_mfma_f32_32x32x16_bf16 v[100:115], v[160:163], v[164:167], v[100:115]
    v_add_f32 v184, v184, v202
    v_add_f32 v185, v185, v203
    v_mfma_f32_32x32x16_bf16 v[116:131], v[160:163], v[168:171], v[116:131]
    v_fmac_f32 v186, v202, v202
    v_fmac_f32 v187, v203, v203
    s_waitcnt lgkmcnt(0)
    v_mfma_f32_32x32x16_bf16 v[36:51], v[132:135], v[144:147], v[36:51]
    ds_read_b128 v[164:167], v22 offset:0
    ds_read_b128 v[168:171], v22 offset:4096
    ds_read_b64_tr_b16 v[152:153], v12 offset:6144
    ds_read_b128 v[188:191], v181 offset:0
    v_mfma_f32_32x32x16_bf16 v[52:67], v[132:135], v[148:151], v[52:67]
    ds_read_b64_tr_b16 v[154:155], v12 offset:7680
    ds_read_b64_tr_b16 v[156:157], v13 offset:6144
    ds_read_b64_tr_b16 v[158:159], v13 offset:7680
    ds_read_b128 v[192:195], v182 offset:0
    v_mfma_f32_32x32x16_bf16 v[68:83], v[136:139], v[144:147], v[68:83]
    ds_read_b64_tr_b16 v[160:161], v14 offset:6144
    ds_read_b64_tr_b16 v[162:163], v14 offset:7680
    v_mfma_f32_32x32x16_bf16 v[84:99], v[136:139], v[148:151], v[84:99]
    v_mfma_f32_32x32x16_bf16 v[100:115], v[140:143], v[144:147], v[100:115]
    v_mfma_f32_32x32x16_bf16 v[116:131], v[140:143], v[148:151], v[116:131]
    s_waitcnt lgkmcnt(0)
    v_mfma_f32_32x32x16_bf16 v[36:51], v[152:155], v[164:167], v[36:51]
    ds_read_b128 v[144:147], v23 offset:0
    ds_read_b128 v[148:151], v23 offset:4096
    ds_read_b64_tr_b16 v[132:133], v12 offset:12288
    v_lshlrev_b32 v196, 16, v188
    v_and_b32 v197, 0xffff0000, v188
    v_lshlrev_b32 v198, 16, v189
    v_mfma_f32_32x32x16_bf16 v[52:67], v[152:155], v[168:171], v[52:67]
    ds_read_b64_tr_b16 v[134:135], v12 offset:13824
    ds_read_b64_tr_b16 v[136:137], v13 offset:12288
    ds_read_b64_tr_b16 v[138:139], v13 offset:13824
    v_and_b32 v199, 0xffff0000, v189
    v_lshlrev_b32 v200, 16, v190
    v_and_b32 v201, 0xffff0000, v190
    v_mfma_f32_32x32x16_bf16 v[68:83], v[156:159], v[164:167], v[68:83]
    ds_read_b64_tr_b16 v[140:141], v14 offset:12288
    ds_read_b64_tr_b16 v[142:143], v14 offset:13824
    v_lshlrev_b32 v202, 16, v191
    v_and_b32 v203, 0xffff0000, v191
    v_add_f32 v184, v184, v196
    v_mfma_f32_32x32x16_bf16 v[84:99], v[156:159], v[168:171], v[84:99]
    v_add_f32 v185, v185, v197
    v_fmac_f32 v186, v196, v196
    v_fmac_f32 v187, v197, v197
    v_mfma_f32_32x32x16_bf16 v[100:115], v[160:163], v[164:167], v[100:115]
    v_add_f32 v184, v184, v198
    v_add_f32 v185, v185, v199
    v_mfma_f32_32x32x16_bf16 v[116:131], v[160:163], v[168:171], v[116:131]
    v_fmac_f32 v186, v198, v198
    v_fmac_f32 v187, v199, v199
    s_waitcnt lgkmcnt(0)
    v_mfma_f32_32x32x16_bf16 v[36:51], v[132:135], v[144:147], v[36:51]
    ds_read_b128 v[164:167], v24 offset:0
    ds_read_b128 v[168:171], v24 offset:4096
    ds_read_b64_tr_b16 v[152:153], v12 offset:18432
    v_add_f32 v184, v184, v200
    v_add_f32 v185, v185, v201
    v_fmac_f32 v186, v200, v200
    v_mfma_f32_32x32x16_bf16 v[52:67], v[132:135], v[148:151], v[52:67]
    ds_read_b64_tr_b16 v[154:155], v12 offset:19968
    ds_read_b64_tr_b16 v[156:157], v13 offset:18432
    ds_read_b64_tr_b16 v[158:159], v13 offset:19968
    v_fmac_f32 v187, v201, v201
    v_add_f32 v184, v184, v202
    v_add_f32 v185, v185, v203
    v_mfma_f32_32x32x16_bf16 v[68:83], v[136:139], v[144:147], v[68:83]
    ds_read_b64_tr_b16 v[160:161], v14 offset:18432
    ds_read_b64_tr_b16 v[162:163], v14 offset:19968
    v_fmac_f32 v186, v202, v202
    v_fmac_f32 v187, v203, v203
    v_lshlrev_b32 v196, 16, v192
    v_mfma_f32_32x32x16_bf16 v[84:99], v[136:139], v[148:151], v[84:99]
    v_and_b32 v197, 0xffff0000, v192
    v_lshlrev_b32 v198, 16, v193
    v_and_b32 v199, 0xffff0000, v193
    v_mfma_f32_32x32x16_bf16 v[100:115], v[140:143], v[144:147], v[100:115]
    v_lshlrev_b32 v200, 16, v194
    v_and_b32 v201, 0xffff0000, v194
    v_mfma_f32_32x32x16_bf16 v[116:131], v[140:143], v[148:151], v[116:131]
    v_lshlrev_b32 v202, 16, v195
    v_and_b32 v203, 0xffff0000, v195
    s_waitcnt lgkmcnt(0)
    v_mfma_f32_32x32x16_bf16 v[36:51], v[152:155], v[164:167], v[36:51]
    s_barrier
    ds_read_b128 v[144:147], v25 offset:0
    ds_read_b128 v[148:151], v25 offset:4096
    ds_read_b64_tr_b16 v[132:133], v15 offset:0
    v_add_f32 v184, v184, v196
    v_add_f32 v185, v185, v197
    v_fmac_f32 v186, v196, v196
    v_mfma_f32_32x32x16_bf16 v[52:67], v[152:155], v[168:171], v[52:67]
    ds_read_b64_tr_b16 v[134:135], v15 offset:1536
    ds_read_b64_tr_b16 v[136:137], v16 offset:0
    ds_read_b64_tr_b16 v[138:139], v16 offset:1536
    v_fmac_f32 v187, v197, v197
    v_add_f32 v184, v184, v198
    v_add_f32 v185, v185, v199
    v_mfma_f32_32x32x16_bf16 v[68:83], v[156:159], v[164:167], v[68:83]
    ds_read_b64_tr_b16 v[140:141], v17 offset:0
    ds_read_b64_tr_b16 v[142:143], v17 offset:1536
    v_fmac_f32 v186, v198, v198
    v_fmac_f32 v187, v199, v199
    v_add_f32 v184, v184, v200
    v_mfma_f32_32x32x16_bf16 v[84:99], v[156:159], v[168:171], v[84:99]
    v_add_f32 v185, v185, v201
    v_fmac_f32 v186, v200, v200
    v_fmac_f32 v187, v201, v201
    v_mfma_f32_32x32x16_bf16 v[100:115], v[160:163], v[164:167], v[100:115]
    v_add_f32 v184, v184, v202
    v_add_f32 v185, v185, v203
    v_mfma_f32_32x32x16_bf16 v[116:131], v[160:163], v[168:171], v[116:131]
    v_fmac_f32 v186, v202, v202
    v_fmac_f32 v187, v203, v203
    s_waitcnt lgkmcnt(0)
    v_mfma_f32_32x32x16_bf16 v[36:51], v[132:135], v[144:147], v[36:51]
    ds_read_b128 v[164:167], v26 offset:0
    ds_read_b128 v[168:171], v26 offset:4096
    ds_read_b64_tr_b16 v[152:153], v15 offset:6144
    v_add_u32 v204, 40960, v181
    ds_read_b128 v[188:191], v204
    v_mfma_f32_32x32x16_bf16 v[52:67], v[132:135], v[148:151], v[52:67]
    ds_read_b64_tr_b16 v[154:155], v15 offset:7680
    ds_read_b64_tr_b16 v[156:157], v16 offset:6144
    ds_read_b64_tr_b16 v[158:159], v16 offset:7680
    v_add_u32 v204, 40960, v182
    ds_read_b128 v[192:195], v204
    v_mfma_f32_32x32x16_bf16 v[68:83], v[136:139], v[144:147], v[68:83]
    ds_read_b64_tr_b16 v[160:161], v17 offset:6144
    ds_read_b64_tr_b16 v[162:163], v17 offset:7680
    v_mfma_f32_32x32x16_bf16 v[84:99], v[136:139], v[148:151], v[84:99]
    v_mfma_f32_32x32x16_bf16 v[100:115], v[140:143], v[144:147], v[100:115]
    v_mfma_f32_32x32x16_bf16 v[116:131], v[140:143], v[148:151], v[116:131]
    s_waitcnt lgkmcnt(0)
    v_mfma_f32_32x32x16_bf16 v[36:51], v[152:155], v[164:167], v[36:51]
    ds_read_b128 v[144:147], v27 offset:0
    ds_read_b128 v[148:151], v27 offset:4096
    ds_read_b64_tr_b16 v[132:133], v15 offset:12288
    v_lshlrev_b32 v196, 16, v188
    v_and_b32 v197, 0xffff0000, v188
    v_lshlrev_b32 v198, 16, v189
    v_mfma_f32_32x32x16_bf16 v[52:67], v[152:155], v[168:171], v[52:67]
    ds_read_b64_tr_b16 v[134:135], v15 offset:13824
    ds_read_b64_tr_b16 v[136:137], v16 offset:12288
    ds_read_b64_tr_b16 v[138:139], v16 offset:13824
    v_and_b32 v199, 0xffff0000, v189
    v_lshlrev_b32 v200, 16, v190
    v_and_b32 v201, 0xffff0000, v190
    v_mfma_f32_32x32x16_bf16 v[68:83], v[156:159], v[164:167], v[68:83]
    ds_read_b64_tr_b16 v[140:141], v17 offset:12288
    ds_read_b64_tr_b16 v[142:143], v17 offset:13824
    v_lshlrev_b32 v202, 16, v191
    v_and_b32 v203, 0xffff0000, v191
    v_add_f32 v184, v184, v196
    v_mfma_f32_32x32x16_bf16 v[84:99], v[156:159], v[168:171], v[84:99]
    v_add_f32 v185, v185, v197
    v_fmac_f32 v186, v196, v196
    v_fmac_f32 v187, v197, v197
    v_mfma_f32_32x32x16_bf16 v[100:115], v[160:163], v[164:167], v[100:115]
    v_add_f32 v184, v184, v198
    v_add_f32 v185, v185, v199
    v_mfma_f32_32x32x16_bf16 v[116:131], v[160:163], v[168:171], v[116:131]
    v_fmac_f32 v186, v198, v198
    v_fmac_f32 v187, v199, v199
    s_waitcnt lgkmcnt(0)
    v_mfma_f32_32x32x16_bf16 v[36:51], v[132:135], v[144:147], v[36:51]
    ds_read_b128 v[164:167], v28 offset:0
    ds_read_b128 v[168:171], v28 offset:4096
    ds_read_b64_tr_b16 v[152:153], v15 offset:18432
    v_add_f32 v184, v184, v200
    v_add_f32 v185, v185, v201
    v_fmac_f32 v186, v200, v200
    v_mfma_f32_32x32x16_bf16 v[52:67], v[132:135], v[148:151], v[52:67]
    ds_read_b64_tr_b16 v[154:155], v15 offset:19968
    ds_read_b64_tr_b16 v[156:157], v16 offset:18432
    ds_read_b64_tr_b16 v[158:159], v16 offset:19968
    v_fmac_f32 v187, v201, v201
    v_add_f32 v184, v184, v202
    v_add_f32 v185, v185, v203
    v_mfma_f32_32x32x16_bf16 v[68:83], v[136:139], v[144:147], v[68:83]
    ds_read_b64_tr_b16 v[160:161], v17 offset:18432
    ds_read_b64_tr_b16 v[162:163], v17 offset:19968
    v_fmac_f32 v186, v202, v202
    v_fmac_f32 v187, v203, v203
    v_lshlrev_b32 v196, 16, v192
    v_mfma_f32_32x32x16_bf16 v[84:99], v[136:139], v[148:151], v[84:99]
    v_and_b32 v197, 0xffff0000, v192
    v_lshlrev_b32 v198, 16, v193
    v_and_b32 v199, 0xffff0000, v193
    v_mfma_f32_32x32x16_bf16 v[100:115], v[140:143], v[144:147], v[100:115]
    v_lshlrev_b32 v200, 16, v194
    v_and_b32 v201, 0xffff0000, v194
    v_mfma_f32_32x32x16_bf16 v[116:131], v[140:143], v[148:151], v[116:131]
    v_lshlrev_b32 v202, 16, v195
    v_and_b32 v203, 0xffff0000, v195
    s_waitcnt lgkmcnt(0)
    v_mfma_f32_32x32x16_bf16 v[36:51], v[152:155], v[164:167], v[36:51]
    s_barrier
    ds_read_b128 v[144:147], v29 offset:0
    ds_read_b128 v[148:151], v29 offset:4096
    ds_read_b64_tr_b16 v[132:133], v18 offset:0
    v_add_f32 v184, v184, v196
    v_add_f32 v185, v185, v197
    v_fmac_f32 v186, v196, v196
    v_mfma_f32_32x32x16_bf16 v[52:67], v[152:155], v[168:171], v[52:67]
    ds_read_b64_tr_b16 v[134:135], v18 offset:1536
    ds_read_b64_tr_b16 v[136:137], v19 offset:0
    ds_read_b64_tr_b16 v[138:139], v19 offset:1536
    v_fmac_f32 v187, v197, v197
    v_add_f32 v184, v184, v198
    v_add_f32 v185, v185, v199
    v_mfma_f32_32x32x16_bf16 v[68:83], v[156:159], v[164:167], v[68:83]
    ds_read_b64_tr_b16 v[140:141], v20 offset:0
    ds_read_b64_tr_b16 v[142:143], v20 offset:1536
    v_fmac_f32 v186, v198, v198
    v_fmac_f32 v187, v199, v199
    v_add_f32 v184, v184, v200
    v_mfma_f32_32x32x16_bf16 v[84:99], v[156:159], v[168:171], v[84:99]
    v_add_f32 v185, v185, v201
    v_fmac_f32 v186, v200, v200
    v_fmac_f32 v187, v201, v201
    v_mfma_f32_32x32x16_bf16 v[100:115], v[160:163], v[164:167], v[100:115]
    v_add_f32 v184, v184, v202
    v_add_f32 v185, v185, v203
    v_mfma_f32_32x32x16_bf16 v[116:131], v[160:163], v[168:171], v[116:131]
    v_fmac_f32 v186, v202, v202
    v_fmac_f32 v187, v203, v203
    s_waitcnt lgkmcnt(0)
    v_mfma_f32_32x32x16_bf16 v[36:51], v[132:135], v[144:147], v[36:51]
    ds_read_b128 v[164:167], v30 offset:0
    ds_read_b128 v[168:171], v30 offset:4096
    ds_read_b64_tr_b16 v[152:153], v18 offset:6144
    v_add_u32 v204, 81920, v181
    ds_read_b128 v[188:191], v204
    v_mfma_f32_32x32x16_bf16 v[52:67], v[132:135], v[148:151], v[52:67]
    ds_read_b64_tr_b16 v[154:155], v18 offset:7680
    ds_read_b64_tr_b16 v[156:157], v19 offset:6144
    ds_read_b64_tr_b16 v[158:159], v19 offset:7680
    v_add_u32 v204, 81920, v182
    ds_read_b128 v[192:195], v204
    v_mfma_f32_32x32x16_bf16 v[68:83], v[136:139], v[144:147], v[68:83]
    ds_read_b64_tr_b16 v[160:161], v20 offset:6144
    ds_read_b64_tr_b16 v[162:163], v20 offset:7680
    v_mfma_f32_32x32x16_bf16 v[84:99], v[136:139], v[148:151], v[84:99]
    v_mfma_f32_32x32x16_bf16 v[100:115], v[140:143], v[144:147], v[100:115]
    v_mfma_f32_32x32x16_bf16 v[116:131], v[140:143], v[148:151], v[116:131]
    s_waitcnt lgkmcnt(0)
    v_mfma_f32_32x32x16_bf16 v[36:51], v[152:155], v[164:167], v[36:51]
    ds_read_b128 v[144:147], v31 offset:0
    ds_read_b128 v[148:151], v31 offset:4096
    ds_read_b64_tr_b16 v[132:133], v18 offset:12288
    v_lshlrev_b32 v196, 16, v188
    v_and_b32 v197, 0xffff0000, v188
    v_lshlrev_b32 v198, 16, v189
    v_mfma_f32_32x32x16_bf16 v[52:67], v[152:155], v[168:171], v[52:67]
    ds_read_b64_tr_b16 v[134:135], v18 offset:13824
    ds_read_b64_tr_b16 v[136:137], v19 offset:12288
    ds_read_b64_tr_b16 v[138:139], v19 offset:13824
    v_and_b32 v199, 0xffff0000, v189
    v_lshlrev_b32 v200, 16, v190
    v_and_b32 v201, 0xffff0000, v190
    v_mfma_f32_32x32x16_bf16 v[68:83], v[156:159], v[164:167], v[68:83]
    ds_read_b64_tr_b16 v[140:141], v20 offset:12288
    ds_read_b64_tr_b16 v[142:143], v20 offset:13824
    v_lshlrev_b32 v202, 16, v191
    v_and_b32 v203, 0xffff0000, v191
    v_add_f32 v184, v184, v196
    v_mfma_f32_32x32x16_bf16 v[84:99], v[156:159], v[168:171], v[84:99]
    v_add_f32 v185, v185, v197
    v_fmac_f32 v186, v196, v196
    v_fmac_f32 v187, v197, v197
    v_mfma_f32_32x32x16_bf16 v[100:115], v[160:163], v[164:167], v[100:115]
    v_add_f32 v184, v184, v198
    v_add_f32 v185, v185, v199
    v_mfma_f32_32x32x16_bf16 v[116:131], v[160:163], v[168:171], v[116:131]
    v_fmac_f32 v186, v198, v198
    v_fmac_f32 v187, v199, v199
    s_waitcnt lgkmcnt(0)
    v_mfma_f32_32x32x16_bf16 v[36:51], v[132:135], v[144:147], v[36:51]
    ds_read_b128 v[164:167], v32 offset:0
    ds_read_b128 v[168:171], v32 offset:4096
    ds_read_b64_tr_b16 v[152:153], v18 offset:18432
    v_add_f32 v184, v184, v200
    v_add_f32 v185, v185, v201
    v_fmac_f32 v186, v200, v200
    v_mfma_f32_32x32x16_bf16 v[52:67], v[132:135], v[148:151], v[52:67]
    ds_read_b64_tr_b16 v[154:155], v18 offset:19968
    ds_read_b64_tr_b16 v[156:157], v19 offset:18432
    ds_read_b64_tr_b16 v[158:159], v19 offset:19968
    v_fmac_f32 v187, v201, v201
    v_add_f32 v184, v184, v202
    v_add_f32 v185, v185, v203
    v_mfma_f32_32x32x16_bf16 v[68:83], v[136:139], v[144:147], v[68:83]
    ds_read_b64_tr_b16 v[160:161], v20 offset:18432
    ds_read_b64_tr_b16 v[162:163], v20 offset:19968
    v_fmac_f32 v186, v202, v202
    v_fmac_f32 v187, v203, v203
    v_lshlrev_b32 v196, 16, v192
    v_mfma_f32_32x32x16_bf16 v[84:99], v[136:139], v[148:151], v[84:99]
    v_and_b32 v197, 0xffff0000, v192
    v_lshlrev_b32 v198, 16, v193
    v_and_b32 v199, 0xffff0000, v193
    v_mfma_f32_32x32x16_bf16 v[100:115], v[140:143], v[144:147], v[100:115]
    v_lshlrev_b32 v200, 16, v194
    v_and_b32 v201, 0xffff0000, v194
    v_mfma_f32_32x32x16_bf16 v[116:131], v[140:143], v[148:151], v[116:131]
    v_lshlrev_b32 v202, 16, v195
    v_and_b32 v203, 0xffff0000, v195
    s_waitcnt lgkmcnt(0)
    v_mfma_f32_32x32x16_bf16 v[36:51], v[152:155], v[164:167], v[36:51]
    s_barrier
    ds_read_b128 v[144:147], v21 offset:0
    ds_read_b128 v[148:151], v21 offset:4096
    ds_read_b64_tr_b16 v[132:133], v12 offset:0
    v_add_f32 v184, v184, v196
    v_add_f32 v185, v185, v197
    v_fmac_f32 v186, v196, v196
    v_mfma_f32_32x32x16_bf16 v[52:67], v[152:155], v[168:171], v[52:67]
    ds_read_b64_tr_b16 v[134:135], v12 offset:1536
    ds_read_b64_tr_b16 v[136:137], v13 offset:0
    ds_read_b64_tr_b16 v[138:139], v13 offset:1536
    v_fmac_f32 v187, v197, v197
    v_add_f32 v184, v184, v198
    v_add_f32 v185, v185, v199
    v_mfma_f32_32x32x16_bf16 v[68:83], v[156:159], v[164:167], v[68:83]
    ds_read_b64_tr_b16 v[140:141], v14 offset:0
    ds_read_b64_tr_b16 v[142:143], v14 offset:1536
    v_fmac_f32 v186, v198, v198
    v_fmac_f32 v187, v199, v199
    v_add_f32 v184, v184, v200
    v_mfma_f32_32x32x16_bf16 v[84:99], v[156:159], v[168:171], v[84:99]
    v_add_f32 v185, v185, v201
    v_fmac_f32 v186, v200, v200
    v_fmac_f32 v187, v201, v201
    v_mfma_f32_32x32x16_bf16 v[100:115], v[160:163], v[164:167], v[100:115]
    v_add_f32 v184, v184, v202
    v_add_f32 v185, v185, v203
    v_mfma_f32_32x32x16_bf16 v[116:131], v[160:163], v[168:171], v[116:131]
    v_fmac_f32 v186, v202, v202
    v_fmac_f32 v187, v203, v203
    s_waitcnt lgkmcnt(0)
    v_mfma_f32_32x32x16_bf16 v[36:51], v[132:135], v[144:147], v[36:51]
    ds_read_b128 v[164:167], v22 offset:0
    ds_read_b128 v[168:171], v22 offset:4096
    ds_read_b64_tr_b16 v[152:153], v12 offset:6144
    ds_read_b128 v[188:191], v181 offset:0
    v_mfma_f32_32x32x16_bf16 v[52:67], v[132:135], v[148:151], v[52:67]
    ds_read_b64_tr_b16 v[154:155], v12 offset:7680
    ds_read_b64_tr_b16 v[156:157], v13 offset:6144
    ds_read_b64_tr_b16 v[158:159], v13 offset:7680
    ds_read_b128 v[192:195], v182 offset:0
    v_mfma_f32_32x32x16_bf16 v[68:83], v[136:139], v[144:147], v[68:83]
    ds_read_b64_tr_b16 v[160:161], v14 offset:6144
    ds_read_b64_tr_b16 v[162:163], v14 offset:7680
    v_mfma_f32_32x32x16_bf16 v[84:99], v[136:139], v[148:151], v[84:99]
    v_mfma_f32_32x32x16_bf16 v[100:115], v[140:143], v[144:147], v[100:115]
    v_mfma_f32_32x32x16_bf16 v[116:131], v[140:143], v[148:151], v[116:131]
    s_waitcnt lgkmcnt(0)
    v_mfma_f32_32x32x16_bf16 v[36:51], v[152:155], v[164:167], v[36:51]
    ds_read_b128 v[144:147], v23 offset:0
    ds_read_b128 v[148:151], v23 offset:4096
    ds_read_b64_tr_b16 v[132:133], v12 offset:12288
    v_lshlrev_b32 v196, 16, v188
    v_and_b32 v197, 0xffff0000, v188
    v_lshlrev_b32 v198, 16, v189
    v_mfma_f32_32x32x16_bf16 v[52:67], v[152:155], v[168:171], v[52:67]
    ds_read_b64_tr_b16 v[134:135], v12 offset:13824
    ds_read_b64_tr_b16 v[136:137], v13 offset:12288
    ds_read_b64_tr_b16 v[138:139], v13 offset:13824
    v_and_b32 v199, 0xffff0000, v189
    v_lshlrev_b32 v200, 16, v190
    v_and_b32 v201, 0xffff0000, v190
    v_mfma_f32_32x32x16_bf16 v[68:83], v[156:159], v[164:167], v[68:83]
    ds_read_b64_tr_b16 v[140:141], v14 offset:12288
    ds_read_b64_tr_b16 v[142:143], v14 offset:13824
    v_lshlrev_b32 v202, 16, v191
    v_and_b32 v203, 0xffff0000, v191
    v_add_f32 v184, v184, v196
    v_mfma_f32_32x32x16_bf16 v[84:99], v[156:159], v[168:171], v[84:99]
    v_add_f32 v185, v185, v197
    v_fmac_f32 v186, v196, v196
    v_fmac_f32 v187, v197, v197
    v_mfma_f32_32x32x16_bf16 v[100:115], v[160:163], v[164:167], v[100:115]
    v_add_f32 v184, v184, v198
    v_add_f32 v185, v185, v199
    v_mfma_f32_32x32x16_bf16 v[116:131], v[160:163], v[168:171], v[116:131]
    v_fmac_f32 v186, v198, v198
    v_fmac_f32 v187, v199, v199
    s_waitcnt lgkmcnt(0)
    v_mfma_f32_32x32x16_bf16 v[36:51], v[132:135], v[144:147], v[36:51]
    ds_read_b128 v[164:167], v24 offset:0
    ds_read_b128 v[168:171], v24 offset:4096
    ds_read_b64_tr_b16 v[152:153], v12 offset:18432
    v_add_f32 v184, v184, v200
    v_add_f32 v185, v185, v201
    v_fmac_f32 v186, v200, v200
    v_mfma_f32_32x32x16_bf16 v[52:67], v[132:135], v[148:151], v[52:67]
    ds_read_b64_tr_b16 v[154:155], v12 offset:19968
    ds_read_b64_tr_b16 v[156:157], v13 offset:18432
    ds_read_b64_tr_b16 v[158:159], v13 offset:19968
    v_fmac_f32 v187, v201, v201
    v_add_f32 v184, v184, v202
    v_add_f32 v185, v185, v203
    v_mfma_f32_32x32x16_bf16 v[68:83], v[136:139], v[144:147], v[68:83]
    ds_read_b64_tr_b16 v[160:161], v14 offset:18432
    ds_read_b64_tr_b16 v[162:163], v14 offset:19968
    v_fmac_f32 v186, v202, v202
    v_fmac_f32 v187, v203, v203
    v_lshlrev_b32 v196, 16, v192
    v_mfma_f32_32x32x16_bf16 v[84:99], v[136:139], v[148:151], v[84:99]
    v_and_b32 v197, 0xffff0000, v192
    v_lshlrev_b32 v198, 16, v193
    v_and_b32 v199, 0xffff0000, v193
    v_mfma_f32_32x32x16_bf16 v[100:115], v[140:143], v[144:147], v[100:115]
    v_lshlrev_b32 v200, 16, v194
    v_and_b32 v201, 0xffff0000, v194
    v_mfma_f32_32x32x16_bf16 v[116:131], v[140:143], v[148:151], v[116:131]
    v_lshlrev_b32 v202, 16, v195
    v_and_b32 v203, 0xffff0000, v195
    s_waitcnt lgkmcnt(0)
    v_mfma_f32_32x32x16_bf16 v[36:51], v[152:155], v[164:167], v[36:51]
    s_barrier
    ds_read_b128 v[144:147], v25 offset:0
    ds_read_b128 v[148:151], v25 offset:4096
    ds_read_b64_tr_b16 v[132:133], v15 offset:0
    v_add_f32 v184, v184, v196
    v_add_f32 v185, v185, v197
    v_fmac_f32 v186, v196, v196
    v_mfma_f32_32x32x16_bf16 v[52:67], v[152:155], v[168:171], v[52:67]
    ds_read_b64_tr_b16 v[134:135], v15 offset:1536
    ds_read_b64_tr_b16 v[136:137], v16 offset:0
    ds_read_b64_tr_b16 v[138:139], v16 offset:1536
    v_fmac_f32 v187, v197, v197
    v_add_f32 v184, v184, v198
    v_add_f32 v185, v185, v199
    v_mfma_f32_32x32x16_bf16 v[68:83], v[156:159], v[164:167], v[68:83]
    ds_read_b64_tr_b16 v[140:141], v17 offset:0
    ds_read_b64_tr_b16 v[142:143], v17 offset:1536
    v_fmac_f32 v186, v198, v198
    v_fmac_f32 v187, v199, v199
    v_add_f32 v184, v184, v200
    v_mfma_f32_32x32x16_bf16 v[84:99], v[156:159], v[168:171], v[84:99]
    v_add_f32 v185, v185, v201
    v_fmac_f32 v186, v200, v200
    v_fmac_f32 v187, v201, v201
    v_mfma_f32_32x32x16_bf16 v[100:115], v[160:163], v[164:167], v[100:115]
    v_add_f32 v184, v184, v202
    v_add_f32 v185, v185, v203
    v_mfma_f32_32x32x16_bf16 v[116:131], v[160:163], v[168:171], v[116:131]
    v_fmac_f32 v186, v202, v202
    v_fmac_f32 v187, v203, v203
    s_waitcnt lgkmcnt(0)
    v_mfma_f32_32x32x16_bf16 v[36:51], v[132:135], v[144:147], v[36:51]
    ds_read_b128 v[164:167], v26 offset:0
    ds_read_b128 v[168:171], v26 offset:4096
    ds_read_b64_tr_b16 v[152:153], v15 offset:6144
    v_add_u32 v204, 40960, v181
    ds_read_b128 v[188:191], v204
    v_mfma_f32_32x32x16_bf16 v[52:67], v[132:135], v[148:151], v[52:67]
    ds_read_b64_tr_b16 v[154:155], v15 offset:7680
    ds_read_b64_tr_b16 v[156:157], v16 offset:6144
    ds_read_b64_tr_b16 v[158:159], v16 offset:7680
    v_add_u32 v204, 40960, v182
    ds_read_b128 v[192:195], v204
    v_mfma_f32_32x32x16_bf16 v[68:83], v[136:139], v[144:147], v[68:83]
    ds_read_b64_tr_b16 v[160:161], v17 offset:6144
    ds_read_b64_tr_b16 v[162:163], v17 offset:7680
    v_mfma_f32_32x32x16_bf16 v[84:99], v[136:139], v[148:151], v[84:99]
    v_mfma_f32_32x32x16_bf16 v[100:115], v[140:143], v[144:147], v[100:115]
    v_mfma_f32_32x32x16_bf16 v[116:131], v[140:143], v[148:151], v[116:131]
    s_waitcnt lgkmcnt(0)
    v_mfma_f32_32x32x16_bf16 v[36:51], v[152:155], v[164:167], v[36:51]
    ds_read_b128 v[144:147], v27 offset:0
    ds_read_b128 v[148:151], v27 offset:4096
    ds_read_b64_tr_b16 v[132:133], v15 offset:12288
    v_lshlrev_b32 v196, 16, v188
    v_and_b32 v197, 0xffff0000, v188
    v_lshlrev_b32 v198, 16, v189
    v_mfma_f32_32x32x16_bf16 v[52:67], v[152:155], v[168:171], v[52:67]
    ds_read_b64_tr_b16 v[134:135], v15 offset:13824
    ds_read_b64_tr_b16 v[136:137], v16 offset:12288
    ds_read_b64_tr_b16 v[138:139], v16 offset:13824
    v_and_b32 v199, 0xffff0000, v189
    v_lshlrev_b32 v200, 16, v190
    v_and_b32 v201, 0xffff0000, v190
    v_mfma_f32_32x32x16_bf16 v[68:83], v[156:159], v[164:167], v[68:83]
    ds_read_b64_tr_b16 v[140:141], v17 offset:12288
    ds_read_b64_tr_b16 v[142:143], v17 offset:13824
    v_lshlrev_b32 v202, 16, v191
    v_and_b32 v203, 0xffff0000, v191
    v_add_f32 v184, v184, v196
    v_mfma_f32_32x32x16_bf16 v[84:99], v[156:159], v[168:171], v[84:99]
    v_add_f32 v185, v185, v197
    v_fmac_f32 v186, v196, v196
    v_fmac_f32 v187, v197, v197
    v_mfma_f32_32x32x16_bf16 v[100:115], v[160:163], v[164:167], v[100:115]
    v_add_f32 v184, v184, v198
    v_add_f32 v185, v185, v199
    v_mfma_f32_32x32x16_bf16 v[116:131], v[160:163], v[168:171], v[116:131]
    v_fmac_f32 v186, v198, v198
    v_fmac_f32 v187, v199, v199
    s_waitcnt lgkmcnt(0)
    v_mfma_f32_32x32x16_bf16 v[36:51], v[132:135], v[144:147], v[36:51]
    ds_read_b128 v[164:167], v28 offset:0
    ds_read_b128 v[168:171], v28 offset:4096
    ds_read_b64_tr_b16 v[152:153], v15 offset:18432
    v_add_f32 v184, v184, v200
    v_add_f32 v185, v185, v201
    v_fmac_f32 v186, v200, v200
    v_mfma_f32_32x32x16_bf16 v[52:67], v[132:135], v[148:151], v[52:67]
    ds_read_b64_tr_b16 v[154:155], v15 offset:19968
    ds_read_b64_tr_b16 v[156:157], v16 offset:18432
    ds_read_b64_tr_b16 v[158:159], v16 offset:19968
    v_fmac_f32 v187, v201, v201
    v_add_f32 v184, v184, v202
    v_add_f32 v185, v185, v203
    v_mfma_f32_32x32x16_bf16 v[68:83], v[136:139], v[144:147], v[68:83]
    ds_read_b64_tr_b16 v[160:161], v17 offset:18432
    ds_read_b64_tr_b16 v[162:163], v17 offset:19968
    v_fmac_f32 v186, v202, v202
    v_fmac_f32 v187, v203, v203
    v_lshlrev_b32 v196, 16, v192
    v_mfma_f32_32x32x16_bf16 v[84:99], v[136:139], v[148:151], v[84:99]
    v_and_b32 v197, 0xffff0000, v192
    v_lshlrev_b32 v198, 16, v193
    v_and_b32 v199, 0xffff0000, v193
    v_mfma_f32_32x32x16_bf16 v[100:115], v[140:143], v[144:147], v[100:115]
    v_lshlrev_b32 v200, 16, v194
    v_and_b32 v201, 0xffff0000, v194
    v_mfma_f32_32x32x16_bf16 v[116:131], v[140:143], v[148:151], v[116:131]
    v_lshlrev_b32 v202, 16, v195
    v_and_b32 v203, 0xffff0000, v195
    s_waitcnt lgkmcnt(0)
    v_mfma_f32_32x32x16_bf16 v[36:51], v[152:155], v[164:167], v[36:51]
    v_add_f32 v184, v184, v196
    v_add_f32 v185, v185, v197
    v_fmac_f32 v186, v196, v196
    v_mfma_f32_32x32x16_bf16 v[52:67], v[152:155], v[168:171], v[52:67]
    v_fmac_f32 v187, v197, v197
    v_add_f32 v184, v184, v198
    v_add_f32 v185, v185, v199
    v_mfma_f32_32x32x16_bf16 v[68:83], v[156:159], v[164:167], v[68:83]
    v_fmac_f32 v186, v198, v198
    v_fmac_f32 v187, v199, v199
    v_add_f32 v184, v184, v200
    v_mfma_f32_32x32x16_bf16 v[84:99], v[156:159], v[168:171], v[84:99]
    v_add_f32 v185, v185, v201
    v_fmac_f32 v186, v200, v200
    v_fmac_f32 v187, v201, v201
    v_mfma_f32_32x32x16_bf16 v[100:115], v[160:163], v[164:167], v[100:115]
    v_add_f32 v184, v184, v202
    v_add_f32 v185, v185, v203
    v_mfma_f32_32x32x16_bf16 v[116:131], v[160:163], v[168:171], v[116:131]
    v_fmac_f32 v186, v202, v202
    v_fmac_f32 v187, v203, v203
    v_add_f32 v204, v184, v185
    v_add_f32 v205, v186, v187
    s_nop 1
    v_add_f32_dpp v204, v204, v204 quad_perm:[1,0,3,2] row_mask:0xf bank_mask:0xf
    v_add_f32_dpp v205, v205, v205 quad_perm:[1,0,3,2] row_mask:0xf bank_mask:0xf
    s_nop 1
    v_add_f32_dpp v204, v204, v204 quad_perm:[2,3,0,1] row_mask:0xf bank_mask:0xf
    v_add_f32_dpp v205, v205, v205 quad_perm:[2,3,0,1] row_mask:0xf bank_mask:0xf
    v_mul_f32 v204, 989855744, v204
    v_mul_f32 v205, 989855744, v205
    v_fma_f32 v205, -v204, v204, v205
    v_max_f32 v205, 0, v205
    v_add_f32 v205, 925353388, v205
    v_rsq_f32 v206, v205
    s_nop 0
    v_mul_f32 v207, v204, v206
    v_lshrrev_b32 v208, 2, v0
    v_lshlrev_b32 v208, 3, v208
    v_add_u32 v208, 123648, v208
    ds_write_b64 v208, v[206:207]
    s_nop 7
    s_nop 3
    s_cmp_eq_u32 s61, 1
    s_cbranch_scc0 k1A_nocs
    s_mov_b32 exec_lo, 536870912
    s_mov_b32 exec_hi, 536870912
    ds_write_b128 v210, v[52:55] offset:0
    ds_write_b128 v210, v[56:59] offset:32
    ds_write_b128 v210, v[60:63] offset:64
    ds_write_b128 v210, v[64:67] offset:96
    ds_write_b128 v210, v[84:87] offset:128
    ds_write_b128 v210, v[88:91] offset:160
    ds_write_b128 v210, v[92:95] offset:192
    ds_write_b128 v210, v[96:99] offset:224
    ds_write_b128 v210, v[116:119] offset:256
    ds_write_b128 v210, v[120:123] offset:288
    ds_write_b128 v210, v[124:127] offset:320
    ds_write_b128 v210, v[128:131] offset:352
    s_mov_b64 exec, -1
k1A_nocs:
    s_waitcnt lgkmcnt(0)
    s_barrier
    ds_read_b64 v[214:215], v211 offset:0
    ds_read_b64 v[216:217], v211 offset:256
    ds_read_b128 v[132:135], v210 offset:0
    ds_read_b128 v[136:139], v210 offset:32
    ds_read_b128 v[140:143], v210 offset:64
    ds_read_b128 v[144:147], v210 offset:96
    ds_read_b128 v[148:151], v210 offset:128
    ds_read_b128 v[152:155], v210 offset:160
    ds_read_b128 v[156:159], v210 offset:192
    ds_read_b128 v[160:163], v210 offset:224
    ds_read_b128 v[164:167], v210 offset:256
    ds_read_b128 v[168:171], v210 offset:288
    ds_read_b128 v[172:175], v210 offset:320
    ds_read_b128 v[176:179], v210 offset:352
    s_waitcnt lgkmcnt(0)
    v_pk_mul_f32 v[218:219], v[132:133], v[214:215] op_sel:[0,1] op_sel_hi:[1,1]
    v_pk_mul_f32 v[220:221], v[134:135], v[214:215] op_sel:[0,1] op_sel_hi:[1,1]
    v_pk_mul_f32 v[222:223], v[136:137], v[214:215] op_sel:[0,1] op_sel_hi:[1,1]
    v_pk_mul_f32 v[224:225], v[138:139], v[214:215] op_sel:[0,1] op_sel_hi:[1,1]
    v_pk_mul_f32 v[226:227], v[140:141], v[214:215] op_sel:[0,1] op_sel_hi:[1,1]
    v_pk_mul_f32 v[228:229], v[142:143], v[214:215] op_sel:[0,1] op_sel_hi:[1,1]
    v_pk_mul_f32 v[230:231], v[144:145], v[214:215] op_sel:[0,1] op_sel_hi:[1,1]
    v_pk_mul_f32 v[232:233], v[146:147], v[214:215] op_sel:[0,1] op_sel_hi:[1,1]
    v_pk_fma_f32 v[36:37], v[36:37], v[214:215], v[218:219] op_sel_hi:[1,0,1] neg_lo:[0,0,1] neg_hi:[0,0,1]
    v_pk_fma_f32 v[38:39], v[38:39], v[214:215], v[220:221] op_sel_hi:[1,0,1] neg_lo:[0,0,1] neg_hi:[0,0,1]
    v_pk_fma_f32 v[40:41], v[40:41], v[214:215], v[222:223] op_sel_hi:[1,0,1] neg_lo:[0,0,1] neg_hi:[0,0,1]
    v_pk_fma_f32 v[42:43], v[42:43], v[214:215], v[224:225] op_sel_hi:[1,0,1] neg_lo:[0,0,1] neg_hi:[0,0,1]
    v_pk_fma_f32 v[44:45], v[44:45], v[214:215], v[226:227] op_sel_hi:[1,0,1] neg_lo:[0,0,1] neg_hi:[0,0,1]
    v_pk_fma_f32 v[46:47], v[46:47], v[214:215], v[228:229] op_sel_hi:[1,0,1] neg_lo:[0,0,1] neg_hi:[0,0,1]
    v_pk_fma_f32 v[48:49], v[48:49], v[214:215], v[230:231] op_sel_hi:[1,0,1] neg_lo:[0,0,1] neg_hi:[0,0,1]
    v_pk_fma_f32 v[50:51], v[50:51], v[214:215], v[232:233] op_sel_hi:[1,0,1] neg_lo:[0,0,1] neg_hi:[0,0,1]
    v_cvt_pk_bf16_f32 v234, v36, v37
    v_cvt_pk_bf16_f32 v235, v38, v39
    v_cvt_pk_bf16_f32 v236, v40, v41
    v_cvt_pk_bf16_f32 v237, v42, v43
    v_cvt_pk_bf16_f32 v238, v44, v45
    v_cvt_pk_bf16_f32 v239, v46, v47
    v_cvt_pk_bf16_f32 v240, v48, v49
    v_cvt_pk_bf16_f32 v241, v50, v51
    ds_write_b64 v212, v[234:235] offset:0
    ds_write_b64 v212, v[236:237] offset:16
    ds_write_b64 v212, v[238:239] offset:32
    ds_write_b64 v212, v[240:241] offset:48
    v_pk_mul_f32 v[218:219], v[148:149], v[214:215] op_sel:[0,1] op_sel_hi:[1,1]
    v_pk_mul_f32 v[220:221], v[150:151], v[214:215] op_sel:[0,1] op_sel_hi:[1,1]
    v_pk_mul_f32 v[222:223], v[152:153], v[214:215] op_sel:[0,1] op_sel_hi:[1,1]
    v_pk_mul_f32 v[224:225], v[154:155], v[214:215] op_sel:[0,1] op_sel_hi:[1,1]
    v_pk_mul_f32 v[226:227], v[156:157], v[214:215] op_sel:[0,1] op_sel_hi:[1,1]
    v_pk_mul_f32 v[228:229], v[158:159], v[214:215] op_sel:[0,1] op_sel_hi:[1,1]
    v_pk_mul_f32 v[230:231], v[160:161], v[214:215] op_sel:[0,1] op_sel_hi:[1,1]
    v_pk_mul_f32 v[232:233], v[162:163], v[214:215] op_sel:[0,1] op_sel_hi:[1,1]
    v_pk_fma_f32 v[68:69], v[68:69], v[214:215], v[218:219] op_sel_hi:[1,0,1] neg_lo:[0,0,1] neg_hi:[0,0,1]
    v_pk_fma_f32 v[70:71], v[70:71], v[214:215], v[220:221] op_sel_hi:[1,0,1] neg_lo:[0,0,1] neg_hi:[0,0,1]
    v_pk_fma_f32 v[72:73], v[72:73], v[214:215], v[222:223] op_sel_hi:[1,0,1] neg_lo:[0,0,1] neg_hi:[0,0,1]
    v_pk_fma_f32 v[74:75], v[74:75], v[214:215], v[224:225] op_sel_hi:[1,0,1] neg_lo:[0,0,1] neg_hi:[0,0,1]
    v_pk_fma_f32 v[76:77], v[76:77], v[214:215], v[226:227] op_sel_hi:[1,0,1] neg_lo:[0,0,1] neg_hi:[0,0,1]
    v_pk_fma_f32 v[78:79], v[78:79], v[214:215], v[228:229] op_sel_hi:[1,0,1] neg_lo:[0,0,1] neg_hi:[0,0,1]
    v_pk_fma_f32 v[80:81], v[80:81], v[214:215], v[230:231] op_sel_hi:[1,0,1] neg_lo:[0,0,1] neg_hi:[0,0,1]
    v_pk_fma_f32 v[82:83], v[82:83], v[214:215], v[232:233] op_sel_hi:[1,0,1] neg_lo:[0,0,1] neg_hi:[0,0,1]
    v_cvt_pk_bf16_f32 v234, v68, v69
    v_cvt_pk_bf16_f32 v235, v70, v71
    v_cvt_pk_bf16_f32 v236, v72, v73
    v_cvt_pk_bf16_f32 v237, v74, v75
    v_cvt_pk_bf16_f32 v238, v76, v77
    v_cvt_pk_bf16_f32 v239, v78, v79
    v_cvt_pk_bf16_f32 v240, v80, v81
    v_cvt_pk_bf16_f32 v241, v82, v83
    ds_write_b64 v212, v[234:235] offset:64
    ds_write_b64 v212, v[236:237] offset:80
    ds_write_b64 v212, v[238:239] offset:96
    ds_write_b64 v212, v[240:241] offset:112
    v_pk_mul_f32 v[218:219], v[164:165], v[214:215] op_sel:[0,1] op_sel_hi:[1,1]
    v_pk_mul_f32 v[220:221], v[166:167], v[214:215] op_sel:[0,1] op_sel_hi:[1,1]
    v_pk_mul_f32 v[222:223], v[168:169], v[214:215] op_sel:[0,1] op_sel_hi:[1,1]
    v_pk_mul_f32 v[224:225], v[170:171], v[214:215] op_sel:[0,1] op_sel_hi:[1,1]
    v_pk_mul_f32 v[226:227], v[172:173], v[214:215] op_sel:[0,1] op_sel_hi:[1,1]
    v_pk_mul_f32 v[228:229], v[174:175], v[214:215] op_sel:[0,1] op_sel_hi:[1,1]
    v_pk_mul_f32 v[230:231], v[176:177], v[214:215] op_sel:[0,1] op_sel_hi:[1,1]
    v_pk_mul_f32 v[232:233], v[178:179], v[214:215] op_sel:[0,1] op_sel_hi:[1,1]
    v_pk_fma_f32 v[100:101], v[100:101], v[214:215], v[218:219] op_sel_hi:[1,0,1] neg_lo:[0,0,1] neg_hi:[0,0,1]
    v_pk_fma_f32 v[102:103], v[102:103], v[214:215], v[220:221] op_sel_hi:[1,0,1] neg_lo:[0,0,1] neg_hi:[0,0,1]
    v_pk_fma_f32 v[104:105], v[104:105], v[214:215], v[222:223] op_sel_hi:[1,0,1] neg_lo:[0,0,1] neg_hi:[0,0,1]
    v_pk_fma_f32 v[106:107], v[106:107], v[214:215], v[224:225] op_sel_hi:[1,0,1] neg_lo:[0,0,1] neg_hi:[0,0,1]
    v_pk_fma_f32 v[108:109], v[108:109], v[214:215], v[226:227] op_sel_hi:[1,0,1] neg_lo:[0,0,1] neg_hi:[0,0,1]
    v_pk_fma_f32 v[110:111], v[110:111], v[214:215], v[228:229] op_sel_hi:[1,0,1] neg_lo:[0,0,1] neg_hi:[0,0,1]
    v_pk_fma_f32 v[112:113], v[112:113], v[214:215], v[230:231] op_sel_hi:[1,0,1] neg_lo:[0,0,1] neg_hi:[0,0,1]
    v_pk_fma_f32 v[114:115], v[114:115], v[214:215], v[232:233] op_sel_hi:[1,0,1] neg_lo:[0,0,1] neg_hi:[0,0,1]
    v_cvt_pk_bf16_f32 v234, v100, v101
    v_cvt_pk_bf16_f32 v235, v102, v103
    v_cvt_pk_bf16_f32 v236, v104, v105
    v_cvt_pk_bf16_f32 v237, v106, v107
    v_cvt_pk_bf16_f32 v238, v108, v109
    v_cvt_pk_bf16_f32 v239, v110, v111
    v_cvt_pk_bf16_f32 v240, v112, v113
    v_cvt_pk_bf16_f32 v241, v114, v115
    ds_write_b64 v212, v[234:235] offset:128
    ds_write_b64 v212, v[236:237] offset:144
    ds_write_b64 v212, v[238:239] offset:160
    ds_write_b64 v212, v[240:241] offset:176
    s_waitcnt lgkmcnt(0)
    s_barrier
    v_pk_mul_f32 v[218:219], v[132:133], v[216:217] op_sel:[0,1] op_sel_hi:[1,1]
    v_pk_mul_f32 v[220:221], v[134:135], v[216:217] op_sel:[0,1] op_sel_hi:[1,1]
    v_pk_mul_f32 v[222:223], v[136:137], v[216:217] op_sel:[0,1] op_sel_hi:[1,1]
    v_pk_mul_f32 v[224:225], v[138:139], v[216:217] op_sel:[0,1] op_sel_hi:[1,1]
    v_pk_mul_f32 v[226:227], v[140:141], v[216:217] op_sel:[0,1] op_sel_hi:[1,1]
    v_pk_mul_f32 v[228:229], v[142:143], v[216:217] op_sel:[0,1] op_sel_hi:[1,1]
    v_pk_mul_f32 v[230:231], v[144:145], v[216:217] op_sel:[0,1] op_sel_hi:[1,1]
    v_pk_mul_f32 v[232:233], v[146:147], v[216:217] op_sel:[0,1] op_sel_hi:[1,1]
    v_pk_fma_f32 v[52:53], v[52:53], v[216:217], v[218:219] op_sel_hi:[1,0,1] neg_lo:[0,0,1] neg_hi:[0,0,1]
    v_pk_fma_f32 v[54:55], v[54:55], v[216:217], v[220:221] op_sel_hi:[1,0,1] neg_lo:[0,0,1] neg_hi:[0,0,1]
    v_pk_fma_f32 v[56:57], v[56:57], v[216:217], v[222:223] op_sel_hi:[1,0,1] neg_lo:[0,0,1] neg_hi:[0,0,1]
    v_pk_fma_f32 v[58:59], v[58:59], v[216:217], v[224:225] op_sel_hi:[1,0,1] neg_lo:[0,0,1] neg_hi:[0,0,1]
    v_pk_fma_f32 v[60:61], v[60:61], v[216:217], v[226:227] op_sel_hi:[1,0,1] neg_lo:[0,0,1] neg_hi:[0,0,1]
    v_pk_fma_f32 v[62:63], v[62:63], v[216:217], v[228:229] op_sel_hi:[1,0,1] neg_lo:[0,0,1] neg_hi:[0,0,1]
    v_pk_fma_f32 v[64:65], v[64:65], v[216:217], v[230:231] op_sel_hi:[1,0,1] neg_lo:[0,0,1] neg_hi:[0,0,1]
    v_pk_fma_f32 v[66:67], v[66:67], v[216:217], v[232:233] op_sel_hi:[1,0,1] neg_lo:[0,0,1] neg_hi:[0,0,1]
    v_cvt_pk_bf16_f32 v234, v52, v53
    v_cvt_pk_bf16_f32 v235, v54, v55
    v_cvt_pk_bf16_f32 v236, v56, v57
    v_cvt_pk_bf16_f32 v237, v58, v59
    v_cvt_pk_bf16_f32 v238, v60, v61
    v_cvt_pk_bf16_f32 v239, v62, v63
    v_cvt_pk_bf16_f32 v240, v64, v65
    v_cvt_pk_bf16_f32 v241, v66, v67
    ds_write_b64 v212, v[234:235] offset:12800
    ds_write_b64 v212, v[236:237] offset:12816
    ds_write_b64 v212, v[238:239] offset:12832
    ds_write_b64 v212, v[240:241] offset:12848
    v_pk_mul_f32 v[218:219], v[148:149], v[216:217] op_sel:[0,1] op_sel_hi:[1,1]
    v_pk_mul_f32 v[220:221], v[150:151], v[216:217] op_sel:[0,1] op_sel_hi:[1,1]
    v_pk_mul_f32 v[222:223], v[152:153], v[216:217] op_sel:[0,1] op_sel_hi:[1,1]
    v_pk_mul_f32 v[224:225], v[154:155], v[216:217] op_sel:[0,1] op_sel_hi:[1,1]
    v_pk_mul_f32 v[226:227], v[156:157], v[216:217] op_sel:[0,1] op_sel_hi:[1,1]
    v_pk_mul_f32 v[228:229], v[158:159], v[216:217] op_sel:[0,1] op_sel_hi:[1,1]
    v_pk_mul_f32 v[230:231], v[160:161], v[216:217] op_sel:[0,1] op_sel_hi:[1,1]
    v_pk_mul_f32 v[232:233], v[162:163], v[216:217] op_sel:[0,1] op_sel_hi:[1,1]
    v_pk_fma_f32 v[84:85], v[84:85], v[216:217], v[218:219] op_sel_hi:[1,0,1] neg_lo:[0,0,1] neg_hi:[0,0,1]
    v_pk_fma_f32 v[86:87], v[86:87], v[216:217], v[220:221] op_sel_hi:[1,0,1] neg_lo:[0,0,1] neg_hi:[0,0,1]
    v_pk_fma_f32 v[88:89], v[88:89], v[216:217], v[222:223] op_sel_hi:[1,0,1] neg_lo:[0,0,1] neg_hi:[0,0,1]
    v_pk_fma_f32 v[90:91], v[90:91], v[216:217], v[224:225] op_sel_hi:[1,0,1] neg_lo:[0,0,1] neg_hi:[0,0,1]
    v_pk_fma_f32 v[92:93], v[92:93], v[216:217], v[226:227] op_sel_hi:[1,0,1] neg_lo:[0,0,1] neg_hi:[0,0,1]
    v_pk_fma_f32 v[94:95], v[94:95], v[216:217], v[228:229] op_sel_hi:[1,0,1] neg_lo:[0,0,1] neg_hi:[0,0,1]
    v_pk_fma_f32 v[96:97], v[96:97], v[216:217], v[230:231] op_sel_hi:[1,0,1] neg_lo:[0,0,1] neg_hi:[0,0,1]
    v_pk_fma_f32 v[98:99], v[98:99], v[216:217], v[232:233] op_sel_hi:[1,0,1] neg_lo:[0,0,1] neg_hi:[0,0,1]
    v_cvt_pk_bf16_f32 v234, v84, v85
    v_cvt_pk_bf16_f32 v235, v86, v87
    v_cvt_pk_bf16_f32 v236, v88, v89
    v_cvt_pk_bf16_f32 v237, v90, v91
    v_cvt_pk_bf16_f32 v238, v92, v93
    v_cvt_pk_bf16_f32 v239, v94, v95
    v_cvt_pk_bf16_f32 v240, v96, v97
    v_cvt_pk_bf16_f32 v241, v98, v99
    ds_write_b64 v212, v[234:235] offset:12864
    ds_write_b64 v212, v[236:237] offset:12880
    ds_write_b64 v212, v[238:239] offset:12896
    ds_write_b64 v212, v[240:241] offset:12912
    v_pk_mul_f32 v[218:219], v[164:165], v[216:217] op_sel:[0,1] op_sel_hi:[1,1]
    v_pk_mul_f32 v[220:221], v[166:167], v[216:217] op_sel:[0,1] op_sel_hi:[1,1]
    v_pk_mul_f32 v[222:223], v[168:169], v[216:217] op_sel:[0,1] op_sel_hi:[1,1]
    v_pk_mul_f32 v[224:225], v[170:171], v[216:217] op_sel:[0,1] op_sel_hi:[1,1]
    v_pk_mul_f32 v[226:227], v[172:173], v[216:217] op_sel:[0,1] op_sel_hi:[1,1]
    v_pk_mul_f32 v[228:229], v[174:175], v[216:217] op_sel:[0,1] op_sel_hi:[1,1]
    v_pk_mul_f32 v[230:231], v[176:177], v[216:217] op_sel:[0,1] op_sel_hi:[1,1]
    v_pk_mul_f32 v[232:233], v[178:179], v[216:217] op_sel:[0,1] op_sel_hi:[1,1]
    v_pk_fma_f32 v[116:117], v[116:117], v[216:217], v[218:219] op_sel_hi:[1,0,1] neg_lo:[0,0,1] neg_hi:[0,0,1]
    v_pk_fma_f32 v[118:119], v[118:119], v[216:217], v[220:221] op_sel_hi:[1,0,1] neg_lo:[0,0,1] neg_hi:[0,0,1]
    v_pk_fma_f32 v[120:121], v[120:121], v[216:217], v[222:223] op_sel_hi:[1,0,1] neg_lo:[0,0,1] neg_hi:[0,0,1]
    v_pk_fma_f32 v[122:123], v[122:123], v[216:217], v[224:225] op_sel_hi:[1,0,1] neg_lo:[0,0,1] neg_hi:[0,0,1]
    v_pk_fma_f32 v[124:125], v[124:125], v[216:217], v[226:227] op_sel_hi:[1,0,1] neg_lo:[0,0,1] neg_hi:[0,0,1]
    v_pk_fma_f32 v[126:127], v[126:127], v[216:217], v[228:229] op_sel_hi:[1,0,1] neg_lo:[0,0,1] neg_hi:[0,0,1]
    v_pk_fma_f32 v[128:129], v[128:129], v[216:217], v[230:231] op_sel_hi:[1,0,1] neg_lo:[0,0,1] neg_hi:[0,0,1]
    v_pk_fma_f32 v[130:131], v[130:131], v[216:217], v[232:233] op_sel_hi:[1,0,1] neg_lo:[0,0,1] neg_hi:[0,0,1]
    v_cvt_pk_bf16_f32 v234, v116, v117
    v_cvt_pk_bf16_f32 v235, v118, v119
    v_cvt_pk_bf16_f32 v236, v120, v121
    v_cvt_pk_bf16_f32 v237, v122, v123
    v_cvt_pk_bf16_f32 v238, v124, v125
    v_cvt_pk_bf16_f32 v239, v126, v127
    v_cvt_pk_bf16_f32 v240, v128, v129
    v_cvt_pk_bf16_f32 v241, v130, v131
    ds_write_b64 v212, v[234:235] offset:12928
    ds_write_b64 v212, v[236:237] offset:12944
    ds_write_b64 v212, v[238:239] offset:12960
    ds_write_b64 v212, v[240:241] offset:12976
    s_waitcnt lgkmcnt(0)
    s_barrier
    s_lshr_b32 s99, s20, 2
    s_lshl_b32 s99, s99, 6
    s_and_b32 s65, s20, 3
    s_lshl_b32 s65, s65, 3
    s_add_u32 s65, s65, s99
    s_add_u32 s65, s65, 32
    v_mul_u32_u24 v5, 2731, v1
    v_lshrrev_b32 v5, 16, v5
    v_mul_u32_u24 v6, 24, v5
    v_sub_u32 v4, v1, v6
    v_add_u32 v248, s65, v5
    v_mul_u32_u24 v6, 400, v248
    v_lshl_add_u32 v242, v4, 4, v6
    v_mul_u32_u24 v6, 5120, v248
    v_lshl_add_u32 v6, v4, 4, v6
    v_add_u32 v245, s27, v6
    v_add_u32 v4, 64, v1
    v_mul_u32_u24 v5, 2731, v4
    v_lshrrev_b32 v5, 16, v5
    v_mul_u32_u24 v6, 24, v5
    v_sub_u32 v4, v4, v6
    v_add_u32 v249, s65, v5
    v_mul_u32_u24 v6, 400, v249
    v_lshl_add_u32 v243, v4, 4, v6
    v_mul_u32_u24 v6, 5120, v249
    v_lshl_add_u32 v6, v4, 4, v6
    v_add_u32 v246, s27, v6
    v_add_u32 v4, 128, v1
    v_mul_u32_u24 v5, 2731, v4
    v_lshrrev_b32 v5, 16, v5
    v_mul_u32_u24 v6, 24, v5
    v_sub_u32 v4, v4, v6
    v_add_u32 v250, s65, v5
    v_mul_u32_u24 v6, 400, v250
    v_lshl_add_u32 v244, v4, 4, v6
    v_mul_u32_u24 v6, 5120, v250
    v_lshl_add_u32 v6, v4, 4, v6
    v_add_u32 v247, s27, v6
    ds_read_b128 v[132:135], v242 offset:0
    ds_read_b128 v[136:139], v243 offset:0
    ds_read_b128 v[140:143], v244 offset:0
    v_add_u32 v4, 0, v248
    v_cmp_gt_u32 vcc, 125, v4
    v_mov_b32 v5, 0x80000000
    v_add_u32 v6, 0, v245
    v_cndmask_b32 v6, v5, v6, vcc
    s_waitcnt lgkmcnt(2)
    buffer_store_dwordx4 v[132:135], v6, s[16:19], 0 offen sc1
    v_add_u32 v4, 0, v249
    v_cmp_gt_u32 vcc, 125, v4
    v_mov_b32 v5, 0x80000000
    v_add_u32 v6, 0, v246
    v_cndmask_b32 v6, v5, v6, vcc
    s_waitcnt lgkmcnt(1)
    buffer_store_dwordx4 v[136:139], v6, s[16:19], 0 offen sc1
    v_add_u32 v4, 0, v250
    v_cmp_gt_u32 vcc, 125, v4
    v_mov_b32 v5, 0x80000000
    v_add_u32 v6, 0, v247
    v_cndmask_b32 v6, v5, v6, vcc
    s_waitcnt lgkmcnt(0)
    buffer_store_dwordx4 v[140:143], v6, s[16:19], 0 offen sc1
k1A_end:
    s_endpgm
k1A_loader:
    v_and_b32 v1, 63, v0
    s_mul_i32 s99, s25, 32
    s_mul_i32 s58, s25, 4096
    s_add_u32 s99, s99, s26
    v_lshrrev_b32 v4, 3, v1
    v_lshrrev_b32 v5, 4, v1
    v_and_b32 v6, 7, v1
    v_xor_b32 v5, v5, v6
    v_add_u32 v4, s99, v4
    v_lshlrev_b32 v4, 10, v4
    v_lshl_add_u32 v18, v5, 4, v4
    v_xor_b32 v5, 4, v5
    v_lshl_add_u32 v6, v5, 4, v4
    v_add_u32 v19, 7168, v6
    v_add_u32 v20, 14336, v18
    v_add_u32 v21, 21504, v6
    s_mul_i32 s63, s22, 384
    s_mul_i32 s56, s25, 6144
    s_mul_i32 s99, s25, 49152
    s_add_u32 s99, s99, s63
    v_mul_u32_u24 v5, 2731, v1
    v_lshrrev_b32 v5, 16, v5
    v_mul_u32_u24 v6, 24, v5
    v_sub_u32 v4, v1, v6
    v_bfe_u32 v6, v5, 1, 1
    v_lshlrev_b32 v6, 2, v6
    v_xor_b32 v4, v4, v6
    v_mul_u32_u24 v5, 3072, v5
    v_lshl_add_u32 v12, v4, 4, v5
    v_add_u32 v12, s99, v12
    v_add_u32 v4, 64, v1
    v_mul_u32_u24 v5, 2731, v4
    v_lshrrev_b32 v5, 16, v5
    v_mul_u32_u24 v6, 24, v5
    v_sub_u32 v4, v4, v6
    v_bfe_u32 v6, v5, 1, 1
    v_lshlrev_b32 v6, 2, v6
    v_xor_b32 v4, v4, v6
    v_mul_u32_u24 v5, 3072, v5
    v_lshl_add_u32 v13, v4, 4, v5
    v_add_u32 v13, s99, v13
    v_add_u32 v4, 128, v1
    v_mul_u32_u24 v5, 2731, v4
    v_lshrrev_b32 v5, 16, v5
    v_mul_u32_u24 v6, 24, v5
    v_sub_u32 v4, v4, v6
    v_bfe_u32 v6, v5, 1, 1
    v_lshlrev_b32 v6, 2, v6
    v_xor_b32 v4, v4, v6
    v_mul_u32_u24 v5, 3072, v5
    v_lshl_add_u32 v14, v4, 4, v5
    v_add_u32 v14, s99, v14
    v_add_u32 v17, 23552, v14
    v_add_u32 v16, 24576, v13
    v_add_u32 v15, 21504, v12
    v_add_u32 v14, 4294965248, v14
    v_add_u32 v13, 4294966272, v13
    s_cmp_eq_u32 s25, 3
    s_cselect_b32 s60, 0xffffffff, 0xffffffff
    s_cselect_b32 s61, 0xff, 0xffffffff
    s_mov_b32 s62, s23
    s_mul_i32 s57, s62, 196608
    s_lshl_b32 s59, s62, 7
    v_mov_b32 v8, 0x3f803f80
    v_mov_b32 v9, 0x3f803f80
    v_mov_b32 v10, 0x3f803f80
    v_mov_b32 v11, 0x3f803f80
    v_lshlrev_b32 v4, 4, v1
    s_mov_b64 exec, 0xffffff
    v_add_u32 v5, 40576, v4
    ds_write_b128 v5, v[8:11]
    v_add_u32 v5, 81536, v4
    ds_write_b128 v5, v[8:11]
    v_add_u32 v5, 122496, v4
    ds_write_b128 v5, v[8:11]
    s_mov_b64 exec, -1
    s_waitcnt lgkmcnt(0)
    s_mov_b32 s30, s42
    s_mov_b32 s31, s43
    s_mov_b32 s8, s4
    s_mov_b32 s9, s5
    s_mov_b32 s10, 2048000
    s_mov_b32 s11, 0x20000
    s_mov_b32 s12, s6
    s_mov_b32 s13, s7
    s_mov_b32 s14, 1572864
    s_mov_b32 s15, 0x20000
    s_add_u32 m0, s58, 24576
    s_nop 0
    buffer_load_dwordx4 v18, s[8:11], s59 offen offset:0  lds
    buffer_load_dwordx4 v19, s[8:11], s59 offen offset:1024  lds
    buffer_load_dwordx4 v20, s[8:11], s59 offen offset:2048  lds
    s_mov_b64 exec, s[60:61]
    buffer_load_dwordx4 v21, s[8:11], s59 offen offset:3072  lds
    s_mov_b64 exec, -1
    s_add_u32 m0, s56, 0
    s_nop 0
    buffer_load_dwordx4 v12, s[12:15], s57 offen offset:0  lds
    buffer_load_dwordx4 v13, s[12:15], s57 offen offset:1024  lds
    buffer_load_dwordx4 v14, s[12:15], s57 offen offset:2048  lds
    buffer_load_dwordx4 v15, s[12:15], s57 offen offset:3072  lds
    s_add_u32 m0, s56, 4096
    s_nop 0
    buffer_load_dwordx4 v16, s[12:15], s57 offen offset:0  lds
    buffer_load_dwordx4 v17, s[12:15], s57 offen offset:1024  lds
    s_add_u32 s62, s62, 1
    s_and_b32 s62, s62, 7
    s_mul_i32 s57, s62, 196608
    s_lshl_b32 s59, s62, 7
    s_add_u32 m0, s58, 65536
    s_nop 0
    buffer_load_dwordx4 v18, s[8:11], s59 offen offset:0  lds
    buffer_load_dwordx4 v19, s[8:11], s59 offen offset:1024  lds
    buffer_load_dwordx4 v20, s[8:11], s59 offen offset:2048  lds
    s_mov_b64 exec, s[60:61]
    buffer_load_dwordx4 v21, s[8:11], s59 offen offset:3072  lds
    s_mov_b64 exec, -1
    s_add_u32 m0, s56, 40960
    s_nop 0
    buffer_load_dwordx4 v12, s[12:15], s57 offen offset:0  lds
    buffer_load_dwordx4 v13, s[12:15], s57 offen offset:1024  lds
    buffer_load_dwordx4 v14, s[12:15], s57 offen offset:2048  lds
    buffer_load_dwordx4 v15, s[12:15], s57 offen offset:3072  lds
    s_add_u32 m0, s56, 45056
    s_nop 0
    buffer_load_dwordx4 v16, s[12:15], s57 offen offset:0  lds
    buffer_load_dwordx4 v17, s[12:15], s57 offen offset:1024  lds
    s_add_u32 s62, s62, 1
    s_and_b32 s62, s62, 7
    s_mul_i32 s57, s62, 196608
    s_lshl_b32 s59, s62, 7
    s_mov_b32 s16, s30
    s_mov_b32 s17, s31
    s_mov_b32 s18, 10240000
    s_mov_b32 s19, 0x20000
    v_lshrrev_b32 v80, 2, v0
    v_and_b32 v81, 3, v0
    v_bfe_u32 v82, v80, 1, 1
    v_lshlrev_b32 v81, 1, v81
    v_xor_b32 v81, v81, v82
    v_lshlrev_b32 v80, 7, v80
    v_lshl_add_u32 v80, v81, 4, v80
    v_add_u32 v56, 24576, v80
    v_xor_b32 v57, 16, v80
    v_add_u32 v57, 24576, v57
    v_mov_b32 v58, 0
    v_mov_b32 v59, 0
    v_mov_b32 v60, 0
    v_mov_b32 v61, 0
    s_waitcnt vmcnt(10)
    s_barrier
    s_add_u32 m0, s58, 106496
    s_nop 0
    buffer_load_dwordx4 v18, s[8:11], s59 offen offset:0  lds
    ds_read_b128 v[64:67], v56 offset:0
    ds_read_b128 v[68:71], v57 offset:0
    s_waitcnt lgkmcnt(0)
    v_lshlrev_b32 v72, 16, v64
    v_and_b32 v73, 0xffff0000, v64
    v_lshlrev_b32 v74, 16, v65
    buffer_load_dwordx4 v19, s[8:11], s59 offen offset:1024  lds
    v_and_b32 v75, 0xffff0000, v65
    v_lshlrev_b32 v76, 16, v66
    v_and_b32 v77, 0xffff0000, v66
    v_lshlrev_b32 v78, 16, v67
    v_and_b32 v79, 0xffff0000, v67
    buffer_load_dwordx4 v20, s[8:11], s59 offen offset:2048  lds
    v_add_f32 v58, v58, v72
    v_add_f32 v59, v59, v73
    v_fmac_f32 v60, v72, v72
    v_fmac_f32 v61, v73, v73
    v_add_f32 v58, v58, v74
    s_mov_b64 exec, s[60:61]
    buffer_load_dwordx4 v21, s[8:11], s59 offen offset:3072  lds
    s_mov_b64 exec, -1
    v_add_f32 v59, v59, v75
    v_fmac_f32 v60, v74, v74
    v_fmac_f32 v61, v75, v75
    v_add_f32 v58, v58, v76
    v_add_f32 v59, v59, v77
    s_add_u32 m0, s56, 81920
    s_nop 0
    buffer_load_dwordx4 v12, s[12:15], s57 offen offset:0  lds
    v_fmac_f32 v60, v76, v76
    v_fmac_f32 v61, v77, v77
    v_add_f32 v58, v58, v78
    v_add_f32 v59, v59, v79
    v_fmac_f32 v60, v78, v78
    buffer_load_dwordx4 v13, s[12:15], s57 offen offset:1024  lds
    v_fmac_f32 v61, v79, v79
    v_lshlrev_b32 v72, 16, v68
    v_and_b32 v73, 0xffff0000, v68
    v_lshlrev_b32 v74, 16, v69
    v_and_b32 v75, 0xffff0000, v69
    buffer_load_dwordx4 v14, s[12:15], s57 offen offset:2048  lds
    v_lshlrev_b32 v76, 16, v70
    v_and_b32 v77, 0xffff0000, v70
    v_lshlrev_b32 v78, 16, v71
    v_and_b32 v79, 0xffff0000, v71
    v_add_f32 v58, v58, v72
    buffer_load_dwordx4 v15, s[12:15], s57 offen offset:3072  lds
    v_add_f32 v59, v59, v73
    v_fmac_f32 v60, v72, v72
    v_fmac_f32 v61, v73, v73
    v_add_f32 v58, v58, v74
    v_add_f32 v59, v59, v75
    s_add_u32 m0, s56, 86016
    s_nop 0
    buffer_load_dwordx4 v16, s[12:15], s57 offen offset:0  lds
    v_fmac_f32 v60, v74, v74
    v_fmac_f32 v61, v75, v75
    v_add_f32 v58, v58, v76
    v_add_f32 v59, v59, v77
    v_fmac_f32 v60, v76, v76
    buffer_load_dwordx4 v17, s[12:15], s57 offen offset:1024  lds
    s_add_u32 s62, s62, 1
    s_and_b32 s62, s62, 7
    s_mul_i32 s57, s62, 196608
    s_lshl_b32 s59, s62, 7
    v_fmac_f32 v61, v77, v77
    v_add_f32 v58, v58, v78
    v_add_f32 v59, v59, v79
    v_fmac_f32 v60, v78, v78
    v_fmac_f32 v61, v79, v79
    s_waitcnt vmcnt(10)
    s_barrier
    s_add_u32 m0, s58, 24576
    s_nop 0
    buffer_load_dwordx4 v18, s[8:11], s59 offen offset:0  lds
    v_add_u32 v80, 40960, v56
    ds_read_b128 v[64:67], v80
    v_add_u32 v80, 40960, v57
    ds_read_b128 v[68:71], v80
    s_waitcnt lgkmcnt(0)
    v_lshlrev_b32 v72, 16, v64
    v_and_b32 v73, 0xffff0000, v64
    v_lshlrev_b32 v74, 16, v65
    buffer_load_dwordx4 v19, s[8:11], s59 offen offset:1024  lds
    v_and_b32 v75, 0xffff0000, v65
    v_lshlrev_b32 v76, 16, v66
    v_and_b32 v77, 0xffff0000, v66
    v_lshlrev_b32 v78, 16, v67
    v_and_b32 v79, 0xffff0000, v67
    buffer_load_dwordx4 v20, s[8:11], s59 offen offset:2048  lds
    v_add_f32 v58, v58, v72
    v_add_f32 v59, v59, v73
    v_fmac_f32 v60, v72, v72
    v_fmac_f32 v61, v73, v73
    v_add_f32 v58, v58, v74
    s_mov_b64 exec, s[60:61]
    buffer_load_dwordx4 v21, s[8:11], s59 offen offset:3072  lds
    s_mov_b64 exec, -1
    v_add_f32 v59, v59, v75
    v_fmac_f32 v60, v74, v74
    v_fmac_f32 v61, v75, v75
    v_add_f32 v58, v58, v76
    v_add_f32 v59, v59, v77
    s_add_u32 m0, s56, 0
    s_nop 0
    buffer_load_dwordx4 v12, s[12:15], s57 offen offset:0  lds
    v_fmac_f32 v60, v76, v76
    v_fmac_f32 v61, v77, v77
    v_add_f32 v58, v58, v78
    v_add_f32 v59, v59, v79
    v_fmac_f32 v60, v78, v78
    buffer_load_dwordx4 v13, s[12:15], s57 offen offset:1024  lds
    v_fmac_f32 v61, v79, v79
    v_lshlrev_b32 v72, 16, v68
    v_and_b32 v73, 0xffff0000, v68
    v_lshlrev_b32 v74, 16, v69
    v_and_b32 v75, 0xffff0000, v69
    buffer_load_dwordx4 v14, s[12:15], s57 offen offset:2048  lds
    v_lshlrev_b32 v76, 16, v70
    v_and_b32 v77, 0xffff0000, v70
    v_lshlrev_b32 v78, 16, v71
    v_and_b32 v79, 0xffff0000, v71
    v_add_f32 v58, v58, v72
    buffer_load_dwordx4 v15, s[12:15], s57 offen offset:3072  lds
    v_add_f32 v59, v59, v73
    v_fmac_f32 v60, v72, v72
    v_fmac_f32 v61, v73, v73
    v_add_f32 v58, v58, v74
    v_add_f32 v59, v59, v75
    s_add_u32 m0, s56, 4096
    s_nop 0
    buffer_load_dwordx4 v16, s[12:15], s57 offen offset:0  lds
    v_fmac_f32 v60, v74, v74
    v_fmac_f32 v61, v75, v75
    v_add_f32 v58, v58, v76
    v_add_f32 v59, v59, v77
    v_fmac_f32 v60, v76, v76
    buffer_load_dwordx4 v17, s[12:15], s57 offen offset:1024  lds
    s_add_u32 s62, s62, 1
    s_and_b32 s62, s62, 7
    s_mul_i32 s57, s62, 196608
    s_lshl_b32 s59, s62, 7
    v_fmac_f32 v61, v77, v77
    v_add_f32 v58, v58, v78
    v_add_f32 v59, v59, v79
    v_fmac_f32 v60, v78, v78
    v_fmac_f32 v61, v79, v79
    s_waitcnt vmcnt(10)
    s_barrier
    s_add_u32 m0, s58, 65536
    s_nop 0
    buffer_load_dwordx4 v18, s[8:11], s59 offen offset:0  lds
    v_add_u32 v80, 81920, v56
    ds_read_b128 v[64:67], v80
    v_add_u32 v80, 81920, v57
    ds_read_b128 v[68:71], v80
    s_waitcnt lgkmcnt(0)
    v_lshlrev_b32 v72, 16, v64
    v_and_b32 v73, 0xffff0000, v64
    v_lshlrev_b32 v74, 16, v65
    buffer_load_dwordx4 v19, s[8:11], s59 offen offset:1024  lds
    v_and_b32 v75, 0xffff0000, v65
    v_lshlrev_b32 v76, 16, v66
    v_and_b32 v77, 0xffff0000, v66
    v_lshlrev_b32 v78, 16, v67
    v_and_b32 v79, 0xffff0000, v67
    buffer_load_dwordx4 v20, s[8:11], s59 offen offset:2048  lds
    v_add_f32 v58, v58, v72
    v_add_f32 v59, v59, v73
    v_fmac_f32 v60, v72, v72
    v_fmac_f32 v61, v73, v73
    v_add_f32 v58, v58, v74
    s_mov_b64 exec, s[60:61]
    buffer_load_dwordx4 v21, s[8:11], s59 offen offset:3072  lds
    s_mov_b64 exec, -1
    v_add_f32 v59, v59, v75
    v_fmac_f32 v60, v74, v74
    v_fmac_f32 v61, v75, v75
    v_add_f32 v58, v58, v76
    v_add_f32 v59, v59, v77
    s_add_u32 m0, s56, 40960
    s_nop 0
    buffer_load_dwordx4 v12, s[12:15], s57 offen offset:0  lds
    v_fmac_f32 v60, v76, v76
    v_fmac_f32 v61, v77, v77
    v_add_f32 v58, v58, v78
    v_add_f32 v59, v59, v79
    v_fmac_f32 v60, v78, v78
    buffer_load_dwordx4 v13, s[12:15], s57 offen offset:1024  lds
    v_fmac_f32 v61, v79, v79
    v_lshlrev_b32 v72, 16, v68
    v_and_b32 v73, 0xffff0000, v68
    v_lshlrev_b32 v74, 16, v69
    v_and_b32 v75, 0xffff0000, v69
    buffer_load_dwordx4 v14, s[12:15], s57 offen offset:2048  lds
    v_lshlrev_b32 v76, 16, v70
    v_and_b32 v77, 0xffff0000, v70
    v_lshlrev_b32 v78, 16, v71
    v_and_b32 v79, 0xffff0000, v71
    v_add_f32 v58, v58, v72
    buffer_load_dwordx4 v15, s[12:15], s57 offen offset:3072  lds
    v_add_f32 v59, v59, v73
    v_fmac_f32 v60, v72, v72
    v_fmac_f32 v61, v73, v73
    v_add_f32 v58, v58, v74
    v_add_f32 v59, v59, v75
    s_add_u32 m0, s56, 45056
    s_nop 0
    buffer_load_dwordx4 v16, s[12:15], s57 offen offset:0  lds
    v_fmac_f32 v60, v74, v74
    v_fmac_f32 v61, v75, v75
    v_add_f32 v58, v58, v76
    v_add_f32 v59, v59, v77
    v_fmac_f32 v60, v76, v76
    buffer_load_dwordx4 v17, s[12:15], s57 offen offset:1024  lds
    s_add_u32 s62, s62, 1
    s_and_b32 s62, s62, 7
    s_mul_i32 s57, s62, 196608
    s_lshl_b32 s59, s62, 7
    v_fmac_f32 v61, v77, v77
    v_add_f32 v58, v58, v78
    v_add_f32 v59, v59, v79
    v_fmac_f32 v60, v78, v78
    v_fmac_f32 v61, v79, v79
    s_waitcnt vmcnt(10)
    s_barrier
    s_add_u32 m0, s58, 106496
    s_nop 0
    buffer_load_dwordx4 v18, s[8:11], s59 offen offset:0  lds
    ds_read_b128 v[64:67], v56 offset:0
    ds_read_b128 v[68:71], v57 offset:0
    s_waitcnt lgkmcnt(0)
    v_lshlrev_b32 v72, 16, v64
    v_and_b32 v73, 0xffff0000, v64
    v_lshlrev_b32 v74, 16, v65
    buffer_load_dwordx4 v19, s[8:11], s59 offen offset:1024  lds
    v_and_b32 v75, 0xffff0000, v65
    v_lshlrev_b32 v76, 16, v66
    v_and_b32 v77, 0xffff0000, v66
    v_lshlrev_b32 v78, 16, v67
    v_and_b32 v79, 0xffff0000, v67
    buffer_load_dwordx4 v20, s[8:11], s59 offen offset:2048  lds
    v_add_f32 v58, v58, v72
    v_add_f32 v59, v59, v73
    v_fmac_f32 v60, v72, v72
    v_fmac_f32 v61, v73, v73
    v_add_f32 v58, v58, v74
    s_mov_b64 exec, s[60:61]
    buffer_load_dwordx4 v21, s[8:11], s59 offen offset:3072  lds
    s_mov_b64 exec, -1
    v_add_f32 v59, v59, v75
    v_fmac_f32 v60, v74, v74
    v_fmac_f32 v61, v75, v75
    v_add_f32 v58, v58, v76
    v_add_f32 v59, v59, v77
    s_add_u32 m0, s56, 81920
    s_nop 0
    buffer_load_dwordx4 v12, s[12:15], s57 offen offset:0  lds
    v_fmac_f32 v60, v76, v76
    v_fmac_f32 v61, v77, v77
    v_add_f32 v58, v58, v78
    v_add_f32 v59, v59, v79
    v_fmac_f32 v60, v78, v78
    buffer_load_dwordx4 v13, s[12:15], s57 offen offset:1024  lds
    v_fmac_f32 v61, v79, v79
    v_lshlrev_b32 v72, 16, v68
    v_and_b32 v73, 0xffff0000, v68
    v_lshlrev_b32 v74, 16, v69
    v_and_b32 v75, 0xffff0000, v69
    buffer_load_dwordx4 v14, s[12:15], s57 offen offset:2048  lds
    v_lshlrev_b32 v76, 16, v70
    v_and_b32 v77, 0xffff0000, v70
    v_lshlrev_b32 v78, 16, v71
    v_and_b32 v79, 0xffff0000, v71
    v_add_f32 v58, v58, v72
    buffer_load_dwordx4 v15, s[12:15], s57 offen offset:3072  lds
    v_add_f32 v59, v59, v73
    v_fmac_f32 v60, v72, v72
    v_fmac_f32 v61, v73, v73
    v_add_f32 v58, v58, v74
    v_add_f32 v59, v59, v75
    s_add_u32 m0, s56, 86016
    s_nop 0
    buffer_load_dwordx4 v16, s[12:15], s57 offen offset:0  lds
    v_fmac_f32 v60, v74, v74
    v_fmac_f32 v61, v75, v75
    v_add_f32 v58, v58, v76
    v_add_f32 v59, v59, v77
    v_fmac_f32 v60, v76, v76
    buffer_load_dwordx4 v17, s[12:15], s57 offen offset:1024  lds
    s_add_u32 s62, s62, 1
    s_and_b32 s62, s62, 7
    s_mul_i32 s57, s62, 196608
    s_lshl_b32 s59, s62, 7
    v_fmac_f32 v61, v77, v77
    v_add_f32 v58, v58, v78
    v_add_f32 v59, v59, v79
    v_fmac_f32 v60, v78, v78
    v_fmac_f32 v61, v79, v79
    s_cmp_lt_u32 s33, 16
    s_cbranch_scc0 .Lpf1_skip
    s_cmp_eq_u32 s25, 0
    s_cbranch_scc0 .Lpf1_skip
    s_getpc_b64 s[96:97]
.Lpf1_pc:
    s_add_u32 s96, s96, (k1_kernel - .Lpf1_pc) & 0xffffffff
    s_addc_u32 s97, s97, ((k1_kernel - .Lpf1_pc) >> 32) & 0xffffffff
    v_and_b32 v254, 63, v0
    s_lshl_b32 s98, s33, 6
    v_add_u32 v254, s98, v254
    v_lshlrev_b32 v254, 7, v254
    v_min_u32 v254, (k4_exit - k1_kernel - 4), v254
    global_load_dword v255, v254, s[96:97]
.Lpf1_skip:
    s_waitcnt vmcnt(10)
    s_barrier
    s_add_u32 m0, s58, 24576
    s_nop 0
    buffer_load_dwordx4 v18, s[8:11], s59 offen offset:0  lds
    v_add_u32 v80, 40960, v56
    ds_read_b128 v[64:67], v80
    v_add_u32 v80, 40960, v57
    ds_read_b128 v[68:71], v80
    s_waitcnt lgkmcnt(0)
    v_lshlrev_b32 v72, 16, v64
    v_and_b32 v73, 0xffff0000, v64
    v_lshlrev_b32 v74, 16, v65
    buffer_load_dwordx4 v19, s[8:11], s59 offen offset:1024  lds
    v_and_b32 v75, 0xffff0000, v65
    v_lshlrev_b32 v76, 16, v66
    v_and_b32 v77, 0xffff0000, v66
    v_lshlrev_b32 v78, 16, v67
    v_and_b32 v79, 0xffff0000, v67
    buffer_load_dwordx4 v20, s[8:11], s59 offen offset:2048  lds
    v_add_f32 v58, v58, v72
    v_add_f32 v59, v59, v73
    v_fmac_f32 v60, v72, v72
    v_fmac_f32 v61, v73, v73
    v_add_f32 v58, v58, v74
    s_mov_b64 exec, s[60:61]
    buffer_load_dwordx4 v21, s[8:11], s59 offen offset:3072  lds
    s_mov_b64 exec, -1
    v_add_f32 v59, v59, v75
    v_fmac_f32 v60, v74, v74
    v_fmac_f32 v61, v75, v75
    v_add_f32 v58, v58, v76
    v_add_f32 v59, v59, v77
    s_add_u32 m0, s56, 0
    s_nop 0
    buffer_load_dwordx4 v12, s[12:15], s57 offen offset:0  lds
    v_fmac_f32 v60, v76, v76
    v_fmac_f32 v61, v77, v77
    v_add_f32 v58, v58, v78
    v_add_f32 v59, v59, v79
    v_fmac_f32 v60, v78, v78
    buffer_load_dwordx4 v13, s[12:15], s57 offen offset:1024  lds
    v_fmac_f32 v61, v79, v79
    v_lshlrev_b32 v72, 16, v68
    v_and_b32 v73, 0xffff0000, v68
    v_lshlrev_b32 v74, 16, v69
    v_and_b32 v75, 0xffff0000, v69
    buffer_load_dwordx4 v14, s[12:15], s57 offen offset:2048  lds
    v_lshlrev_b32 v76, 16, v70
    v_and_b32 v77, 0xffff0000, v70
    v_lshlrev_b32 v78, 16, v71
    v_and_b32 v79, 0xffff0000, v71
    v_add_f32 v58, v58, v72
    buffer_load_dwordx4 v15, s[12:15], s57 offen offset:3072  lds
    v_add_f32 v59, v59, v73
    v_fmac_f32 v60, v72, v72
    v_fmac_f32 v61, v73, v73
    v_add_f32 v58, v58, v74
    v_add_f32 v59, v59, v75
    s_add_u32 m0, s56, 4096
    s_nop 0
    buffer_load_dwordx4 v16, s[12:15], s57 offen offset:0  lds
    v_fmac_f32 v60, v74, v74
    v_fmac_f32 v61, v75, v75
    v_add_f32 v58, v58, v76
    v_add_f32 v59, v59, v77
    v_fmac_f32 v60, v76, v76
    buffer_load_dwordx4 v17, s[12:15], s57 offen offset:1024  lds
    s_add_u32 s62, s62, 1
    s_and_b32 s62, s62, 7
    s_mul_i32 s57, s62, 196608
    s_lshl_b32 s59, s62, 7
    v_fmac_f32 v61, v77, v77
    v_add_f32 v58, v58, v78
    v_add_f32 v59, v59, v79
    v_fmac_f32 v60, v78, v78
    v_fmac_f32 v61, v79, v79
    s_waitcnt vmcnt(10)
    s_barrier
    s_add_u32 m0, s58, 65536
    s_nop 0
    buffer_load_dwordx4 v18, s[8:11], s59 offen offset:0  lds
    v_add_u32 v80, 81920, v56
    ds_read_b128 v[64:67], v80
    v_add_u32 v80, 81920, v57
    ds_read_b128 v[68:71], v80
    s_waitcnt lgkmcnt(0)
    v_lshlrev_b32 v72, 16, v64
    v_and_b32 v73, 0xffff0000, v64
    v_lshlrev_b32 v74, 16, v65
    buffer_load_dwordx4 v19, s[8:11], s59 offen offset:1024  lds
    v_and_b32 v75, 0xffff0000, v65
    v_lshlrev_b32 v76, 16, v66
    v_and_b32 v77, 0xffff0000, v66
    v_lshlrev_b32 v78, 16, v67
    v_and_b32 v79, 0xffff0000, v67
    buffer_load_dwordx4 v20, s[8:11], s59 offen offset:2048  lds
    v_add_f32 v58, v58, v72
    v_add_f32 v59, v59, v73
    v_fmac_f32 v60, v72, v72
    v_fmac_f32 v61, v73, v73
    v_add_f32 v58, v58, v74
    s_mov_b64 exec, s[60:61]
    buffer_load_dwordx4 v21, s[8:11], s59 offen offset:3072  lds
    s_mov_b64 exec, -1
    v_add_f32 v59, v59, v75
    v_fmac_f32 v60, v74, v74
    v_fmac_f32 v61, v75, v75
    v_add_f32 v58, v58, v76
    v_add_f32 v59, v59, v77
    s_add_u32 m0, s56, 40960
    s_nop 0
    buffer_load_dwordx4 v12, s[12:15], s57 offen offset:0  lds
    v_fmac_f32 v60, v76, v76
    v_fmac_f32 v61, v77, v77
    v_add_f32 v58, v58, v78
    v_add_f32 v59, v59, v79
    v_fmac_f32 v60, v78, v78
    buffer_load_dwordx4 v13, s[12:15], s57 offen offset:1024  lds
    v_fmac_f32 v61, v79, v79
    v_lshlrev_b32 v72, 16, v68
    v_and_b32 v73, 0xffff0000, v68
    v_lshlrev_b32 v74, 16, v69
    v_and_b32 v75, 0xffff0000, v69
    buffer_load_dwordx4 v14, s[12:15], s57 offen offset:2048  lds
    v_lshlrev_b32 v76, 16, v70
    v_and_b32 v77, 0xffff0000, v70
    v_lshlrev_b32 v78, 16, v71
    v_and_b32 v79, 0xffff0000, v71
    v_add_f32 v58, v58, v72
    buffer_load_dwordx4 v15, s[12:15], s57 offen offset:3072  lds
    v_add_f32 v59, v59, v73
    v_fmac_f32 v60, v72, v72
    v_fmac_f32 v61, v73, v73
    v_add_f32 v58, v58, v74
    v_add_f32 v59, v59, v75
    s_add_u32 m0, s56, 45056
    s_nop 0
    buffer_load_dwordx4 v16, s[12:15], s57 offen offset:0  lds
    v_fmac_f32 v60, v74, v74
    v_fmac_f32 v61, v75, v75
    v_add_f32 v58, v58, v76
    v_add_f32 v59, v59, v77
    v_fmac_f32 v60, v76, v76
    buffer_load_dwordx4 v17, s[12:15], s57 offen offset:1024  lds
    s_add_u32 s62, s62, 1
    s_and_b32 s62, s62, 7
    s_mul_i32 s57, s62, 196608
    s_lshl_b32 s59, s62, 7
    v_fmac_f32 v61, v77, v77
    v_add_f32 v58, v58, v78
    v_add_f32 v59, v59, v79
    v_fmac_f32 v60, v78, v78
    v_fmac_f32 v61, v79, v79
    s_lshl_b32 s98, s2, 2
    s_add_u32 s98, s98, s25
    s_lshl_b32 s98, s98, 13
    v_and_b32 v4, 63, v0
    v_lshlrev_b32 v4, 7, v4
    v_add_u32 v4, s98, v4
    s_load_dwordx2 s[76:77], s[0:1], 40
    s_mov_b32 s78, 524288
    s_mov_b32 s79, 0x20000
    s_waitcnt lgkmcnt(0)
    buffer_load_dword v252, v4, s[76:79], 0 offen
    s_load_dwordx2 s[76:77], s[0:1], 56
    s_mov_b32 s78, 1048576
    s_mov_b32 s79, 0x20000
    s_waitcnt lgkmcnt(0)
    buffer_load_dword v252, v4, s[76:79], 0 offen
    s_load_dwordx2 s[76:77], s[0:1], 48
    s_mov_b32 s78, 63488
    s_mov_b32 s79, 0x20000
    s_waitcnt lgkmcnt(0)
    buffer_load_dword v252, v4, s[76:79], 0 offen
    s_waitcnt vmcnt(13)
    s_barrier
    ds_read_b128 v[64:67], v56 offset:0
    ds_read_b128 v[68:71], v57 offset:0
    s_waitcnt lgkmcnt(0)
    v_lshlrev_b32 v72, 16, v64
    v_and_b32 v73, 0xffff0000, v64
    v_lshlrev_b32 v74, 16, v65
    v_and_b32 v75, 0xffff0000, v65
    v_lshlrev_b32 v76, 16, v66
    v_and_b32 v77, 0xffff0000, v66
    v_lshlrev_b32 v78, 16, v67
    v_and_b32 v79, 0xffff0000, v67
    v_add_f32 v58, v58, v72
    v_add_f32 v59, v59, v73
    v_fmac_f32 v60, v72, v72
    v_fmac_f32 v61, v73, v73
    v_add_f32 v58, v58, v74
    v_add_f32 v59, v59, v75
    v_fmac_f32 v60, v74, v74
    v_fmac_f32 v61, v75, v75
    v_add_f32 v58, v58, v76
    v_add_f32 v59, v59, v77
    v_fmac_f32 v60, v76, v76
    v_fmac_f32 v61, v77, v77
    v_add_f32 v58, v58, v78
    v_add_f32 v59, v59, v79
    v_fmac_f32 v60, v78, v78
    v_fmac_f32 v61, v79, v79
    v_lshlrev_b32 v72, 16, v68
    v_and_b32 v73, 0xffff0000, v68
    v_lshlrev_b32 v74, 16, v69
    v_and_b32 v75, 0xffff0000, v69
    v_lshlrev_b32 v76, 16, v70
    v_and_b32 v77, 0xffff0000, v70
    v_lshlrev_b32 v78, 16, v71
    v_and_b32 v79, 0xffff0000, v71
    v_add_f32 v58, v58, v72
    v_add_f32 v59, v59, v73
    v_fmac_f32 v60, v72, v72
    v_fmac_f32 v61, v73, v73
    v_add_f32 v58, v58, v74
    v_add_f32 v59, v59, v75
    v_fmac_f32 v60, v74, v74
    v_fmac_f32 v61, v75, v75
    v_add_f32 v58, v58, v76
    v_add_f32 v59, v59, v77
    v_fmac_f32 v60, v76, v76
    v_fmac_f32 v61, v77, v77
    v_add_f32 v58, v58, v78
    v_add_f32 v59, v59, v79
    v_fmac_f32 v60, v78, v78
    v_fmac_f32 v61, v79, v79
    s_lshl_b32 s98, s33, 2
    s_add_u32 s98, s98, s25
    s_lshl_b32 s98, s98, 13
    v_and_b32 v4, 63, v0
    v_lshlrev_b32 v4, 7, v4
    v_add_u32 v4, s98, v4
    s_load_dwordx2 s[76:77], s[0:1], 16
    s_mov_b32 s78, 524288
    s_mov_b32 s79, 0x20000
    s_waitcnt lgkmcnt(0)
    buffer_load_dword v252, v4, s[76:79], 0 offen
    s_load_dwordx2 s[76:77], s[0:1], 32
    s_mov_b32 s78, 31744
    s_mov_b32 s79, 0x20000
    s_waitcnt lgkmcnt(0)
    buffer_load_dword v252, v4, s[76:79], 0 offen
    s_waitcnt vmcnt(5)
    s_barrier
    v_add_u32 v80, 40960, v56
    ds_read_b128 v[64:67], v80
    v_add_u32 v80, 40960, v57
    ds_read_b128 v[68:71], v80
    s_waitcnt lgkmcnt(0)
    v_lshlrev_b32 v72, 16, v64
    v_and_b32 v73, 0xffff0000, v64
    v_lshlrev_b32 v74, 16, v65
    v_and_b32 v75, 0xffff0000, v65
    v_lshlrev_b32 v76, 16, v66
    v_and_b32 v77, 0xffff0000, v66
    v_lshlrev_b32 v78, 16, v67
    v_and_b32 v79, 0xffff0000, v67
    v_add_f32 v58, v58, v72
    v_add_f32 v59, v59, v73
    v_fmac_f32 v60, v72, v72
    v_fmac_f32 v61, v73, v73
    v_add_f32 v58, v58, v74
    v_add_f32 v59, v59, v75
    v_fmac_f32 v60, v74, v74
    v_fmac_f32 v61, v75, v75
    v_add_f32 v58, v58, v76
    v_add_f32 v59, v59, v77
    v_fmac_f32 v60, v76, v76
    v_fmac_f32 v61, v77, v77
    v_add_f32 v58, v58, v78
    v_add_f32 v59, v59, v79
    v_fmac_f32 v60, v78, v78
    v_fmac_f32 v61, v79, v79
    v_lshlrev_b32 v72, 16, v68
    v_and_b32 v73, 0xffff0000, v68
    v_lshlrev_b32 v74, 16, v69
    v_and_b32 v75, 0xffff0000, v69
    v_lshlrev_b32 v76, 16, v70
    v_and_b32 v77, 0xffff0000, v70
    v_lshlrev_b32 v78, 16, v71
    v_and_b32 v79, 0xffff0000, v71
    v_add_f32 v58, v58, v72
    v_add_f32 v59, v59, v73
    v_fmac_f32 v60, v72, v72
    v_fmac_f32 v61, v73, v73
    v_add_f32 v58, v58, v74
    v_add_f32 v59, v59, v75
    v_fmac_f32 v60, v74, v74
    v_fmac_f32 v61, v75, v75
    v_add_f32 v58, v58, v76
    v_add_f32 v59, v59, v77
    v_fmac_f32 v60, v76, v76
    v_fmac_f32 v61, v77, v77
    v_add_f32 v58, v58, v78
    v_add_f32 v59, v59, v79
    v_fmac_f32 v60, v78, v78
    v_fmac_f32 v61, v79, v79
    v_add_f32 v80, v58, v59
    v_add_f32 v81, v60, v61
    s_nop 1
    v_add_f32_dpp v80, v80, v80 quad_perm:[1,0,3,2] row_mask:0xf bank_mask:0xf
    v_add_f32_dpp v81, v81, v81 quad_perm:[1,0,3,2] row_mask:0xf bank_mask:0xf
    s_nop 1
    v_add_f32_dpp v80, v80, v80 quad_perm:[2,3,0,1] row_mask:0xf bank_mask:0xf
    v_add_f32_dpp v81, v81, v81 quad_perm:[2,3,0,1] row_mask:0xf bank_mask:0xf
    v_mul_f32 v80, 989855744, v80
    v_mul_f32 v81, 989855744, v81
    v_fma_f32 v81, -v80, v80, v81
    v_max_f32 v81, 0, v81
    v_add_f32 v81, 925353388, v81
    v_rsq_f32 v82, v81
    s_nop 0
    v_mul_f32 v83, v80, v82
    v_lshrrev_b32 v84, 2, v0
    v_lshlrev_b32 v84, 3, v84
    v_add_u32 v84, 123648, v84
    ds_write_b64 v84, v[82:83]
    s_waitcnt lgkmcnt(0)
    s_barrier
    s_barrier
    s_lshr_b32 s99, s25, 1
    s_lshl_b32 s99, s99, 6
    s_and_b32 s66, s25, 1
    s_lshl_b32 s66, s66, 4
    s_add_u32 s66, s66, s99
    v_mul_u32_u24 v5, 2731, v1
    v_lshrrev_b32 v5, 16, v5
    v_mul_u32_u24 v6, 24, v5
    v_sub_u32 v4, v1, v6
    v_add_u32 v92, s66, v5
    v_mul_u32_u24 v6, 400, v92
    v_lshl_add_u32 v86, v4, 4, v6
    v_mul_u32_u24 v6, 5120, v92
    v_lshl_add_u32 v6, v4, 4, v6
    v_add_u32 v89, s27, v6
    v_add_u32 v4, 64, v1
    v_mul_u32_u24 v5, 2731, v4
    v_lshrrev_b32 v5, 16, v5
    v_mul_u32_u24 v6, 24, v5
    v_sub_u32 v4, v4, v6
    v_add_u32 v93, s66, v5
    v_mul_u32_u24 v6, 400, v93
    v_lshl_add_u32 v87, v4, 4, v6
    v_mul_u32_u24 v6, 5120, v93
    v_lshl_add_u32 v6, v4, 4, v6
    v_add_u32 v90, s27, v6
    v_add_u32 v4, 128, v1
    v_mul_u32_u24 v5, 2731, v4
    v_lshrrev_b32 v5, 16, v5
    v_mul_u32_u24 v6, 24, v5
    v_sub_u32 v4, v4, v6
    v_add_u32 v94, s66, v5
    v_mul_u32_u24 v6, 400, v94
    v_lshl_add_u32 v88, v4, 4, v6
    v_mul_u32_u24 v6, 5120, v94
    v_lshl_add_u32 v6, v4, 4, v6
    v_add_u32 v91, s27, v6
    ds_read_b128 v[24:27], v86 offset:0
    ds_read_b128 v[28:31], v87 offset:0
    ds_read_b128 v[32:35], v88 offset:0
    ds_read_b128 v[36:39], v86 offset:3200
    ds_read_b128 v[40:43], v87 offset:3200
    ds_read_b128 v[44:47], v88 offset:3200
    s_mov_b32 s64, 0
    s_waitcnt lgkmcnt(5)
    buffer_store_dwordx4 v[24:27], v89, s[16:19], s64 offen sc1
    s_mov_b32 s64, 0
    s_waitcnt lgkmcnt(4)
    buffer_store_dwordx4 v[28:31], v90, s[16:19], s64 offen sc1
    s_mov_b32 s64, 0
    s_waitcnt lgkmcnt(3)
    buffer_store_dwordx4 v[32:35], v91, s[16:19], s64 offen sc1
    s_mov_b32 s64, 40960
    s_waitcnt lgkmcnt(2)
    buffer_store_dwordx4 v[36:39], v89, s[16:19], s64 offen sc1
    s_mov_b32 s64, 40960
    s_waitcnt lgkmcnt(1)
    buffer_store_dwordx4 v[40:43], v90, s[16:19], s64 offen sc1
    s_mov_b32 s64, 40960
    s_waitcnt lgkmcnt(0)
    buffer_store_dwordx4 v[44:47], v91, s[16:19], s64 offen sc1
    s_barrier
    s_lshr_b32 s99, s20, 2
    s_lshl_b32 s99, s99, 6
    s_and_b32 s66, s20, 3
    s_lshl_b32 s66, s66, 3
    s_add_u32 s66, s66, s99
    s_add_u32 s66, s66, 32
    v_mul_u32_u24 v5, 2731, v1
    v_lshrrev_b32 v5, 16, v5
    v_mul_u32_u24 v6, 24, v5
    v_sub_u32 v4, v1, v6
    v_add_u32 v92, s66, v5
    v_mul_u32_u24 v6, 400, v92
    v_lshl_add_u32 v86, v4, 4, v6
    v_mul_u32_u24 v6, 5120, v92
    v_lshl_add_u32 v6, v4, 4, v6
    v_add_u32 v89, s27, v6
    v_add_u32 v4, 64, v1
    v_mul_u32_u24 v5, 2731, v4
    v_lshrrev_b32 v5, 16, v5
    v_mul_u32_u24 v6, 24, v5
    v_sub_u32 v4, v4, v6
    v_add_u32 v93, s66, v5
    v_mul_u32_u24 v6, 400, v93
    v_lshl_add_u32 v87, v4, 4, v6
    v_mul_u32_u24 v6, 5120, v93
    v_lshl_add_u32 v6, v4, 4, v6
    v_add_u32 v90, s27, v6
    v_add_u32 v4, 128, v1
    v_mul_u32_u24 v5, 2731, v4
    v_lshrrev_b32 v5, 16, v5
    v_mul_u32_u24 v6, 24, v5
    v_sub_u32 v4, v4, v6
    v_add_u32 v94, s66, v5
    v_mul_u32_u24 v6, 400, v94
    v_lshl_add_u32 v88, v4, 4, v6
    v_mul_u32_u24 v6, 5120, v94
    v_lshl_add_u32 v6, v4, 4, v6
    v_add_u32 v91, s27, v6
    ds_read_b128 v[24:27], v86 offset:0
    ds_read_b128 v[28:31], v87 offset:0
    ds_read_b128 v[32:35], v88 offset:0
    v_add_u32 v4, 0, v92
    v_cmp_gt_u32 vcc, 125, v4
    v_mov_b32 v5, 0x80000000
    v_add_u32 v6, 0, v89
    v_cndmask_b32 v6, v5, v6, vcc
    s_waitcnt lgkmcnt(2)
    buffer_store_dwordx4 v[24:27], v6, s[16:19], 0 offen sc1
    v_add_u32 v4, 0, v93
    v_cmp_gt_u32 vcc, 125, v4
    v_mov_b32 v5, 0x80000000
    v_add_u32 v6, 0, v90
    v_cndmask_b32 v6, v5, v6, vcc
    s_waitcnt lgkmcnt(1)
    buffer_store_dwordx4 v[28:31], v6, s[16:19], 0 offen sc1
    v_add_u32 v4, 0, v94
    v_cmp_gt_u32 vcc, 125, v4
    v_mov_b32 v5, 0x80000000
    v_add_u32 v6, 0, v91
    v_cndmask_b32 v6, v5, v6, vcc
    s_waitcnt lgkmcnt(0)
    buffer_store_dwordx4 v[32:35], v6, s[16:19], 0 offen sc1
    s_endpgm
k1_typeB:
    s_mul_i32 s26, s21, 125
    s_mul_i32 s27, s26, 5120
    s_mul_i32 s99, s22, 256
    s_add_u32 s27, s27, s99
    s_add_u32 s27, s27, 3072
    s_and_b32 s25, s20, 3
    s_cmp_ge_u32 s20, 4
    s_cbranch_scc1 k1B_loader
    v_and_b32 v1, 63, v0
    s_and_b32 s60, s20, 1
    s_lshr_b32 s61, s20, 1
    s_mul_i32 s62, s60, 2
    v_bfe_u32 v4, v1, 2, 2
    v_lshrrev_b32 v5, 5, v1
    v_lshl_add_u32 v4, v5, 3, v4
    v_and_b32 v5, 3, v4
    v_mul_u32_u24 v4, 256, v4
    v_bfe_u32 v6, v1, 4, 1
    v_lshl_add_u32 v4, v6, 5, v4
    v_and_b32 v6, 3, v1
    v_lshl_add_u32 v4, v6, 3, v4
    s_add_u32 s99, s62, 0
    v_xor_b32 v7, s99, v5
    v_lshl_add_u32 v7, v7, 6, v4
    v_add_u32 v12, 0, v7
    v_add_u32 v14, 32768, v7
    v_add_u32 v16, 65536, v7
    v_add_u32 v18, 98304, v7
    s_add_u32 s99, s62, 1
    v_xor_b32 v7, s99, v5
    v_lshl_add_u32 v7, v7, 6, v4
    v_add_u32 v13, 0, v7
    v_add_u32 v15, 32768, v7
    v_add_u32 v17, 65536, v7
    v_add_u32 v19, 98304, v7
    v_and_b32 v4, 31, v1
    s_lshl_b32 s99, s61, 6
    v_add_u32 v148, s99, v4
    v_bfe_u32 v4, v148, 1, 3
    v_lshrrev_b32 v5, 5, v1
    v_xor_b32 v4, v4, v5
    v_lshlrev_b32 v4, 4, v4
    v_lshl_add_u32 v4, v148, 7, v4
    v_add_u32 v20, 16384, v4
    v_add_u32 v24, 49152, v4
    v_add_u32 v28, 81920, v4
    v_add_u32 v32, 114688, v4
    v_xor_b32 v5, 32, v4
    v_add_u32 v21, 16384, v5
    v_add_u32 v25, 49152, v5
    v_add_u32 v29, 81920, v5
    v_add_u32 v33, 114688, v5
    v_xor_b32 v5, 64, v4
    v_add_u32 v22, 16384, v5
    v_add_u32 v26, 49152, v5
    v_add_u32 v30, 81920, v5
    v_add_u32 v34, 114688, v5
    v_xor_b32 v5, 96, v4
    v_add_u32 v23, 16384, v5
    v_add_u32 v27, 49152, v5
    v_add_u32 v31, 81920, v5
    v_add_u32 v35, 114688, v5
    v_lshrrev_b32 v172, 2, v0
    v_and_b32 v173, 3, v0
    v_bfe_u32 v174, v172, 1, 1
    v_lshlrev_b32 v173, 1, v173
    v_xor_b32 v173, v173, v174
    v_lshlrev_b32 v172, 7, v172
    v_lshl_add_u32 v172, v173, 4, v172
    v_add_u32 v149, 16384, v172
    v_xor_b32 v150, 16, v172
    v_add_u32 v150, 16384, v150
    v_mov_b32 v152, 0
    v_mov_b32 v153, 0
    v_mov_b32 v154, 0
    v_mov_b32 v155, 0
    v_lshrrev_b32 v4, 5, v1
    v_lshlrev_b32 v178, 4, v4
    s_mul_i32 s99, s60, 256
    s_add_u32 s99, s99, 131072
    v_add_u32 v178, s99, v178
    v_lshlrev_b32 v179, 3, v148
    v_add_u32 v179, 131840, v179
    v_mul_u32_u24 v180, 272, v148
    v_lshl_add_u32 v180, v4, 3, v180
    s_mul_i32 s99, s60, 128
    v_add_u32 v180, s99, v180
    s_mov_b32 s66, 1065353216
    s_mov_b32 s67, 1065353216
    v_mov_b32 v182, 3184710632
    v_mov_b32 v183, 3184710632
    v_mov_b32 v184, 3222493025
    v_mov_b32 v185, 3222493025
    v_mov_b32 v186, 0
    v_mov_b32 v187, 0
    v_mov_b32 v188, 0
    v_mov_b32 v189, 0
    v_mov_b32 v190, 0
    v_mov_b32 v191, 0
    v_mov_b32 v192, 0
    v_mov_b32 v193, 0
    s_waitcnt lgkmcnt(0)
    s_mov_b32 s30, s42
    s_mov_b32 s31, s43
    s_mov_b32 s16, s30
    s_mov_b32 s17, s31
    s_mov_b32 s18, 10240000
    s_mov_b32 s19, 0x20000
    s_add_u32 s52, s30, 10485760
    s_addc_u32 s53, s31, 0
    s_mov_b32 s54, 131072
    s_mov_b32 s55, 0x20000
    s_barrier
    ds_read_b128 v[108:111], v20 offset:0
    ds_read_b128 v[112:115], v20 offset:4096
    ds_read_b64_tr_b16 v[100:101], v12 offset:0
    ds_read_b64_tr_b16 v[102:103], v12 offset:1024
    ds_read_b64_tr_b16 v[104:105], v13 offset:0
    ds_read_b64_tr_b16 v[106:107], v13 offset:1024
    ds_read_b128 v[124:127], v21 offset:0
    ds_read_b128 v[128:131], v21 offset:4096
    ds_read_b64_tr_b16 v[116:117], v12 offset:4096
    ds_read_b64_tr_b16 v[118:119], v12 offset:5120
    ds_read_b64_tr_b16 v[120:121], v13 offset:4096
    ds_read_b64_tr_b16 v[122:123], v13 offset:5120
    s_waitcnt lgkmcnt(6)
    v_mfma_f32_32x32x16_bf16 v[36:51], v[100:103], v[108:111], 0
    ds_read_b128 v[140:143], v22 offset:0
    ds_read_b128 v[144:147], v22 offset:4096
    ds_read_b64_tr_b16 v[132:133], v12 offset:8192
    ds_read_b128 v[156:159], v149 offset:0
    v_mfma_f32_32x32x16_bf16 v[52:67], v[100:103], v[112:115], 0
    ds_read_b64_tr_b16 v[134:135], v12 offset:9216
    ds_read_b64_tr_b16 v[136:137], v13 offset:8192
    ds_read_b64_tr_b16 v[138:139], v13 offset:9216
    ds_read_b128 v[160:163], v150 offset:0
    v_mfma_f32_32x32x16_bf16 v[68:83], v[104:107], v[108:111], 0
    v_mfma_f32_32x32x16_bf16 v[84:99], v[104:107], v[112:115], 0
    s_waitcnt lgkmcnt(0)
    v_mfma_f32_32x32x16_bf16 v[36:51], v[116:119], v[124:127], v[36:51]
    ds_read_b128 v[108:111], v23 offset:0
    ds_read_b128 v[112:115], v23 offset:4096
    ds_read_b64_tr_b16 v[100:101], v12 offset:12288
    v_lshlrev_b32 v164, 16, v156
    v_and_b32 v165, 0xffff0000, v156
    v_lshlrev_b32 v166, 16, v157
    v_and_b32 v167, 0xffff0000, v157
    v_mfma_f32_32x32x16_bf16 v[52:67], v[116:119], v[128:131], v[52:67]
    ds_read_b64_tr_b16 v[102:103], v12 offset:13312
    ds_read_b64_tr_b16 v[104:105], v13 offset:12288
    ds_read_b64_tr_b16 v[106:107], v13 offset:13312
    v_lshlrev_b32 v168, 16, v158
    v_and_b32 v169, 0xffff0000, v158
    v_lshlrev_b32 v170, 16, v159
    v_and_b32 v171, 0xffff0000, v159
    v_mfma_f32_32x32x16_bf16 v[68:83], v[120:123], v[124:127], v[68:83]
    v_add_f32 v152, v152, v164
    v_add_f32 v153, v153, v165
    v_fmac_f32 v154, v164, v164
    v_fmac_f32 v155, v165, v165
    v_mfma_f32_32x32x16_bf16 v[84:99], v[120:123], v[128:131], v[84:99]
    v_add_f32 v152, v152, v166
    v_add_f32 v153, v153, v167
    v_fmac_f32 v154, v166, v166
    v_fmac_f32 v155, v167, v167
    s_waitcnt lgkmcnt(0)
    v_mfma_f32_32x32x16_bf16 v[36:51], v[132:135], v[140:143], v[36:51]
    s_barrier
    ds_read_b128 v[124:127], v24 offset:0
    ds_read_b128 v[128:131], v24 offset:4096
    ds_read_b64_tr_b16 v[116:117], v14 offset:0
    v_add_f32 v152, v152, v168
    v_add_f32 v153, v153, v169
    v_fmac_f32 v154, v168, v168
    v_fmac_f32 v155, v169, v169
    v_mfma_f32_32x32x16_bf16 v[52:67], v[132:135], v[144:147], v[52:67]
    ds_read_b64_tr_b16 v[118:119], v14 offset:1024
    ds_read_b64_tr_b16 v[120:121], v15 offset:0
    ds_read_b64_tr_b16 v[122:123], v15 offset:1024
    v_add_f32 v152, v152, v170
    v_add_f32 v153, v153, v171
    v_fmac_f32 v154, v170, v170
    v_fmac_f32 v155, v171, v171
    v_mfma_f32_32x32x16_bf16 v[68:83], v[136:139], v[140:143], v[68:83]
    v_lshlrev_b32 v164, 16, v160
    v_and_b32 v165, 0xffff0000, v160
    v_lshlrev_b32 v166, 16, v161
    v_and_b32 v167, 0xffff0000, v161
    v_mfma_f32_32x32x16_bf16 v[84:99], v[136:139], v[144:147], v[84:99]
    v_lshlrev_b32 v168, 16, v162
    v_and_b32 v169, 0xffff0000, v162
    v_lshlrev_b32 v170, 16, v163
    v_and_b32 v171, 0xffff0000, v163
    s_waitcnt lgkmcnt(6)
    v_mfma_f32_32x32x16_bf16 v[36:51], v[100:103], v[108:111], v[36:51]
    ds_read_b128 v[140:143], v25 offset:0
    ds_read_b128 v[144:147], v25 offset:4096
    ds_read_b64_tr_b16 v[132:133], v14 offset:4096
    v_add_f32 v152, v152, v164
    v_add_f32 v153, v153, v165
    v_fmac_f32 v154, v164, v164
    v_fmac_f32 v155, v165, v165
    v_mfma_f32_32x32x16_bf16 v[52:67], v[100:103], v[112:115], v[52:67]
    ds_read_b64_tr_b16 v[134:135], v14 offset:5120
    ds_read_b64_tr_b16 v[136:137], v15 offset:4096
    ds_read_b64_tr_b16 v[138:139], v15 offset:5120
    v_add_f32 v152, v152, v166
    v_add_f32 v153, v153, v167
    v_fmac_f32 v154, v166, v166
    v_fmac_f32 v155, v167, v167
    v_mfma_f32_32x32x16_bf16 v[68:83], v[104:107], v[108:111], v[68:83]
    v_add_f32 v152, v152, v168
    v_add_f32 v153, v153, v169
    v_fmac_f32 v154, v168, v168
    v_fmac_f32 v155, v169, v169
    v_mfma_f32_32x32x16_bf16 v[84:99], v[104:107], v[112:115], v[84:99]
    v_add_f32 v152, v152, v170
    v_add_f32 v153, v153, v171
    v_fmac_f32 v154, v170, v170
    v_fmac_f32 v155, v171, v171
    s_waitcnt lgkmcnt(6)
    v_mfma_f32_32x32x16_bf16 v[36:51], v[116:119], v[124:127], v[36:51]
    ds_read_b128 v[108:111], v26 offset:0
    ds_read_b128 v[112:115], v26 offset:4096
    ds_read_b64_tr_b16 v[100:101], v14 offset:8192
    v_add_u32 v172, 32768, v149
    ds_read_b128 v[156:159], v172
    v_mfma_f32_32x32x16_bf16 v[52:67], v[116:119], v[128:131], v[52:67]
    ds_read_b64_tr_b16 v[102:103], v14 offset:9216
    ds_read_b64_tr_b16 v[104:105], v15 offset:8192
    ds_read_b64_tr_b16 v[106:107], v15 offset:9216
    v_add_u32 v172, 32768, v150
    ds_read_b128 v[160:163], v172
    v_mfma_f32_32x32x16_bf16 v[68:83], v[120:123], v[124:127], v[68:83]
    v_mfma_f32_32x32x16_bf16 v[84:99], v[120:123], v[128:131], v[84:99]
    s_waitcnt lgkmcnt(0)
    v_mfma_f32_32x32x16_bf16 v[36:51], v[132:135], v[140:143], v[36:51]
    ds_read_b128 v[124:127], v27 offset:0
    ds_read_b128 v[128:131], v27 offset:4096
    ds_read_b64_tr_b16 v[116:117], v14 offset:12288
    v_lshlrev_b32 v164, 16, v156
    v_and_b32 v165, 0xffff0000, v156
    v_lshlrev_b32 v166, 16, v157
    v_and_b32 v167, 0xffff0000, v157
    v_mfma_f32_32x32x16_bf16 v[52:67], v[132:135], v[144:147], v[52:67]
    ds_read_b64_tr_b16 v[118:119], v14 offset:13312
    ds_read_b64_tr_b16 v[120:121], v15 offset:12288
    ds_read_b64_tr_b16 v[122:123], v15 offset:13312
    v_lshlrev_b32 v168, 16, v158
    v_and_b32 v169, 0xffff0000, v158
    v_lshlrev_b32 v170, 16, v159
    v_and_b32 v171, 0xffff0000, v159
    v_mfma_f32_32x32x16_bf16 v[68:83], v[136:139], v[140:143], v[68:83]
    v_add_f32 v152, v152, v164
    v_add_f32 v153, v153, v165
    v_fmac_f32 v154, v164, v164
    v_fmac_f32 v155, v165, v165
    v_mfma_f32_32x32x16_bf16 v[84:99], v[136:139], v[144:147], v[84:99]
    v_add_f32 v152, v152, v166
    v_add_f32 v153, v153, v167
    v_fmac_f32 v154, v166, v166
    v_fmac_f32 v155, v167, v167
    s_waitcnt lgkmcnt(0)
    v_mfma_f32_32x32x16_bf16 v[36:51], v[100:103], v[108:111], v[36:51]
    s_barrier
    ds_read_b128 v[140:143], v28 offset:0
    ds_read_b128 v[144:147], v28 offset:4096
    ds_read_b64_tr_b16 v[132:133], v16 offset:0
    v_add_f32 v152, v152, v168
    v_add_f32 v153, v153, v169
    v_fmac_f32 v154, v168, v168
    v_fmac_f32 v155, v169, v169
    v_mfma_f32_32x32x16_bf16 v[52:67], v[100:103], v[112:115], v[52:67]
    ds_read_b64_tr_b16 v[134:135], v16 offset:1024
    ds_read_b64_tr_b16 v[136:137], v17 offset:0
    ds_read_b64_tr_b16 v[138:139], v17 offset:1024
    v_add_f32 v152, v152, v170
    v_add_f32 v153, v153, v171
    v_fmac_f32 v154, v170, v170
    v_fmac_f32 v155, v171, v171
    v_mfma_f32_32x32x16_bf16 v[68:83], v[104:107], v[108:111], v[68:83]
    v_lshlrev_b32 v164, 16, v160
    v_and_b32 v165, 0xffff0000, v160
    v_lshlrev_b32 v166, 16, v161
    v_and_b32 v167, 0xffff0000, v161
    v_mfma_f32_32x32x16_bf16 v[84:99], v[104:107], v[112:115], v[84:99]
    v_lshlrev_b32 v168, 16, v162
    v_and_b32 v169, 0xffff0000, v162
    v_lshlrev_b32 v170, 16, v163
    v_and_b32 v171, 0xffff0000, v163
    s_waitcnt lgkmcnt(6)
    v_mfma_f32_32x32x16_bf16 v[36:51], v[116:119], v[124:127], v[36:51]
    ds_read_b128 v[108:111], v29 offset:0
    ds_read_b128 v[112:115], v29 offset:4096
    ds_read_b64_tr_b16 v[100:101], v16 offset:4096
    v_add_f32 v152, v152, v164
    v_add_f32 v153, v153, v165
    v_fmac_f32 v154, v164, v164
    v_fmac_f32 v155, v165, v165
    v_mfma_f32_32x32x16_bf16 v[52:67], v[116:119], v[128:131], v[52:67]
    ds_read_b64_tr_b16 v[102:103], v16 offset:5120
    ds_read_b64_tr_b16 v[104:105], v17 offset:4096
    ds_read_b64_tr_b16 v[106:107], v17 offset:5120
    v_add_f32 v152, v152, v166
    v_add_f32 v153, v153, v167
    v_fmac_f32 v154, v166, v166
    v_fmac_f32 v155, v167, v167
    v_mfma_f32_32x32x16_bf16 v[68:83], v[120:123], v[124:127], v[68:83]
    v_add_f32 v152, v152, v168
    v_add_f32 v153, v153, v169
    v_fmac_f32 v154, v168, v168
    v_fmac_f32 v155, v169, v169
    v_mfma_f32_32x32x16_bf16 v[84:99], v[120:123], v[128:131], v[84:99]
    v_add_f32 v152, v152, v170
    v_add_f32 v153, v153, v171
    v_fmac_f32 v154, v170, v170
    v_fmac_f32 v155, v171, v171
    s_waitcnt lgkmcnt(6)
    v_mfma_f32_32x32x16_bf16 v[36:51], v[132:135], v[140:143], v[36:51]
    ds_read_b128 v[124:127], v30 offset:0
    ds_read_b128 v[128:131], v30 offset:4096
    ds_read_b64_tr_b16 v[116:117], v16 offset:8192
    v_add_u32 v172, 65536, v149
    ds_read_b128 v[156:159], v172
    v_mfma_f32_32x32x16_bf16 v[52:67], v[132:135], v[144:147], v[52:67]
    ds_read_b64_tr_b16 v[118:119], v16 offset:9216
    ds_read_b64_tr_b16 v[120:121], v17 offset:8192
    ds_read_b64_tr_b16 v[122:123], v17 offset:9216
    v_add_u32 v172, 65536, v150
    ds_read_b128 v[160:163], v172
    v_mfma_f32_32x32x16_bf16 v[68:83], v[136:139], v[140:143], v[68:83]
    v_mfma_f32_32x32x16_bf16 v[84:99], v[136:139], v[144:147], v[84:99]
    s_waitcnt lgkmcnt(0)
    v_mfma_f32_32x32x16_bf16 v[36:51], v[100:103], v[108:111], v[36:51]
    ds_read_b128 v[140:143], v31 offset:0
    ds_read_b128 v[144:147], v31 offset:4096
    ds_read_b64_tr_b16 v[132:133], v16 offset:12288
    v_lshlrev_b32 v164, 16, v156
    v_and_b32 v165, 0xffff0000, v156
    v_lshlrev_b32 v166, 16, v157
    v_and_b32 v167, 0xffff0000, v157
    v_mfma_f32_32x32x16_bf16 v[52:67], v[100:103], v[112:115], v[52:67]
    ds_read_b64_tr_b16 v[134:135], v16 offset:13312
    ds_read_b64_tr_b16 v[136:137], v17 offset:12288
    ds_read_b64_tr_b16 v[138:139], v17 offset:13312
    v_lshlrev_b32 v168, 16, v158
    v_and_b32 v169, 0xffff0000, v158
    v_lshlrev_b32 v170, 16, v159
    v_and_b32 v171, 0xffff0000, v159
    v_mfma_f32_32x32x16_bf16 v[68:83], v[104:107], v[108:111], v[68:83]
    v_add_f32 v152, v152, v164
    v_add_f32 v153, v153, v165
    v_fmac_f32 v154, v164, v164
    v_fmac_f32 v155, v165, v165
    v_mfma_f32_32x32x16_bf16 v[84:99], v[104:107], v[112:115], v[84:99]
    v_add_f32 v152, v152, v166
    v_add_f32 v153, v153, v167
    v_fmac_f32 v154, v166, v166
    v_fmac_f32 v155, v167, v167
    s_waitcnt lgkmcnt(0)
    v_mfma_f32_32x32x16_bf16 v[36:51], v[116:119], v[124:127], v[36:51]
    s_barrier
    ds_read_b128 v[108:111], v32 offset:0
    ds_read_b128 v[112:115], v32 offset:4096
    ds_read_b64_tr_b16 v[100:101], v18 offset:0
    v_add_f32 v152, v152, v168
    v_add_f32 v153, v153, v169
    v_fmac_f32 v154, v168, v168
    v_fmac_f32 v155, v169, v169
    v_mfma_f32_32x32x16_bf16 v[52:67], v[116:119], v[128:131], v[52:67]
    ds_read_b64_tr_b16 v[102:103], v18 offset:1024
    ds_read_b64_tr_b16 v[104:105], v19 offset:0
    ds_read_b64_tr_b16 v[106:107], v19 offset:1024
    v_add_f32 v152, v152, v170
    v_add_f32 v153, v153, v171
    v_fmac_f32 v154, v170, v170
    v_fmac_f32 v155, v171, v171
    v_mfma_f32_32x32x16_bf16 v[68:83], v[120:123], v[124:127], v[68:83]
    v_lshlrev_b32 v164, 16, v160
    v_and_b32 v165, 0xffff0000, v160
    v_lshlrev_b32 v166, 16, v161
    v_and_b32 v167, 0xffff0000, v161
    v_mfma_f32_32x32x16_bf16 v[84:99], v[120:123], v[128:131], v[84:99]
    v_lshlrev_b32 v168, 16, v162
    v_and_b32 v169, 0xffff0000, v162
    v_lshlrev_b32 v170, 16, v163
    v_and_b32 v171, 0xffff0000, v163
    s_waitcnt lgkmcnt(6)
    v_mfma_f32_32x32x16_bf16 v[36:51], v[132:135], v[140:143], v[36:51]
    ds_read_b128 v[124:127], v33 offset:0
    ds_read_b128 v[128:131], v33 offset:4096
    ds_read_b64_tr_b16 v[116:117], v18 offset:4096
    v_add_f32 v152, v152, v164
    v_add_f32 v153, v153, v165
    v_fmac_f32 v154, v164, v164
    v_fmac_f32 v155, v165, v165
    v_mfma_f32_32x32x16_bf16 v[52:67], v[132:135], v[144:147], v[52:67]
    ds_read_b64_tr_b16 v[118:119], v18 offset:5120
    ds_read_b64_tr_b16 v[120:121], v19 offset:4096
    ds_read_b64_tr_b16 v[122:123], v19 offset:5120
    v_add_f32 v152, v152, v166
    v_add_f32 v153, v153, v167
    v_fmac_f32 v154, v166, v166
    v_fmac_f32 v155, v167, v167
    v_mfma_f32_32x32x16_bf16 v[68:83], v[136:139], v[140:143], v[68:83]
    v_add_f32 v152, v152, v168
    v_add_f32 v153, v153, v169
    v_fmac_f32 v154, v168, v168
    v_fmac_f32 v155, v169, v169
    v_mfma_f32_32x32x16_bf16 v[84:99], v[136:139], v[144:147], v[84:99]
    v_add_f32 v152, v152, v170
    v_add_f32 v153, v153, v171
    v_fmac_f32 v154, v170, v170
    v_fmac_f32 v155, v171, v171
    s_waitcnt lgkmcnt(6)
    v_mfma_f32_32x32x16_bf16 v[36:51], v[100:103], v[108:111], v[36:51]
    ds_read_b128 v[140:143], v34 offset:0
    ds_read_b128 v[144:147], v34 offset:4096
    ds_read_b64_tr_b16 v[132:133], v18 offset:8192
    v_add_u32 v172, 98304, v149
    ds_read_b128 v[156:159], v172
    v_mfma_f32_32x32x16_bf16 v[52:67], v[100:103], v[112:115], v[52:67]
    ds_read_b64_tr_b16 v[134:135], v18 offset:9216
    ds_read_b64_tr_b16 v[136:137], v19 offset:8192
    ds_read_b64_tr_b16 v[138:139], v19 offset:9216
    v_add_u32 v172, 98304, v150
    ds_read_b128 v[160:163], v172
    v_mfma_f32_32x32x16_bf16 v[68:83], v[104:107], v[108:111], v[68:83]
    v_mfma_f32_32x32x16_bf16 v[84:99], v[104:107], v[112:115], v[84:99]
    s_waitcnt lgkmcnt(0)
    v_mfma_f32_32x32x16_bf16 v[36:51], v[116:119], v[124:127], v[36:51]
    ds_read_b128 v[108:111], v35 offset:0
    ds_read_b128 v[112:115], v35 offset:4096
    ds_read_b64_tr_b16 v[100:101], v18 offset:12288
    v_lshlrev_b32 v164, 16, v156
    v_and_b32 v165, 0xffff0000, v156
    v_lshlrev_b32 v166, 16, v157
    v_and_b32 v167, 0xffff0000, v157
    v_mfma_f32_32x32x16_bf16 v[52:67], v[116:119], v[128:131], v[52:67]
    ds_read_b64_tr_b16 v[102:103], v18 offset:13312
    ds_read_b64_tr_b16 v[104:105], v19 offset:12288
    ds_read_b64_tr_b16 v[106:107], v19 offset:13312
    v_lshlrev_b32 v168, 16, v158
    v_and_b32 v169, 0xffff0000, v158
    v_lshlrev_b32 v170, 16, v159
    v_and_b32 v171, 0xffff0000, v159
    v_mfma_f32_32x32x16_bf16 v[68:83], v[120:123], v[124:127], v[68:83]
    v_add_f32 v152, v152, v164
    v_add_f32 v153, v153, v165
    v_fmac_f32 v154, v164, v164
    v_fmac_f32 v155, v165, v165
    v_mfma_f32_32x32x16_bf16 v[84:99], v[120:123], v[128:131], v[84:99]
    v_add_f32 v152, v152, v166
    v_add_f32 v153, v153, v167
    v_fmac_f32 v154, v166, v166
    v_fmac_f32 v155, v167, v167
    s_waitcnt lgkmcnt(0)
    v_mfma_f32_32x32x16_bf16 v[36:51], v[132:135], v[140:143], v[36:51]
    s_barrier
    ds_read_b128 v[124:127], v20 offset:0
    ds_read_b128 v[128:131], v20 offset:4096
    ds_read_b64_tr_b16 v[116:117], v12 offset:0
    v_add_f32 v152, v152, v168
    v_add_f32 v153, v153, v169
    v_fmac_f32 v154, v168, v168
    v_fmac_f32 v155, v169, v169
    v_mfma_f32_32x32x16_bf16 v[52:67], v[132:135], v[144:147], v[52:67]
    ds_read_b64_tr_b16 v[118:119], v12 offset:1024
    ds_read_b64_tr_b16 v[120:121], v13 offset:0
    ds_read_b64_tr_b16 v[122:123], v13 offset:1024
    v_add_f32 v152, v152, v170
    v_add_f32 v153, v153, v171
    v_fmac_f32 v154, v170, v170
    v_fmac_f32 v155, v171, v171
    v_mfma_f32_32x32x16_bf16 v[68:83], v[136:139], v[140:143], v[68:83]
    v_lshlrev_b32 v164, 16, v160
    v_and_b32 v165, 0xffff0000, v160
    v_lshlrev_b32 v166, 16, v161
    v_and_b32 v167, 0xffff0000, v161
    v_mfma_f32_32x32x16_bf16 v[84:99], v[136:139], v[144:147], v[84:99]
    v_lshlrev_b32 v168, 16, v162
    v_and_b32 v169, 0xffff0000, v162
    v_lshlrev_b32 v170, 16, v163
    v_and_b32 v171, 0xffff0000, v163
    s_waitcnt lgkmcnt(6)
    v_mfma_f32_32x32x16_bf16 v[36:51], v[100:103], v[108:111], v[36:51]
    ds_read_b128 v[140:143], v21 offset:0
    ds_read_b128 v[144:147], v21 offset:4096
    ds_read_b64_tr_b16 v[132:133], v12 offset:4096
    v_add_f32 v152, v152, v164
    v_add_f32 v153, v153, v165
    v_fmac_f32 v154, v164, v164
    v_fmac_f32 v155, v165, v165
    v_mfma_f32_32x32x16_bf16 v[52:67], v[100:103], v[112:115], v[52:67]
    ds_read_b64_tr_b16 v[134:135], v12 offset:5120
    ds_read_b64_tr_b16 v[136:137], v13 offset:4096
    ds_read_b64_tr_b16 v[138:139], v13 offset:5120
    v_add_f32 v152, v152, v166
    v_add_f32 v153, v153, v167
    v_fmac_f32 v154, v166, v166
    v_fmac_f32 v155, v167, v167
    v_mfma_f32_32x32x16_bf16 v[68:83], v[104:107], v[108:111], v[68:83]
    v_add_f32 v152, v152, v168
    v_add_f32 v153, v153, v169
    v_fmac_f32 v154, v168, v168
    v_fmac_f32 v155, v169, v169
    v_mfma_f32_32x32x16_bf16 v[84:99], v[104:107], v[112:115], v[84:99]
    v_add_f32 v152, v152, v170
    v_add_f32 v153, v153, v171
    v_fmac_f32 v154, v170, v170
    v_fmac_f32 v155, v171, v171
    s_waitcnt lgkmcnt(6)
    v_mfma_f32_32x32x16_bf16 v[36:51], v[116:119], v[124:127], v[36:51]
    ds_read_b128 v[108:111], v22 offset:0
    ds_read_b128 v[112:115], v22 offset:4096
    ds_read_b64_tr_b16 v[100:101], v12 offset:8192
    ds_read_b128 v[156:159], v149 offset:0
    v_mfma_f32_32x32x16_bf16 v[52:67], v[116:119], v[128:131], v[52:67]
    ds_read_b64_tr_b16 v[102:103], v12 offset:9216
    ds_read_b64_tr_b16 v[104:105], v13 offset:8192
    ds_read_b64_tr_b16 v[106:107], v13 offset:9216
    ds_read_b128 v[160:163], v150 offset:0
    v_mfma_f32_32x32x16_bf16 v[68:83], v[120:123], v[124:127], v[68:83]
    v_mfma_f32_32x32x16_bf16 v[84:99], v[120:123], v[128:131], v[84:99]
    s_waitcnt lgkmcnt(0)
    v_mfma_f32_32x32x16_bf16 v[36:51], v[132:135], v[140:143], v[36:51]
    ds_read_b128 v[124:127], v23 offset:0
    ds_read_b128 v[128:131], v23 offset:4096
    ds_read_b64_tr_b16 v[116:117], v12 offset:12288
    v_lshlrev_b32 v164, 16, v156
    v_and_b32 v165, 0xffff0000, v156
    v_lshlrev_b32 v166, 16, v157
    v_and_b32 v167, 0xffff0000, v157
    v_mfma_f32_32x32x16_bf16 v[52:67], v[132:135], v[144:147], v[52:67]
    ds_read_b64_tr_b16 v[118:119], v12 offset:13312
    ds_read_b64_tr_b16 v[120:121], v13 offset:12288
    ds_read_b64_tr_b16 v[122:123], v13 offset:13312
    v_lshlrev_b32 v168, 16, v158
    v_and_b32 v169, 0xffff0000, v158
    v_lshlrev_b32 v170, 16, v159
    v_and_b32 v171, 0xffff0000, v159
    v_mfma_f32_32x32x16_bf16 v[68:83], v[136:139], v[140:143], v[68:83]
    v_add_f32 v152, v152, v164
    v_add_f32 v153, v153, v165
    v_fmac_f32 v154, v164, v164
    v_fmac_f32 v155, v165, v165
    v_mfma_f32_32x32x16_bf16 v[84:99], v[136:139], v[144:147], v[84:99]
    v_add_f32 v152, v152, v166
    v_add_f32 v153, v153, v167
    v_fmac_f32 v154, v166, v166
    v_fmac_f32 v155, v167, v167
    s_waitcnt lgkmcnt(0)
    v_mfma_f32_32x32x16_bf16 v[36:51], v[100:103], v[108:111], v[36:51]
    s_barrier
    ds_read_b128 v[140:143], v24 offset:0
    ds_read_b128 v[144:147], v24 offset:4096
    ds_read_b64_tr_b16 v[132:133], v14 offset:0
    v_add_f32 v152, v152, v168
    v_add_f32 v153, v153, v169
    v_fmac_f32 v154, v168, v168
    v_fmac_f32 v155, v169, v169
    v_mfma_f32_32x32x16_bf16 v[52:67], v[100:103], v[112:115], v[52:67]
    ds_read_b64_tr_b16 v[134:135], v14 offset:1024
    ds_read_b64_tr_b16 v[136:137], v15 offset:0
    ds_read_b64_tr_b16 v[138:139], v15 offset:1024
    v_add_f32 v152, v152, v170
    v_add_f32 v153, v153, v171
    v_fmac_f32 v154, v170, v170
    v_fmac_f32 v155, v171, v171
    v_mfma_f32_32x32x16_bf16 v[68:83], v[104:107], v[108:111], v[68:83]
    v_lshlrev_b32 v164, 16, v160
    v_and_b32 v165, 0xffff0000, v160
    v_lshlrev_b32 v166, 16, v161
    v_and_b32 v167, 0xffff0000, v161
    v_mfma_f32_32x32x16_bf16 v[84:99], v[104:107], v[112:115], v[84:99]
    v_lshlrev_b32 v168, 16, v162
    v_and_b32 v169, 0xffff0000, v162
    v_lshlrev_b32 v170, 16, v163
    v_and_b32 v171, 0xffff0000, v163
    s_waitcnt lgkmcnt(6)
    v_mfma_f32_32x32x16_bf16 v[36:51], v[116:119], v[124:127], v[36:51]
    ds_read_b128 v[108:111], v25 offset:0
    ds_read_b128 v[112:115], v25 offset:4096
    ds_read_b64_tr_b16 v[100:101], v14 offset:4096
    v_add_f32 v152, v152, v164
    v_add_f32 v153, v153, v165
    v_fmac_f32 v154, v164, v164
    v_fmac_f32 v155, v165, v165
    v_mfma_f32_32x32x16_bf16 v[52:67], v[116:119], v[128:131], v[52:67]
    ds_read_b64_tr_b16 v[102:103], v14 offset:5120
    ds_read_b64_tr_b16 v[104:105], v15 offset:4096
    ds_read_b64_tr_b16 v[106:107], v15 offset:5120
    v_add_f32 v152, v152, v166
    v_add_f32 v153, v153, v167
    v_fmac_f32 v154, v166, v166
    v_fmac_f32 v155, v167, v167
    v_mfma_f32_32x32x16_bf16 v[68:83], v[120:123], v[124:127], v[68:83]
    v_add_f32 v152, v152, v168
    v_add_f32 v153, v153, v169
    v_fmac_f32 v154, v168, v168
    v_fmac_f32 v155, v169, v169
    v_mfma_f32_32x32x16_bf16 v[84:99], v[120:123], v[128:131], v[84:99]
    v_add_f32 v152, v152, v170
    v_add_f32 v153, v153, v171
    v_fmac_f32 v154, v170, v170
    v_fmac_f32 v155, v171, v171
    s_waitcnt lgkmcnt(6)
    v_mfma_f32_32x32x16_bf16 v[36:51], v[132:135], v[140:143], v[36:51]
    ds_read_b128 v[124:127], v26 offset:0
    ds_read_b128 v[128:131], v26 offset:4096
    ds_read_b64_tr_b16 v[116:117], v14 offset:8192
    v_add_u32 v172, 32768, v149
    ds_read_b128 v[156:159], v172
    v_mfma_f32_32x32x16_bf16 v[52:67], v[132:135], v[144:147], v[52:67]
    ds_read_b64_tr_b16 v[118:119], v14 offset:9216
    ds_read_b64_tr_b16 v[120:121], v15 offset:8192
    ds_read_b64_tr_b16 v[122:123], v15 offset:9216
    v_add_u32 v172, 32768, v150
    ds_read_b128 v[160:163], v172
    v_mfma_f32_32x32x16_bf16 v[68:83], v[136:139], v[140:143], v[68:83]
    v_mfma_f32_32x32x16_bf16 v[84:99], v[136:139], v[144:147], v[84:99]
    s_waitcnt lgkmcnt(0)
    v_mfma_f32_32x32x16_bf16 v[36:51], v[100:103], v[108:111], v[36:51]
    ds_read_b128 v[140:143], v27 offset:0
    ds_read_b128 v[144:147], v27 offset:4096
    ds_read_b64_tr_b16 v[132:133], v14 offset:12288
    v_lshlrev_b32 v164, 16, v156
    v_and_b32 v165, 0xffff0000, v156
    v_lshlrev_b32 v166, 16, v157
    v_and_b32 v167, 0xffff0000, v157
    v_mfma_f32_32x32x16_bf16 v[52:67], v[100:103], v[112:115], v[52:67]
    ds_read_b64_tr_b16 v[134:135], v14 offset:13312
    ds_read_b64_tr_b16 v[136:137], v15 offset:12288
    ds_read_b64_tr_b16 v[138:139], v15 offset:13312
    v_lshlrev_b32 v168, 16, v158
    v_and_b32 v169, 0xffff0000, v158
    v_lshlrev_b32 v170, 16, v159
    v_and_b32 v171, 0xffff0000, v159
    v_mfma_f32_32x32x16_bf16 v[68:83], v[104:107], v[108:111], v[68:83]
    v_add_f32 v152, v152, v164
    v_add_f32 v153, v153, v165
    v_fmac_f32 v154, v164, v164
    v_fmac_f32 v155, v165, v165
    v_mfma_f32_32x32x16_bf16 v[84:99], v[104:107], v[112:115], v[84:99]
    v_add_f32 v152, v152, v166
    v_add_f32 v153, v153, v167
    v_fmac_f32 v154, v166, v166
    v_fmac_f32 v155, v167, v167
    s_waitcnt lgkmcnt(0)
    v_mfma_f32_32x32x16_bf16 v[36:51], v[116:119], v[124:127], v[36:51]
    s_barrier
    ds_read_b128 v[108:111], v28 offset:0
    ds_read_b128 v[112:115], v28 offset:4096
    ds_read_b64_tr_b16 v[100:101], v16 offset:0
    v_add_f32 v152, v152, v168
    v_add_f32 v153, v153, v169
    v_fmac_f32 v154, v168, v168
    v_fmac_f32 v155, v169, v169
    v_mfma_f32_32x32x16_bf16 v[52:67], v[116:119], v[128:131], v[52:67]
    ds_read_b64_tr_b16 v[102:103], v16 offset:1024
    ds_read_b64_tr_b16 v[104:105], v17 offset:0
    ds_read_b64_tr_b16 v[106:107], v17 offset:1024
    v_add_f32 v152, v152, v170
    v_add_f32 v153, v153, v171
    v_fmac_f32 v154, v170, v170
    v_fmac_f32 v155, v171, v171
    v_mfma_f32_32x32x16_bf16 v[68:83], v[120:123], v[124:127], v[68:83]
    v_lshlrev_b32 v164, 16, v160
    v_and_b32 v165, 0xffff0000, v160
    v_lshlrev_b32 v166, 16, v161
    v_and_b32 v167, 0xffff0000, v161
    v_mfma_f32_32x32x16_bf16 v[84:99], v[120:123], v[128:131], v[84:99]
    v_lshlrev_b32 v168, 16, v162
    v_and_b32 v169, 0xffff0000, v162
    v_lshlrev_b32 v170, 16, v163
    v_and_b32 v171, 0xffff0000, v163
    s_waitcnt lgkmcnt(6)
    v_mfma_f32_32x32x16_bf16 v[36:51], v[132:135], v[140:143], v[36:51]
    ds_read_b128 v[124:127], v29 offset:0
    ds_read_b128 v[128:131], v29 offset:4096
    ds_read_b64_tr_b16 v[116:117], v16 offset:4096
    v_add_f32 v152, v152, v164
    v_add_f32 v153, v153, v165
    v_fmac_f32 v154, v164, v164
    v_fmac_f32 v155, v165, v165
    v_mfma_f32_32x32x16_bf16 v[52:67], v[132:135], v[144:147], v[52:67]
    ds_read_b64_tr_b16 v[118:119], v16 offset:5120
    ds_read_b64_tr_b16 v[120:121], v17 offset:4096
    ds_read_b64_tr_b16 v[122:123], v17 offset:5120
    v_add_f32 v152, v152, v166
    v_add_f32 v153, v153, v167
    v_fmac_f32 v154, v166, v166
    v_fmac_f32 v155, v167, v167
    v_mfma_f32_32x32x16_bf16 v[68:83], v[136:139], v[140:143], v[68:83]
    v_add_f32 v152, v152, v168
    v_add_f32 v153, v153, v169
    v_fmac_f32 v154, v168, v168
    v_fmac_f32 v155, v169, v169
    v_mfma_f32_32x32x16_bf16 v[84:99], v[136:139], v[144:147], v[84:99]
    v_add_f32 v152, v152, v170
    v_add_f32 v153, v153, v171
    v_fmac_f32 v154, v170, v170
    v_fmac_f32 v155, v171, v171
    s_waitcnt lgkmcnt(6)
    v_mfma_f32_32x32x16_bf16 v[36:51], v[100:103], v[108:111], v[36:51]
    ds_read_b128 v[140:143], v30 offset:0
    ds_read_b128 v[144:147], v30 offset:4096
    ds_read_b64_tr_b16 v[132:133], v16 offset:8192
    v_add_u32 v172, 65536, v149
    ds_read_b128 v[156:159], v172
    v_mfma_f32_32x32x16_bf16 v[52:67], v[100:103], v[112:115], v[52:67]
    ds_read_b64_tr_b16 v[134:135], v16 offset:9216
    ds_read_b64_tr_b16 v[136:137], v17 offset:8192
    ds_read_b64_tr_b16 v[138:139], v17 offset:9216
    v_add_u32 v172, 65536, v150
    ds_read_b128 v[160:163], v172
    v_mfma_f32_32x32x16_bf16 v[68:83], v[104:107], v[108:111], v[68:83]
    v_mfma_f32_32x32x16_bf16 v[84:99], v[104:107], v[112:115], v[84:99]
    s_waitcnt lgkmcnt(0)
    v_mfma_f32_32x32x16_bf16 v[36:51], v[116:119], v[124:127], v[36:51]
    ds_read_b128 v[108:111], v31 offset:0
    ds_read_b128 v[112:115], v31 offset:4096
    ds_read_b64_tr_b16 v[100:101], v16 offset:12288
    v_lshlrev_b32 v164, 16, v156
    v_and_b32 v165, 0xffff0000, v156
    v_lshlrev_b32 v166, 16, v157
    v_and_b32 v167, 0xffff0000, v157
    v_mfma_f32_32x32x16_bf16 v[52:67], v[116:119], v[128:131], v[52:67]
    ds_read_b64_tr_b16 v[102:103], v16 offset:13312
    ds_read_b64_tr_b16 v[104:105], v17 offset:12288
    ds_read_b64_tr_b16 v[106:107], v17 offset:13312
    v_lshlrev_b32 v168, 16, v158
    v_and_b32 v169, 0xffff0000, v158
    v_lshlrev_b32 v170, 16, v159
    v_and_b32 v171, 0xffff0000, v159
    v_mfma_f32_32x32x16_bf16 v[68:83], v[120:123], v[124:127], v[68:83]
    v_add_f32 v152, v152, v164
    v_add_f32 v153, v153, v165
    v_fmac_f32 v154, v164, v164
    v_fmac_f32 v155, v165, v165
    v_mfma_f32_32x32x16_bf16 v[84:99], v[120:123], v[128:131], v[84:99]
    v_add_f32 v152, v152, v166
    v_add_f32 v153, v153, v167
    v_fmac_f32 v154, v166, v166
    v_fmac_f32 v155, v167, v167
    s_waitcnt lgkmcnt(0)
    v_mfma_f32_32x32x16_bf16 v[36:51], v[132:135], v[140:143], v[36:51]
    s_barrier
    ds_read_b128 v[124:127], v32 offset:0
    ds_read_b128 v[128:131], v32 offset:4096
    ds_read_b64_tr_b16 v[116:117], v18 offset:0
    v_add_f32 v152, v152, v168
    v_add_f32 v153, v153, v169
    v_fmac_f32 v154, v168, v168
    v_fmac_f32 v155, v169, v169
    v_mfma_f32_32x32x16_bf16 v[52:67], v[132:135], v[144:147], v[52:67]
    ds_read_b64_tr_b16 v[118:119], v18 offset:1024
    ds_read_b64_tr_b16 v[120:121], v19 offset:0
    ds_read_b64_tr_b16 v[122:123], v19 offset:1024
    v_add_f32 v152, v152, v170
    v_add_f32 v153, v153, v171
    v_fmac_f32 v154, v170, v170
    v_fmac_f32 v155, v171, v171
    v_mfma_f32_32x32x16_bf16 v[68:83], v[136:139], v[140:143], v[68:83]
    v_lshlrev_b32 v164, 16, v160
    v_and_b32 v165, 0xffff0000, v160
    v_lshlrev_b32 v166, 16, v161
    v_and_b32 v167, 0xffff0000, v161
    v_mfma_f32_32x32x16_bf16 v[84:99], v[136:139], v[144:147], v[84:99]
    v_lshlrev_b32 v168, 16, v162
    v_and_b32 v169, 0xffff0000, v162
    v_lshlrev_b32 v170, 16, v163
    v_and_b32 v171, 0xffff0000, v163
    s_waitcnt lgkmcnt(6)
    v_mfma_f32_32x32x16_bf16 v[36:51], v[100:103], v[108:111], v[36:51]
    ds_read_b128 v[140:143], v33 offset:0
    ds_read_b128 v[144:147], v33 offset:4096
    ds_read_b64_tr_b16 v[132:133], v18 offset:4096
    v_add_f32 v152, v152, v164
    v_add_f32 v153, v153, v165
    v_fmac_f32 v154, v164, v164
    v_fmac_f32 v155, v165, v165
    v_mfma_f32_32x32x16_bf16 v[52:67], v[100:103], v[112:115], v[52:67]
    ds_read_b64_tr_b16 v[134:135], v18 offset:5120
    ds_read_b64_tr_b16 v[136:137], v19 offset:4096
    ds_read_b64_tr_b16 v[138:139], v19 offset:5120
    v_add_f32 v152, v152, v166
    v_add_f32 v153, v153, v167
    v_fmac_f32 v154, v166, v166
    v_fmac_f32 v155, v167, v167
    v_mfma_f32_32x32x16_bf16 v[68:83], v[104:107], v[108:111], v[68:83]
    v_add_f32 v152, v152, v168
    v_add_f32 v153, v153, v169
    v_fmac_f32 v154, v168, v168
    v_fmac_f32 v155, v169, v169
    v_mfma_f32_32x32x16_bf16 v[84:99], v[104:107], v[112:115], v[84:99]
    v_add_f32 v152, v152, v170
    v_add_f32 v153, v153, v171
    v_fmac_f32 v154, v170, v170
    v_fmac_f32 v155, v171, v171
    s_waitcnt lgkmcnt(6)
    v_mfma_f32_32x32x16_bf16 v[36:51], v[116:119], v[124:127], v[36:51]
    ds_read_b128 v[108:111], v34 offset:0
    ds_read_b128 v[112:115], v34 offset:4096
    ds_read_b64_tr_b16 v[100:101], v18 offset:8192
    v_add_u32 v172, 98304, v149
    ds_read_b128 v[156:159], v172
    v_mfma_f32_32x32x16_bf16 v[52:67], v[116:119], v[128:131], v[52:67]
    ds_read_b64_tr_b16 v[102:103], v18 offset:9216
    ds_read_b64_tr_b16 v[104:105], v19 offset:8192
    ds_read_b64_tr_b16 v[106:107], v19 offset:9216
    v_add_u32 v172, 98304, v150
    ds_read_b128 v[160:163], v172
    v_mfma_f32_32x32x16_bf16 v[68:83], v[120:123], v[124:127], v[68:83]
    v_mfma_f32_32x32x16_bf16 v[84:99], v[120:123], v[128:131], v[84:99]
    s_waitcnt lgkmcnt(0)
    v_mfma_f32_32x32x16_bf16 v[36:51], v[132:135], v[140:143], v[36:51]
    ds_read_b128 v[124:127], v35 offset:0
    ds_read_b128 v[128:131], v35 offset:4096
    ds_read_b64_tr_b16 v[116:117], v18 offset:12288
    v_lshlrev_b32 v164, 16, v156
    v_and_b32 v165, 0xffff0000, v156
    v_lshlrev_b32 v166, 16, v157
    v_and_b32 v167, 0xffff0000, v157
    v_mfma_f32_32x32x16_bf16 v[52:67], v[132:135], v[144:147], v[52:67]
    ds_read_b64_tr_b16 v[118:119], v18 offset:13312
    ds_read_b64_tr_b16 v[120:121], v19 offset:12288
    ds_read_b64_tr_b16 v[122:123], v19 offset:13312
    v_lshlrev_b32 v168, 16, v158
    v_and_b32 v169, 0xffff0000, v158
    v_lshlrev_b32 v170, 16, v159
    v_and_b32 v171, 0xffff0000, v159
    v_mfma_f32_32x32x16_bf16 v[68:83], v[136:139], v[140:143], v[68:83]
    v_add_f32 v152, v152, v164
    v_add_f32 v153, v153, v165
    v_fmac_f32 v154, v164, v164
    v_fmac_f32 v155, v165, v165
    v_mfma_f32_32x32x16_bf16 v[84:99], v[136:139], v[144:147], v[84:99]
    v_add_f32 v152, v152, v166
    v_add_f32 v153, v153, v167
    v_fmac_f32 v154, v166, v166
    v_fmac_f32 v155, v167, v167
    s_waitcnt lgkmcnt(0)
    v_mfma_f32_32x32x16_bf16 v[36:51], v[100:103], v[108:111], v[36:51]
    v_add_f32 v152, v152, v168
    v_add_f32 v153, v153, v169
    v_fmac_f32 v154, v168, v168
    v_fmac_f32 v155, v169, v169
    v_mfma_f32_32x32x16_bf16 v[52:67], v[100:103], v[112:115], v[52:67]
    v_add_f32 v152, v152, v170
    v_add_f32 v153, v153, v171
    v_fmac_f32 v154, v170, v170
    v_fmac_f32 v155, v171, v171
    v_mfma_f32_32x32x16_bf16 v[68:83], v[104:107], v[108:111], v[68:83]
    v_lshlrev_b32 v164, 16, v160
    v_and_b32 v165, 0xffff0000, v160
    v_lshlrev_b32 v166, 16, v161
    v_and_b32 v167, 0xffff0000, v161
    v_mfma_f32_32x32x16_bf16 v[84:99], v[104:107], v[112:115], v[84:99]
    v_lshlrev_b32 v168, 16, v162
    v_and_b32 v169, 0xffff0000, v162
    v_lshlrev_b32 v170, 16, v163
    v_and_b32 v171, 0xffff0000, v163
    s_waitcnt lgkmcnt(0)
    v_mfma_f32_32x32x16_bf16 v[36:51], v[116:119], v[124:127], v[36:51]
    v_add_f32 v152, v152, v164
    v_add_f32 v153, v153, v165
    v_fmac_f32 v154, v164, v164
    v_fmac_f32 v155, v165, v165
    v_mfma_f32_32x32x16_bf16 v[52:67], v[116:119], v[128:131], v[52:67]
    v_add_f32 v152, v152, v166
    v_add_f32 v153, v153, v167
    v_fmac_f32 v154, v166, v166
    v_fmac_f32 v155, v167, v167
    v_mfma_f32_32x32x16_bf16 v[68:83], v[120:123], v[124:127], v[68:83]
    v_add_f32 v152, v152, v168
    v_add_f32 v153, v153, v169
    v_fmac_f32 v154, v168, v168
    v_fmac_f32 v155, v169, v169
    v_mfma_f32_32x32x16_bf16 v[84:99], v[120:123], v[128:131], v[84:99]
    v_add_f32 v152, v152, v170
    v_add_f32 v153, v153, v171
    v_fmac_f32 v154, v170, v170
    v_fmac_f32 v155, v171, v171
    v_add_f32 v172, v152, v153
    v_add_f32 v173, v154, v155
    s_nop 1
    v_add_f32_dpp v172, v172, v172 quad_perm:[1,0,3,2] row_mask:0xf bank_mask:0xf
    v_add_f32_dpp v173, v173, v173 quad_perm:[1,0,3,2] row_mask:0xf bank_mask:0xf
    s_nop 1
    v_add_f32_dpp v172, v172, v172 quad_perm:[2,3,0,1] row_mask:0xf bank_mask:0xf
    v_add_f32_dpp v173, v173, v173 quad_perm:[2,3,0,1] row_mask:0xf bank_mask:0xf
    v_mul_f32 v172, 989855744, v172
    v_mul_f32 v173, 989855744, v173
    v_fma_f32 v173, -v172, v172, v173
    v_max_f32 v173, 0, v173
    v_add_f32 v173, 925353388, v173
    v_rsq_f32 v174, v173
    s_nop 0
    v_mul_f32 v175, v172, v174
    v_lshrrev_b32 v176, 2, v0
    v_lshlrev_b32 v176, 3, v176
    v_add_u32 v176, 131840, v176
    ds_write_b64 v176, v[174:175]
    s_nop 7
    s_nop 3
    s_cmp_eq_u32 s61, 1
    s_cbranch_scc0 k1B_nocs
    s_mov_b32 exec_lo, 536870912
    s_mov_b32 exec_hi, 536870912
    ds_write_b128 v178, v[52:55] offset:0
    ds_write_b128 v178, v[56:59] offset:32
    ds_write_b128 v178, v[60:63] offset:64
    ds_write_b128 v178, v[64:67] offset:96
    ds_write_b128 v178, v[84:87] offset:128
    ds_write_b128 v178, v[88:91] offset:160
    ds_write_b128 v178, v[92:95] offset:192
    ds_write_b128 v178, v[96:99] offset:224
    s_mov_b64 exec, -1
k1B_nocs:
    s_waitcnt lgkmcnt(0)
    s_barrier
    ds_read_b64 v[194:195], v179 offset:0
    ds_read_b64 v[196:197], v179 offset:256
    ds_read_b128 v[100:103], v178 offset:0
    ds_read_b128 v[104:107], v178 offset:32
    ds_read_b128 v[108:111], v178 offset:64
    ds_read_b128 v[112:115], v178 offset:96
    ds_read_b128 v[116:119], v178 offset:128
    ds_read_b128 v[120:123], v178 offset:160
    ds_read_b128 v[124:127], v178 offset:192
    ds_read_b128 v[128:131], v178 offset:224
    s_waitcnt lgkmcnt(0)
    v_pk_mul_f32 v[198:199], v[100:101], v[194:195] op_sel:[0,1] op_sel_hi:[1,1]
    v_pk_mul_f32 v[200:201], v[102:103], v[194:195] op_sel:[0,1] op_sel_hi:[1,1]
    v_pk_mul_f32 v[202:203], v[104:105], v[194:195] op_sel:[0,1] op_sel_hi:[1,1]
    v_pk_mul_f32 v[204:205], v[106:107], v[194:195] op_sel:[0,1] op_sel_hi:[1,1]
    v_pk_mul_f32 v[206:207], v[108:109], v[194:195] op_sel:[0,1] op_sel_hi:[1,1]
    v_pk_mul_f32 v[208:209], v[110:111], v[194:195] op_sel:[0,1] op_sel_hi:[1,1]
    v_pk_mul_f32 v[210:211], v[112:113], v[194:195] op_sel:[0,1] op_sel_hi:[1,1]
    v_pk_mul_f32 v[212:213], v[114:115], v[194:195] op_sel:[0,1] op_sel_hi:[1,1]
    v_pk_fma_f32 v[36:37], v[36:37], v[194:195], v[198:199] op_sel_hi:[1,0,1] neg_lo:[0,0,1] neg_hi:[0,0,1]
    v_pk_fma_f32 v[38:39], v[38:39], v[194:195], v[200:201] op_sel_hi:[1,0,1] neg_lo:[0,0,1] neg_hi:[0,0,1]
    v_pk_fma_f32 v[40:41], v[40:41], v[194:195], v[202:203] op_sel_hi:[1,0,1] neg_lo:[0,0,1] neg_hi:[0,0,1]
    v_pk_fma_f32 v[42:43], v[42:43], v[194:195], v[204:205] op_sel_hi:[1,0,1] neg_lo:[0,0,1] neg_hi:[0,0,1]
    v_pk_fma_f32 v[44:45], v[44:45], v[194:195], v[206:207] op_sel_hi:[1,0,1] neg_lo:[0,0,1] neg_hi:[0,0,1]
    v_pk_fma_f32 v[46:47], v[46:47], v[194:195], v[208:209] op_sel_hi:[1,0,1] neg_lo:[0,0,1] neg_hi:[0,0,1]
    v_pk_fma_f32 v[48:49], v[48:49], v[194:195], v[210:211] op_sel_hi:[1,0,1] neg_lo:[0,0,1] neg_hi:[0,0,1]
    v_pk_fma_f32 v[50:51], v[50:51], v[194:195], v[212:213] op_sel_hi:[1,0,1] neg_lo:[0,0,1] neg_hi:[0,0,1]
    v_pk_mul_f32 v[198:199], v[36:37], v[36:37]
    v_pk_mul_f32 v[200:201], v[38:39], v[38:39]
    v_pk_mul_f32 v[202:203], v[40:41], v[40:41]
    v_pk_mul_f32 v[204:205], v[42:43], v[42:43]
    v_pk_mul_f32 v[206:207], v[44:45], v[44:45]
    v_pk_mul_f32 v[208:209], v[46:47], v[46:47]
    v_pk_mul_f32 v[210:211], v[48:49], v[48:49]
    v_pk_mul_f32 v[212:213], v[50:51], v[50:51]
    v_pk_fma_f32 v[198:199], v[198:199], v[182:183], v[184:185]
    v_pk_fma_f32 v[200:201], v[200:201], v[182:183], v[184:185]
    v_pk_fma_f32 v[202:203], v[202:203], v[182:183], v[184:185]
    v_pk_fma_f32 v[204:205], v[204:205], v[182:183], v[184:185]
    v_pk_fma_f32 v[206:207], v[206:207], v[182:183], v[184:185]
    v_pk_fma_f32 v[208:209], v[208:209], v[182:183], v[184:185]
    v_pk_fma_f32 v[210:211], v[210:211], v[182:183], v[184:185]
    v_pk_fma_f32 v[212:213], v[212:213], v[182:183], v[184:185]
    v_pk_mul_f32 v[198:199], v[198:199], v[36:37]
    v_pk_mul_f32 v[200:201], v[200:201], v[38:39]
    v_pk_mul_f32 v[202:203], v[202:203], v[40:41]
    v_pk_mul_f32 v[204:205], v[204:205], v[42:43]
    v_pk_mul_f32 v[206:207], v[206:207], v[44:45]
    v_pk_mul_f32 v[208:209], v[208:209], v[46:47]
    v_pk_mul_f32 v[210:211], v[210:211], v[48:49]
    v_pk_mul_f32 v[212:213], v[212:213], v[50:51]
    v_exp_f32 v198, v198
    v_exp_f32 v199, v199
    v_exp_f32 v200, v200
    v_exp_f32 v201, v201
    v_exp_f32 v202, v202
    v_exp_f32 v203, v203
    v_exp_f32 v204, v204
    v_exp_f32 v205, v205
    v_exp_f32 v206, v206
    v_exp_f32 v207, v207
    v_exp_f32 v208, v208
    v_exp_f32 v209, v209
    v_exp_f32 v210, v210
    v_exp_f32 v211, v211
    v_exp_f32 v212, v212
    v_exp_f32 v213, v213
    v_pk_add_f32 v[198:199], v[198:199], s[66:67]
    v_pk_add_f32 v[200:201], v[200:201], s[66:67]
    v_pk_add_f32 v[202:203], v[202:203], s[66:67]
    v_pk_add_f32 v[204:205], v[204:205], s[66:67]
    v_pk_add_f32 v[206:207], v[206:207], s[66:67]
    v_pk_add_f32 v[208:209], v[208:209], s[66:67]
    v_pk_add_f32 v[210:211], v[210:211], s[66:67]
    v_pk_add_f32 v[212:213], v[212:213], s[66:67]
    v_rcp_f32 v198, v198
    v_rcp_f32 v199, v199
    v_rcp_f32 v200, v200
    v_rcp_f32 v201, v201
    v_rcp_f32 v202, v202
    v_rcp_f32 v203, v203
    v_rcp_f32 v204, v204
    v_rcp_f32 v205, v205
    v_rcp_f32 v206, v206
    v_rcp_f32 v207, v207
    v_rcp_f32 v208, v208
    v_rcp_f32 v209, v209
    v_rcp_f32 v210, v210
    v_rcp_f32 v211, v211
    v_rcp_f32 v212, v212
    v_rcp_f32 v213, v213
    v_pk_mul_f32 v[36:37], v[36:37], v[198:199]
    v_pk_mul_f32 v[38:39], v[38:39], v[200:201]
    v_pk_mul_f32 v[40:41], v[40:41], v[202:203]
    v_pk_mul_f32 v[42:43], v[42:43], v[204:205]
    v_pk_mul_f32 v[44:45], v[44:45], v[206:207]
    v_pk_mul_f32 v[46:47], v[46:47], v[208:209]
    v_pk_mul_f32 v[48:49], v[48:49], v[210:211]
    v_pk_mul_f32 v[50:51], v[50:51], v[212:213]
    v_pk_add_f32 v[186:187], v[186:187], v[36:37]
    v_pk_fma_f32 v[188:189], v[36:37], v[36:37], v[188:189]
    v_pk_add_f32 v[186:187], v[186:187], v[38:39]
    v_pk_fma_f32 v[188:189], v[38:39], v[38:39], v[188:189]
    v_pk_add_f32 v[186:187], v[186:187], v[40:41]
    v_pk_fma_f32 v[188:189], v[40:41], v[40:41], v[188:189]
    v_pk_add_f32 v[186:187], v[186:187], v[42:43]
    v_pk_fma_f32 v[188:189], v[42:43], v[42:43], v[188:189]
    v_pk_add_f32 v[186:187], v[186:187], v[44:45]
    v_pk_fma_f32 v[188:189], v[44:45], v[44:45], v[188:189]
    v_pk_add_f32 v[186:187], v[186:187], v[46:47]
    v_pk_fma_f32 v[188:189], v[46:47], v[46:47], v[188:189]
    v_pk_add_f32 v[186:187], v[186:187], v[48:49]
    v_pk_fma_f32 v[188:189], v[48:49], v[48:49], v[188:189]
    v_pk_add_f32 v[186:187], v[186:187], v[50:51]
    v_pk_fma_f32 v[188:189], v[50:51], v[50:51], v[188:189]
    v_cvt_pk_bf16_f32 v214, v36, v37
    v_cvt_pk_bf16_f32 v215, v38, v39
    v_cvt_pk_bf16_f32 v216, v40, v41
    v_cvt_pk_bf16_f32 v217, v42, v43
    v_cvt_pk_bf16_f32 v218, v44, v45
    v_cvt_pk_bf16_f32 v219, v46, v47
    v_cvt_pk_bf16_f32 v220, v48, v49
    v_cvt_pk_bf16_f32 v221, v50, v51
    ds_write_b64 v180, v[214:215] offset:0
    ds_write_b64 v180, v[216:217] offset:16
    ds_write_b64 v180, v[218:219] offset:32
    ds_write_b64 v180, v[220:221] offset:48
    v_pk_mul_f32 v[198:199], v[116:117], v[194:195] op_sel:[0,1] op_sel_hi:[1,1]
    v_pk_mul_f32 v[200:201], v[118:119], v[194:195] op_sel:[0,1] op_sel_hi:[1,1]
    v_pk_mul_f32 v[202:203], v[120:121], v[194:195] op_sel:[0,1] op_sel_hi:[1,1]
    v_pk_mul_f32 v[204:205], v[122:123], v[194:195] op_sel:[0,1] op_sel_hi:[1,1]
    v_pk_mul_f32 v[206:207], v[124:125], v[194:195] op_sel:[0,1] op_sel_hi:[1,1]
    v_pk_mul_f32 v[208:209], v[126:127], v[194:195] op_sel:[0,1] op_sel_hi:[1,1]
    v_pk_mul_f32 v[210:211], v[128:129], v[194:195] op_sel:[0,1] op_sel_hi:[1,1]
    v_pk_mul_f32 v[212:213], v[130:131], v[194:195] op_sel:[0,1] op_sel_hi:[1,1]
    v_pk_fma_f32 v[68:69], v[68:69], v[194:195], v[198:199] op_sel_hi:[1,0,1] neg_lo:[0,0,1] neg_hi:[0,0,1]
    v_pk_fma_f32 v[70:71], v[70:71], v[194:195], v[200:201] op_sel_hi:[1,0,1] neg_lo:[0,0,1] neg_hi:[0,0,1]
    v_pk_fma_f32 v[72:73], v[72:73], v[194:195], v[202:203] op_sel_hi:[1,0,1] neg_lo:[0,0,1] neg_hi:[0,0,1]
    v_pk_fma_f32 v[74:75], v[74:75], v[194:195], v[204:205] op_sel_hi:[1,0,1] neg_lo:[0,0,1] neg_hi:[0,0,1]
    v_pk_fma_f32 v[76:77], v[76:77], v[194:195], v[206:207] op_sel_hi:[1,0,1] neg_lo:[0,0,1] neg_hi:[0,0,1]
    v_pk_fma_f32 v[78:79], v[78:79], v[194:195], v[208:209] op_sel_hi:[1,0,1] neg_lo:[0,0,1] neg_hi:[0,0,1]
    v_pk_fma_f32 v[80:81], v[80:81], v[194:195], v[210:211] op_sel_hi:[1,0,1] neg_lo:[0,0,1] neg_hi:[0,0,1]
    v_pk_fma_f32 v[82:83], v[82:83], v[194:195], v[212:213] op_sel_hi:[1,0,1] neg_lo:[0,0,1] neg_hi:[0,0,1]
    v_pk_mul_f32 v[198:199], v[68:69], v[68:69]
    v_pk_mul_f32 v[200:201], v[70:71], v[70:71]
    v_pk_mul_f32 v[202:203], v[72:73], v[72:73]
    v_pk_mul_f32 v[204:205], v[74:75], v[74:75]
    v_pk_mul_f32 v[206:207], v[76:77], v[76:77]
    v_pk_mul_f32 v[208:209], v[78:79], v[78:79]
    v_pk_mul_f32 v[210:211], v[80:81], v[80:81]
    v_pk_mul_f32 v[212:213], v[82:83], v[82:83]
    v_pk_fma_f32 v[198:199], v[198:199], v[182:183], v[184:185]
    v_pk_fma_f32 v[200:201], v[200:201], v[182:183], v[184:185]
    v_pk_fma_f32 v[202:203], v[202:203], v[182:183], v[184:185]
    v_pk_fma_f32 v[204:205], v[204:205], v[182:183], v[184:185]
    v_pk_fma_f32 v[206:207], v[206:207], v[182:183], v[184:185]
    v_pk_fma_f32 v[208:209], v[208:209], v[182:183], v[184:185]
    v_pk_fma_f32 v[210:211], v[210:211], v[182:183], v[184:185]
    v_pk_fma_f32 v[212:213], v[212:213], v[182:183], v[184:185]
    v_pk_mul_f32 v[198:199], v[198:199], v[68:69]
    v_pk_mul_f32 v[200:201], v[200:201], v[70:71]
    v_pk_mul_f32 v[202:203], v[202:203], v[72:73]
    v_pk_mul_f32 v[204:205], v[204:205], v[74:75]
    v_pk_mul_f32 v[206:207], v[206:207], v[76:77]
    v_pk_mul_f32 v[208:209], v[208:209], v[78:79]
    v_pk_mul_f32 v[210:211], v[210:211], v[80:81]
    v_pk_mul_f32 v[212:213], v[212:213], v[82:83]
    v_exp_f32 v198, v198
    v_exp_f32 v199, v199
    v_exp_f32 v200, v200
    v_exp_f32 v201, v201
    v_exp_f32 v202, v202
    v_exp_f32 v203, v203
    v_exp_f32 v204, v204
    v_exp_f32 v205, v205
    v_exp_f32 v206, v206
    v_exp_f32 v207, v207
    v_exp_f32 v208, v208
    v_exp_f32 v209, v209
    v_exp_f32 v210, v210
    v_exp_f32 v211, v211
    v_exp_f32 v212, v212
    v_exp_f32 v213, v213
    v_pk_add_f32 v[198:199], v[198:199], s[66:67]
    v_pk_add_f32 v[200:201], v[200:201], s[66:67]
    v_pk_add_f32 v[202:203], v[202:203], s[66:67]
    v_pk_add_f32 v[204:205], v[204:205], s[66:67]
    v_pk_add_f32 v[206:207], v[206:207], s[66:67]
    v_pk_add_f32 v[208:209], v[208:209], s[66:67]
    v_pk_add_f32 v[210:211], v[210:211], s[66:67]
    v_pk_add_f32 v[212:213], v[212:213], s[66:67]
    v_rcp_f32 v198, v198
    v_rcp_f32 v199, v199
    v_rcp_f32 v200, v200
    v_rcp_f32 v201, v201
    v_rcp_f32 v202, v202
    v_rcp_f32 v203, v203
    v_rcp_f32 v204, v204
    v_rcp_f32 v205, v205
    v_rcp_f32 v206, v206
    v_rcp_f32 v207, v207
    v_rcp_f32 v208, v208
    v_rcp_f32 v209, v209
    v_rcp_f32 v210, v210
    v_rcp_f32 v211, v211
    v_rcp_f32 v212, v212
    v_rcp_f32 v213, v213
    v_pk_mul_f32 v[68:69], v[68:69], v[198:199]
    v_pk_mul_f32 v[70:71], v[70:71], v[200:201]
    v_pk_mul_f32 v[72:73], v[72:73], v[202:203]
    v_pk_mul_f32 v[74:75], v[74:75], v[204:205]
    v_pk_mul_f32 v[76:77], v[76:77], v[206:207]
    v_pk_mul_f32 v[78:79], v[78:79], v[208:209]
    v_pk_mul_f32 v[80:81], v[80:81], v[210:211]
    v_pk_mul_f32 v[82:83], v[82:83], v[212:213]
    v_pk_add_f32 v[186:187], v[186:187], v[68:69]
    v_pk_fma_f32 v[188:189], v[68:69], v[68:69], v[188:189]
    v_pk_add_f32 v[186:187], v[186:187], v[70:71]
    v_pk_fma_f32 v[188:189], v[70:71], v[70:71], v[188:189]
    v_pk_add_f32 v[186:187], v[186:187], v[72:73]
    v_pk_fma_f32 v[188:189], v[72:73], v[72:73], v[188:189]
    v_pk_add_f32 v[186:187], v[186:187], v[74:75]
    v_pk_fma_f32 v[188:189], v[74:75], v[74:75], v[188:189]
    v_pk_add_f32 v[186:187], v[186:187], v[76:77]
    v_pk_fma_f32 v[188:189], v[76:77], v[76:77], v[188:189]
    v_pk_add_f32 v[186:187], v[186:187], v[78:79]
    v_pk_fma_f32 v[188:189], v[78:79], v[78:79], v[188:189]
    v_pk_add_f32 v[186:187], v[186:187], v[80:81]
    v_pk_fma_f32 v[188:189], v[80:81], v[80:81], v[188:189]
    v_pk_add_f32 v[186:187], v[186:187], v[82:83]
    v_pk_fma_f32 v[188:189], v[82:83], v[82:83], v[188:189]
    v_cvt_pk_bf16_f32 v214, v68, v69
    v_cvt_pk_bf16_f32 v215, v70, v71
    v_cvt_pk_bf16_f32 v216, v72, v73
    v_cvt_pk_bf16_f32 v217, v74, v75
    v_cvt_pk_bf16_f32 v218, v76, v77
    v_cvt_pk_bf16_f32 v219, v78, v79
    v_cvt_pk_bf16_f32 v220, v80, v81
    v_cvt_pk_bf16_f32 v221, v82, v83
    ds_write_b64 v180, v[214:215] offset:64
    ds_write_b64 v180, v[216:217] offset:80
    ds_write_b64 v180, v[218:219] offset:96
    ds_write_b64 v180, v[220:221] offset:112
    s_waitcnt lgkmcnt(0)
    s_barrier
    v_pk_mul_f32 v[198:199], v[100:101], v[196:197] op_sel:[0,1] op_sel_hi:[1,1]
    v_pk_mul_f32 v[200:201], v[102:103], v[196:197] op_sel:[0,1] op_sel_hi:[1,1]
    v_pk_mul_f32 v[202:203], v[104:105], v[196:197] op_sel:[0,1] op_sel_hi:[1,1]
    v_pk_mul_f32 v[204:205], v[106:107], v[196:197] op_sel:[0,1] op_sel_hi:[1,1]
    v_pk_mul_f32 v[206:207], v[108:109], v[196:197] op_sel:[0,1] op_sel_hi:[1,1]
    v_pk_mul_f32 v[208:209], v[110:111], v[196:197] op_sel:[0,1] op_sel_hi:[1,1]
    v_pk_mul_f32 v[210:211], v[112:113], v[196:197] op_sel:[0,1] op_sel_hi:[1,1]
    v_pk_mul_f32 v[212:213], v[114:115], v[196:197] op_sel:[0,1] op_sel_hi:[1,1]
    v_pk_fma_f32 v[52:53], v[52:53], v[196:197], v[198:199] op_sel_hi:[1,0,1] neg_lo:[0,0,1] neg_hi:[0,0,1]
    v_pk_fma_f32 v[54:55], v[54:55], v[196:197], v[200:201] op_sel_hi:[1,0,1] neg_lo:[0,0,1] neg_hi:[0,0,1]
    v_pk_fma_f32 v[56:57], v[56:57], v[196:197], v[202:203] op_sel_hi:[1,0,1] neg_lo:[0,0,1] neg_hi:[0,0,1]
    v_pk_fma_f32 v[58:59], v[58:59], v[196:197], v[204:205] op_sel_hi:[1,0,1] neg_lo:[0,0,1] neg_hi:[0,0,1]
    v_pk_fma_f32 v[60:61], v[60:61], v[196:197], v[206:207] op_sel_hi:[1,0,1] neg_lo:[0,0,1] neg_hi:[0,0,1]
    v_pk_fma_f32 v[62:63], v[62:63], v[196:197], v[208:209] op_sel_hi:[1,0,1] neg_lo:[0,0,1] neg_hi:[0,0,1]
    v_pk_fma_f32 v[64:65], v[64:65], v[196:197], v[210:211] op_sel_hi:[1,0,1] neg_lo:[0,0,1] neg_hi:[0,0,1]
    v_pk_fma_f32 v[66:67], v[66:67], v[196:197], v[212:213] op_sel_hi:[1,0,1] neg_lo:[0,0,1] neg_hi:[0,0,1]
    v_pk_mul_f32 v[198:199], v[52:53], v[52:53]
    v_pk_mul_f32 v[200:201], v[54:55], v[54:55]
    v_pk_mul_f32 v[202:203], v[56:57], v[56:57]
    v_pk_mul_f32 v[204:205], v[58:59], v[58:59]
    v_pk_mul_f32 v[206:207], v[60:61], v[60:61]
    v_pk_mul_f32 v[208:209], v[62:63], v[62:63]
    v_pk_mul_f32 v[210:211], v[64:65], v[64:65]
    v_pk_mul_f32 v[212:213], v[66:67], v[66:67]
    v_pk_fma_f32 v[198:199], v[198:199], v[182:183], v[184:185]
    v_pk_fma_f32 v[200:201], v[200:201], v[182:183], v[184:185]
    v_pk_fma_f32 v[202:203], v[202:203], v[182:183], v[184:185]
    v_pk_fma_f32 v[204:205], v[204:205], v[182:183], v[184:185]
    v_pk_fma_f32 v[206:207], v[206:207], v[182:183], v[184:185]
    v_pk_fma_f32 v[208:209], v[208:209], v[182:183], v[184:185]
    v_pk_fma_f32 v[210:211], v[210:211], v[182:183], v[184:185]
    v_pk_fma_f32 v[212:213], v[212:213], v[182:183], v[184:185]
    v_pk_mul_f32 v[198:199], v[198:199], v[52:53]
    v_pk_mul_f32 v[200:201], v[200:201], v[54:55]
    v_pk_mul_f32 v[202:203], v[202:203], v[56:57]
    v_pk_mul_f32 v[204:205], v[204:205], v[58:59]
    v_pk_mul_f32 v[206:207], v[206:207], v[60:61]
    v_pk_mul_f32 v[208:209], v[208:209], v[62:63]
    v_pk_mul_f32 v[210:211], v[210:211], v[64:65]
    v_pk_mul_f32 v[212:213], v[212:213], v[66:67]
    v_exp_f32 v198, v198
    v_exp_f32 v199, v199
    v_exp_f32 v200, v200
    v_exp_f32 v201, v201
    v_exp_f32 v202, v202
    v_exp_f32 v203, v203
    v_exp_f32 v204, v204
    v_exp_f32 v205, v205
    v_exp_f32 v206, v206
    v_exp_f32 v207, v207
    v_exp_f32 v208, v208
    v_exp_f32 v209, v209
    v_exp_f32 v210, v210
    v_exp_f32 v211, v211
    v_exp_f32 v212, v212
    v_exp_f32 v213, v213
    v_pk_add_f32 v[198:199], v[198:199], s[66:67]
    v_pk_add_f32 v[200:201], v[200:201], s[66:67]
    v_pk_add_f32 v[202:203], v[202:203], s[66:67]
    v_pk_add_f32 v[204:205], v[204:205], s[66:67]
    v_pk_add_f32 v[206:207], v[206:207], s[66:67]
    v_pk_add_f32 v[208:209], v[208:209], s[66:67]
    v_pk_add_f32 v[210:211], v[210:211], s[66:67]
    v_pk_add_f32 v[212:213], v[212:213], s[66:67]
    v_rcp_f32 v198, v198
    v_rcp_f32 v199, v199
    v_rcp_f32 v200, v200
    v_rcp_f32 v201, v201
    v_rcp_f32 v202, v202
    v_rcp_f32 v203, v203
    v_rcp_f32 v204, v204
    v_rcp_f32 v205, v205
    v_rcp_f32 v206, v206
    v_rcp_f32 v207, v207
    v_rcp_f32 v208, v208
    v_rcp_f32 v209, v209
    v_rcp_f32 v210, v210
    v_rcp_f32 v211, v211
    v_rcp_f32 v212, v212
    v_rcp_f32 v213, v213
    v_pk_mul_f32 v[52:53], v[52:53], v[198:199]
    v_pk_mul_f32 v[54:55], v[54:55], v[200:201]
    v_pk_mul_f32 v[56:57], v[56:57], v[202:203]
    v_pk_mul_f32 v[58:59], v[58:59], v[204:205]
    v_pk_mul_f32 v[60:61], v[60:61], v[206:207]
    v_pk_mul_f32 v[62:63], v[62:63], v[208:209]
    v_pk_mul_f32 v[64:65], v[64:65], v[210:211]
    v_pk_mul_f32 v[66:67], v[66:67], v[212:213]
    v_pk_add_f32 v[190:191], v[190:191], v[52:53]
    v_pk_fma_f32 v[192:193], v[52:53], v[52:53], v[192:193]
    v_pk_add_f32 v[190:191], v[190:191], v[54:55]
    v_pk_fma_f32 v[192:193], v[54:55], v[54:55], v[192:193]
    v_pk_add_f32 v[190:191], v[190:191], v[56:57]
    v_pk_fma_f32 v[192:193], v[56:57], v[56:57], v[192:193]
    v_pk_add_f32 v[190:191], v[190:191], v[58:59]
    v_pk_fma_f32 v[192:193], v[58:59], v[58:59], v[192:193]
    v_pk_add_f32 v[190:191], v[190:191], v[60:61]
    v_pk_fma_f32 v[192:193], v[60:61], v[60:61], v[192:193]
    v_pk_add_f32 v[190:191], v[190:191], v[62:63]
    v_pk_fma_f32 v[192:193], v[62:63], v[62:63], v[192:193]
    v_pk_add_f32 v[190:191], v[190:191], v[64:65]
    v_pk_fma_f32 v[192:193], v[64:65], v[64:65], v[192:193]
    v_pk_add_f32 v[190:191], v[190:191], v[66:67]
    v_pk_fma_f32 v[192:193], v[66:67], v[66:67], v[192:193]
    v_cvt_pk_bf16_f32 v214, v52, v53
    v_cvt_pk_bf16_f32 v215, v54, v55
    v_cvt_pk_bf16_f32 v216, v56, v57
    v_cvt_pk_bf16_f32 v217, v58, v59
    v_cvt_pk_bf16_f32 v218, v60, v61
    v_cvt_pk_bf16_f32 v219, v62, v63
    v_cvt_pk_bf16_f32 v220, v64, v65
    v_cvt_pk_bf16_f32 v221, v66, v67
    ds_write_b64 v180, v[214:215] offset:8704
    ds_write_b64 v180, v[216:217] offset:8720
    ds_write_b64 v180, v[218:219] offset:8736
    ds_write_b64 v180, v[220:221] offset:8752
    v_pk_mul_f32 v[198:199], v[116:117], v[196:197] op_sel:[0,1] op_sel_hi:[1,1]
    v_pk_mul_f32 v[200:201], v[118:119], v[196:197] op_sel:[0,1] op_sel_hi:[1,1]
    v_pk_mul_f32 v[202:203], v[120:121], v[196:197] op_sel:[0,1] op_sel_hi:[1,1]
    v_pk_mul_f32 v[204:205], v[122:123], v[196:197] op_sel:[0,1] op_sel_hi:[1,1]
    v_pk_mul_f32 v[206:207], v[124:125], v[196:197] op_sel:[0,1] op_sel_hi:[1,1]
    v_pk_mul_f32 v[208:209], v[126:127], v[196:197] op_sel:[0,1] op_sel_hi:[1,1]
    v_pk_mul_f32 v[210:211], v[128:129], v[196:197] op_sel:[0,1] op_sel_hi:[1,1]
    v_pk_mul_f32 v[212:213], v[130:131], v[196:197] op_sel:[0,1] op_sel_hi:[1,1]
    v_pk_fma_f32 v[84:85], v[84:85], v[196:197], v[198:199] op_sel_hi:[1,0,1] neg_lo:[0,0,1] neg_hi:[0,0,1]
    v_pk_fma_f32 v[86:87], v[86:87], v[196:197], v[200:201] op_sel_hi:[1,0,1] neg_lo:[0,0,1] neg_hi:[0,0,1]
    v_pk_fma_f32 v[88:89], v[88:89], v[196:197], v[202:203] op_sel_hi:[1,0,1] neg_lo:[0,0,1] neg_hi:[0,0,1]
    v_pk_fma_f32 v[90:91], v[90:91], v[196:197], v[204:205] op_sel_hi:[1,0,1] neg_lo:[0,0,1] neg_hi:[0,0,1]
    v_pk_fma_f32 v[92:93], v[92:93], v[196:197], v[206:207] op_sel_hi:[1,0,1] neg_lo:[0,0,1] neg_hi:[0,0,1]
    v_pk_fma_f32 v[94:95], v[94:95], v[196:197], v[208:209] op_sel_hi:[1,0,1] neg_lo:[0,0,1] neg_hi:[0,0,1]
    v_pk_fma_f32 v[96:97], v[96:97], v[196:197], v[210:211] op_sel_hi:[1,0,1] neg_lo:[0,0,1] neg_hi:[0,0,1]
    v_pk_fma_f32 v[98:99], v[98:99], v[196:197], v[212:213] op_sel_hi:[1,0,1] neg_lo:[0,0,1] neg_hi:[0,0,1]
    v_pk_mul_f32 v[198:199], v[84:85], v[84:85]
    v_pk_mul_f32 v[200:201], v[86:87], v[86:87]
    v_pk_mul_f32 v[202:203], v[88:89], v[88:89]
    v_pk_mul_f32 v[204:205], v[90:91], v[90:91]
    v_pk_mul_f32 v[206:207], v[92:93], v[92:93]
    v_pk_mul_f32 v[208:209], v[94:95], v[94:95]
    v_pk_mul_f32 v[210:211], v[96:97], v[96:97]
    v_pk_mul_f32 v[212:213], v[98:99], v[98:99]
    v_pk_fma_f32 v[198:199], v[198:199], v[182:183], v[184:185]
    v_pk_fma_f32 v[200:201], v[200:201], v[182:183], v[184:185]
    v_pk_fma_f32 v[202:203], v[202:203], v[182:183], v[184:185]
    v_pk_fma_f32 v[204:205], v[204:205], v[182:183], v[184:185]
    v_pk_fma_f32 v[206:207], v[206:207], v[182:183], v[184:185]
    v_pk_fma_f32 v[208:209], v[208:209], v[182:183], v[184:185]
    v_pk_fma_f32 v[210:211], v[210:211], v[182:183], v[184:185]
    v_pk_fma_f32 v[212:213], v[212:213], v[182:183], v[184:185]
    v_pk_mul_f32 v[198:199], v[198:199], v[84:85]
    v_pk_mul_f32 v[200:201], v[200:201], v[86:87]
    v_pk_mul_f32 v[202:203], v[202:203], v[88:89]
    v_pk_mul_f32 v[204:205], v[204:205], v[90:91]
    v_pk_mul_f32 v[206:207], v[206:207], v[92:93]
    v_pk_mul_f32 v[208:209], v[208:209], v[94:95]
    v_pk_mul_f32 v[210:211], v[210:211], v[96:97]
    v_pk_mul_f32 v[212:213], v[212:213], v[98:99]
    v_exp_f32 v198, v198
    v_exp_f32 v199, v199
    v_exp_f32 v200, v200
    v_exp_f32 v201, v201
    v_exp_f32 v202, v202
    v_exp_f32 v203, v203
    v_exp_f32 v204, v204
    v_exp_f32 v205, v205
    v_exp_f32 v206, v206
    v_exp_f32 v207, v207
    v_exp_f32 v208, v208
    v_exp_f32 v209, v209
    v_exp_f32 v210, v210
    v_exp_f32 v211, v211
    v_exp_f32 v212, v212
    v_exp_f32 v213, v213
    v_pk_add_f32 v[198:199], v[198:199], s[66:67]
    v_pk_add_f32 v[200:201], v[200:201], s[66:67]
    v_pk_add_f32 v[202:203], v[202:203], s[66:67]
    v_pk_add_f32 v[204:205], v[204:205], s[66:67]
    v_pk_add_f32 v[206:207], v[206:207], s[66:67]
    v_pk_add_f32 v[208:209], v[208:209], s[66:67]
    v_pk_add_f32 v[210:211], v[210:211], s[66:67]
    v_pk_add_f32 v[212:213], v[212:213], s[66:67]
    v_rcp_f32 v198, v198
    v_rcp_f32 v199, v199
    v_rcp_f32 v200, v200
    v_rcp_f32 v201, v201
    v_rcp_f32 v202, v202
    v_rcp_f32 v203, v203
    v_rcp_f32 v204, v204
    v_rcp_f32 v205, v205
    v_rcp_f32 v206, v206
    v_rcp_f32 v207, v207
    v_rcp_f32 v208, v208
    v_rcp_f32 v209, v209
    v_rcp_f32 v210, v210
    v_rcp_f32 v211, v211
    v_rcp_f32 v212, v212
    v_rcp_f32 v213, v213
    v_pk_mul_f32 v[84:85], v[84:85], v[198:199]
    v_pk_mul_f32 v[86:87], v[86:87], v[200:201]
    v_pk_mul_f32 v[88:89], v[88:89], v[202:203]
    v_pk_mul_f32 v[90:91], v[90:91], v[204:205]
    v_pk_mul_f32 v[92:93], v[92:93], v[206:207]
    v_pk_mul_f32 v[94:95], v[94:95], v[208:209]
    v_pk_mul_f32 v[96:97], v[96:97], v[210:211]
    v_pk_mul_f32 v[98:99], v[98:99], v[212:213]
    v_pk_add_f32 v[190:191], v[190:191], v[84:85]
    v_pk_fma_f32 v[192:193], v[84:85], v[84:85], v[192:193]
    v_pk_add_f32 v[190:191], v[190:191], v[86:87]
    v_pk_fma_f32 v[192:193], v[86:87], v[86:87], v[192:193]
    v_pk_add_f32 v[190:191], v[190:191], v[88:89]
    v_pk_fma_f32 v[192:193], v[88:89], v[88:89], v[192:193]
    v_pk_add_f32 v[190:191], v[190:191], v[90:91]
    v_pk_fma_f32 v[192:193], v[90:91], v[90:91], v[192:193]
    v_pk_add_f32 v[190:191], v[190:191], v[92:93]
    v_pk_fma_f32 v[192:193], v[92:93], v[92:93], v[192:193]
    v_pk_add_f32 v[190:191], v[190:191], v[94:95]
    v_pk_fma_f32 v[192:193], v[94:95], v[94:95], v[192:193]
    v_pk_add_f32 v[190:191], v[190:191], v[96:97]
    v_pk_fma_f32 v[192:193], v[96:97], v[96:97], v[192:193]
    v_pk_add_f32 v[190:191], v[190:191], v[98:99]
    v_pk_fma_f32 v[192:193], v[98:99], v[98:99], v[192:193]
    v_cvt_pk_bf16_f32 v214, v84, v85
    v_cvt_pk_bf16_f32 v215, v86, v87
    v_cvt_pk_bf16_f32 v216, v88, v89
    v_cvt_pk_bf16_f32 v217, v90, v91
    v_cvt_pk_bf16_f32 v218, v92, v93
    v_cvt_pk_bf16_f32 v219, v94, v95
    v_cvt_pk_bf16_f32 v220, v96, v97
    v_cvt_pk_bf16_f32 v221, v98, v99
    ds_write_b64 v180, v[214:215] offset:8768
    ds_write_b64 v180, v[216:217] offset:8784
    ds_write_b64 v180, v[218:219] offset:8800
    ds_write_b64 v180, v[220:221] offset:8816
    s_waitcnt lgkmcnt(0)
    s_barrier
    s_lshr_b32 s99, s20, 2
    s_lshl_b32 s99, s99, 6
    s_and_b32 s68, s20, 3
    s_lshl_b32 s68, s68, 3
    s_add_u32 s68, s68, s99
    s_add_u32 s68, s68, 32
    v_lshrrev_b32 v5, 4, v1
    v_and_b32 v4, 15, v1
    v_add_u32 v224, s68, v5
    v_mul_u32_u24 v6, 272, v224
    v_lshl_add_u32 v222, v4, 4, v6
    v_mul_u32_u24 v6, 5120, v224
    v_lshl_add_u32 v6, v4, 4, v6
    v_add_u32 v223, s27, v6
    ds_read_b128 v[100:103], v222 offset:0
    ds_read_b128 v[104:107], v222 offset:1088
    s_mov_b32 s63, 0
    s_waitcnt lgkmcnt(1)
    buffer_store_dwordx4 v[100:103], v223, s[16:19], s63 offen sc1
    v_add_u32 v4, 4, v224
    v_cmp_gt_u32 vcc, 125, v4
    v_mov_b32 v5, 0x80000000
    v_add_u32 v6, 20480, v223
    v_cndmask_b32 v6, v5, v6, vcc
    s_waitcnt lgkmcnt(0)
    buffer_store_dwordx4 v[104:107], v6, s[16:19], 0 offen sc1
    s_cmp_ge_u32 s22, 4
    s_cbranch_scc0 k1B_end
    s_sub_u32 s99, s22, 4
    s_lshl_b32 s99, s99, 1
    s_add_u32 s99, s99, s60
    s_lshl_b32 s64, s99, 14
    v_add_f32 v4, v186, v187
    v_add_f32 v5, v188, v189
    v_mov_b32 v6, v4
    s_nop 1
    v_permlane32_swap_b32 v4, v6
    s_nop 1
    v_add_f32 v4, v4, v6
    v_mov_b32 v7, v5
    s_nop 1
    v_permlane32_swap_b32 v5, v7
    s_nop 1
    v_add_f32 v5, v5, v7
    v_add_u32 v9, 0, v148
    v_add_u32 v8, s26, v9
    v_lshlrev_b32 v8, 3, v8
    v_cmp_gt_u32 vcc, 125, v9
    v_mov_b32 v10, 0x80000000
    s_nop 0
    v_cndmask_b32 v8, v10, v8, vcc
    s_mov_b32 exec_hi, 0
    buffer_store_dwordx2 v[4:5], v8, s[52:55], s64 offen sc1
    s_mov_b32 exec_hi, -1
    s_nop 1
    v_add_f32 v4, v190, v191
    v_add_f32 v5, v192, v193
    v_mov_b32 v6, v4
    s_nop 1
    v_permlane32_swap_b32 v4, v6
    s_nop 1
    v_add_f32 v4, v4, v6
    v_mov_b32 v7, v5
    s_nop 1
    v_permlane32_swap_b32 v5, v7
    s_nop 1
    v_add_f32 v5, v5, v7
    v_add_u32 v9, 32, v148
    v_add_u32 v8, s26, v9
    v_lshlrev_b32 v8, 3, v8
    v_cmp_gt_u32 vcc, 125, v9
    v_mov_b32 v10, 0x80000000
    s_nop 0
    v_cndmask_b32 v8, v10, v8, vcc
    s_mov_b32 exec_hi, 0
    buffer_store_dwordx2 v[4:5], v8, s[52:55], s64 offen sc1
    s_mov_b32 exec_hi, -1
    s_nop 1
k1B_end:
    s_endpgm
k1B_loader:
    v_and_b32 v1, 63, v0
    s_mul_i32 s99, s25, 32
    s_mul_i32 s58, s25, 4096
    s_add_u32 s99, s99, s26
    v_lshrrev_b32 v4, 3, v1
    v_lshrrev_b32 v5, 4, v1
    v_and_b32 v6, 7, v1
    v_xor_b32 v5, v5, v6
    v_add_u32 v4, s99, v4
    v_lshlrev_b32 v4, 10, v4
    v_lshl_add_u32 v16, v5, 4, v4
    v_xor_b32 v5, 4, v5
    v_lshl_add_u32 v6, v5, 4, v4
    v_add_u32 v17, 7168, v6
    v_add_u32 v18, 14336, v16
    v_add_u32 v19, 21504, v6
    s_mul_i32 s63, s22, 256
    s_mul_i32 s56, s25, 4096
    s_mul_i32 s99, s25, 32768
    s_add_u32 s99, s99, s63
    v_lshrrev_b32 v5, 4, v1
    v_and_b32 v4, 15, v1
    v_and_b32 v6, 3, v5
    v_lshlrev_b32 v6, 2, v6
    v_xor_b32 v4, v4, v6
    v_mul_u32_u24 v5, 2048, v5
    v_lshl_add_u32 v12, v4, 4, v5
    v_add_u32 v12, s99, v12
    v_add_u32 v15, 21504, v12
    v_add_u32 v14, 14336, v12
    v_add_u32 v13, 7168, v12
    s_cmp_eq_u32 s25, 3
    s_cselect_b32 s60, 0xffffffff, 0xffffffff
    s_cselect_b32 s61, 0xff, 0xffffffff
    s_mov_b32 s62, s23
    s_mul_i32 s57, s62, 131072
    s_lshl_b32 s59, s62, 7
    v_mov_b32 v8, 0x3f803f80
    v_mov_b32 v9, 0x3f803f80
    v_mov_b32 v10, 0x3f803f80
    v_mov_b32 v11, 0x3f803f80
    v_lshlrev_b32 v4, 4, v1
    s_mov_b64 exec, 0xffffff
    v_add_u32 v5, 32384, v4
    ds_write_b128 v5, v[8:11]
    v_add_u32 v5, 65152, v4
    ds_write_b128 v5, v[8:11]
    v_add_u32 v5, 97920, v4
    ds_write_b128 v5, v[8:11]
    v_add_u32 v5, 130688, v4
    ds_write_b128 v5, v[8:11]
    s_mov_b64 exec, -1
    s_waitcnt lgkmcnt(0)
    s_mov_b32 s30, s42
    s_mov_b32 s31, s43
    s_mov_b32 s8, s4
    s_mov_b32 s9, s5
    s_mov_b32 s10, 2048000
    s_mov_b32 s11, 0x20000
    s_mov_b32 s12, s28
    s_mov_b32 s13, s29
    s_mov_b32 s14, 1048576
    s_mov_b32 s15, 0x20000
    s_add_u32 m0, s58, 16384
    s_nop 0
    buffer_load_dwordx4 v16, s[8:11], s59 offen offset:0  lds
    buffer_load_dwordx4 v17, s[8:11], s59 offen offset:1024  lds
    buffer_load_dwordx4 v18, s[8:11], s59 offen offset:2048  lds
    s_mov_b64 exec, s[60:61]
    buffer_load_dwordx4 v19, s[8:11], s59 offen offset:3072  lds
    s_mov_b64 exec, -1
    s_add_u32 m0, s56, 0
    s_nop 0
    buffer_load_dwordx4 v12, s[12:15], s57 offen offset:0  lds
    buffer_load_dwordx4 v13, s[12:15], s57 offen offset:1024  lds
    buffer_load_dwordx4 v14, s[12:15], s57 offen offset:2048  lds
    buffer_load_dwordx4 v15, s[12:15], s57 offen offset:3072  lds
    s_add_u32 s62, s62, 1
    s_and_b32 s62, s62, 7
    s_mul_i32 s57, s62, 131072
    s_lshl_b32 s59, s62, 7
    s_add_u32 m0, s58, 49152
    s_nop 0
    buffer_load_dwordx4 v16, s[8:11], s59 offen offset:0  lds
    buffer_load_dwordx4 v17, s[8:11], s59 offen offset:1024  lds
    buffer_load_dwordx4 v18, s[8:11], s59 offen offset:2048  lds
    s_mov_b64 exec, s[60:61]
    buffer_load_dwordx4 v19, s[8:11], s59 offen offset:3072  lds
    s_mov_b64 exec, -1
    s_add_u32 m0, s56, 32768
    s_nop 0
    buffer_load_dwordx4 v12, s[12:15], s57 offen offset:0  lds
    buffer_load_dwordx4 v13, s[12:15], s57 offen offset:1024  lds
    buffer_load_dwordx4 v14, s[12:15], s57 offen offset:2048  lds
    buffer_load_dwordx4 v15, s[12:15], s57 offen offset:3072  lds
    s_add_u32 s62, s62, 1
    s_and_b32 s62, s62, 7
    s_mul_i32 s57, s62, 131072
    s_lshl_b32 s59, s62, 7
    s_mov_b32 s16, s30
    s_mov_b32 s17, s31
    s_mov_b32 s18, 10240000
    s_mov_b32 s19, 0x20000
    v_lshrrev_b32 v76, 2, v0
    v_and_b32 v77, 3, v0
    v_bfe_u32 v78, v76, 1, 1
    v_lshlrev_b32 v77, 1, v77
    v_xor_b32 v77, v77, v78
    v_lshlrev_b32 v76, 7, v76
    v_lshl_add_u32 v76, v77, 4, v76
    v_add_u32 v52, 16384, v76
    v_xor_b32 v53, 16, v76
    v_add_u32 v53, 16384, v53
    v_mov_b32 v54, 0
    v_mov_b32 v55, 0
    v_mov_b32 v56, 0
    v_mov_b32 v57, 0
    s_waitcnt vmcnt(8)
    s_barrier
    s_add_u32 m0, s58, 81920
    s_nop 0
    buffer_load_dwordx4 v16, s[8:11], s59 offen offset:0  lds
    ds_read_b128 v[60:63], v52 offset:0
    ds_read_b128 v[64:67], v53 offset:0
    s_waitcnt lgkmcnt(0)
    v_lshlrev_b32 v68, 16, v60
    v_and_b32 v69, 0xffff0000, v60
    v_lshlrev_b32 v70, 16, v61
    v_and_b32 v71, 0xffff0000, v61
    buffer_load_dwordx4 v17, s[8:11], s59 offen offset:1024  lds
    v_lshlrev_b32 v72, 16, v62
    v_and_b32 v73, 0xffff0000, v62
    v_lshlrev_b32 v74, 16, v63
    v_and_b32 v75, 0xffff0000, v63
    v_add_f32 v54, v54, v68
    v_add_f32 v55, v55, v69
    v_fmac_f32 v56, v68, v68
    buffer_load_dwordx4 v18, s[8:11], s59 offen offset:2048  lds
    v_fmac_f32 v57, v69, v69
    v_add_f32 v54, v54, v70
    v_add_f32 v55, v55, v71
    v_fmac_f32 v56, v70, v70
    v_fmac_f32 v57, v71, v71
    v_add_f32 v54, v54, v72
    v_add_f32 v55, v55, v73
    s_mov_b64 exec, s[60:61]
    buffer_load_dwordx4 v19, s[8:11], s59 offen offset:3072  lds
    s_mov_b64 exec, -1
    v_fmac_f32 v56, v72, v72
    v_fmac_f32 v57, v73, v73
    v_add_f32 v54, v54, v74
    v_add_f32 v55, v55, v75
    v_fmac_f32 v56, v74, v74
    v_fmac_f32 v57, v75, v75
    s_add_u32 m0, s56, 65536
    s_nop 0
    buffer_load_dwordx4 v12, s[12:15], s57 offen offset:0  lds
    v_lshlrev_b32 v68, 16, v64
    v_and_b32 v69, 0xffff0000, v64
    v_lshlrev_b32 v70, 16, v65
    v_and_b32 v71, 0xffff0000, v65
    v_lshlrev_b32 v72, 16, v66
    v_and_b32 v73, 0xffff0000, v66
    buffer_load_dwordx4 v13, s[12:15], s57 offen offset:1024  lds
    v_lshlrev_b32 v74, 16, v67
    v_and_b32 v75, 0xffff0000, v67
    v_add_f32 v54, v54, v68
    v_add_f32 v55, v55, v69
    v_fmac_f32 v56, v68, v68
    v_fmac_f32 v57, v69, v69
    buffer_load_dwordx4 v14, s[12:15], s57 offen offset:2048  lds
    v_add_f32 v54, v54, v70
    v_add_f32 v55, v55, v71
    v_fmac_f32 v56, v70, v70
    v_fmac_f32 v57, v71, v71
    v_add_f32 v54, v54, v72
    v_add_f32 v55, v55, v73
    buffer_load_dwordx4 v15, s[12:15], s57 offen offset:3072  lds
    s_add_u32 s62, s62, 1
    s_and_b32 s62, s62, 7
    s_mul_i32 s57, s62, 131072
    s_lshl_b32 s59, s62, 7
    v_fmac_f32 v56, v72, v72
    v_fmac_f32 v57, v73, v73
    v_add_f32 v54, v54, v74
    v_add_f32 v55, v55, v75
    v_fmac_f32 v56, v74, v74
    v_fmac_f32 v57, v75, v75
    s_waitcnt vmcnt(8)
    s_barrier
    s_add_u32 m0, s58, 114688
    s_nop 0
    buffer_load_dwordx4 v16, s[8:11], s59 offen offset:0  lds
    v_add_u32 v76, 32768, v52
    ds_read_b128 v[60:63], v76
    v_add_u32 v76, 32768, v53
    ds_read_b128 v[64:67], v76
    s_waitcnt lgkmcnt(0)
    v_lshlrev_b32 v68, 16, v60
    v_and_b32 v69, 0xffff0000, v60
    v_lshlrev_b32 v70, 16, v61
    v_and_b32 v71, 0xffff0000, v61
    buffer_load_dwordx4 v17, s[8:11], s59 offen offset:1024  lds
    v_lshlrev_b32 v72, 16, v62
    v_and_b32 v73, 0xffff0000, v62
    v_lshlrev_b32 v74, 16, v63
    v_and_b32 v75, 0xffff0000, v63
    v_add_f32 v54, v54, v68
    v_add_f32 v55, v55, v69
    v_fmac_f32 v56, v68, v68
    buffer_load_dwordx4 v18, s[8:11], s59 offen offset:2048  lds
    v_fmac_f32 v57, v69, v69
    v_add_f32 v54, v54, v70
    v_add_f32 v55, v55, v71
    v_fmac_f32 v56, v70, v70
    v_fmac_f32 v57, v71, v71
    v_add_f32 v54, v54, v72
    v_add_f32 v55, v55, v73
    s_mov_b64 exec, s[60:61]
    buffer_load_dwordx4 v19, s[8:11], s59 offen offset:3072  lds
    s_mov_b64 exec, -1
    v_fmac_f32 v56, v72, v72
    v_fmac_f32 v57, v73, v73
    v_add_f32 v54, v54, v74
    v_add_f32 v55, v55, v75
    v_fmac_f32 v56, v74, v74
    v_fmac_f32 v57, v75, v75
    s_add_u32 m0, s56, 98304
    s_nop 0
    buffer_load_dwordx4 v12, s[12:15], s57 offen offset:0  lds
    v_lshlrev_b32 v68, 16, v64
    v_and_b32 v69, 0xffff0000, v64
    v_lshlrev_b32 v70, 16, v65
    v_and_b32 v71, 0xffff0000, v65
    v_lshlrev_b32 v72, 16, v66
    v_and_b32 v73, 0xffff0000, v66
    buffer_load_dwordx4 v13, s[12:15], s57 offen offset:1024  lds
    v_lshlrev_b32 v74, 16, v67
    v_and_b32 v75, 0xffff0000, v67
    v_add_f32 v54, v54, v68
    v_add_f32 v55, v55, v69
    v_fmac_f32 v56, v68, v68
    v_fmac_f32 v57, v69, v69
    buffer_load_dwordx4 v14, s[12:15], s57 offen offset:2048  lds
    v_add_f32 v54, v54, v70
    v_add_f32 v55, v55, v71
    v_fmac_f32 v56, v70, v70
    v_fmac_f32 v57, v71, v71
    v_add_f32 v54, v54, v72
    v_add_f32 v55, v55, v73
    buffer_load_dwordx4 v15, s[12:15], s57 offen offset:3072  lds
    s_add_u32 s62, s62, 1
    s_and_b32 s62, s62, 7
    s_mul_i32 s57, s62, 131072
    s_lshl_b32 s59, s62, 7
    v_fmac_f32 v56, v72, v72
    v_fmac_f32 v57, v73, v73
    v_add_f32 v54, v54, v74
    v_add_f32 v55, v55, v75
    v_fmac_f32 v56, v74, v74
    v_fmac_f32 v57, v75, v75
    s_waitcnt vmcnt(8)
    s_barrier
    s_add_u32 m0, s58, 16384
    s_nop 0
    buffer_load_dwordx4 v16, s[8:11], s59 offen offset:0  lds
    v_add_u32 v76, 65536, v52
    ds_read_b128 v[60:63], v76
    v_add_u32 v76, 65536, v53
    ds_read_b128 v[64:67], v76
    s_waitcnt lgkmcnt(0)
    v_lshlrev_b32 v68, 16, v60
    v_and_b32 v69, 0xffff0000, v60
    v_lshlrev_b32 v70, 16, v61
    v_and_b32 v71, 0xffff0000, v61
    buffer_load_dwordx4 v17, s[8:11], s59 offen offset:1024  lds
    v_lshlrev_b32 v72, 16, v62
    v_and_b32 v73, 0xffff0000, v62
    v_lshlrev_b32 v74, 16, v63
    v_and_b32 v75, 0xffff0000, v63
    v_add_f32 v54, v54, v68
    v_add_f32 v55, v55, v69
    v_fmac_f32 v56, v68, v68
    buffer_load_dwordx4 v18, s[8:11], s59 offen offset:2048  lds
    v_fmac_f32 v57, v69, v69
    v_add_f32 v54, v54, v70
    v_add_f32 v55, v55, v71
    v_fmac_f32 v56, v70, v70
    v_fmac_f32 v57, v71, v71
    v_add_f32 v54, v54, v72
    v_add_f32 v55, v55, v73
    s_mov_b64 exec, s[60:61]
    buffer_load_dwordx4 v19, s[8:11], s59 offen offset:3072  lds
    s_mov_b64 exec, -1
    v_fmac_f32 v56, v72, v72
    v_fmac_f32 v57, v73, v73
    v_add_f32 v54, v54, v74
    v_add_f32 v55, v55, v75
    v_fmac_f32 v56, v74, v74
    v_fmac_f32 v57, v75, v75
    s_add_u32 m0, s56, 0
    s_nop 0
    buffer_load_dwordx4 v12, s[12:15], s57 offen offset:0  lds
    v_lshlrev_b32 v68, 16, v64
    v_and_b32 v69, 0xffff0000, v64
    v_lshlrev_b32 v70, 16, v65
    v_and_b32 v71, 0xffff0000, v65
    v_lshlrev_b32 v72, 16, v66
    v_and_b32 v73, 0xffff0000, v66
    buffer_load_dwordx4 v13, s[12:15], s57 offen offset:1024  lds
    v_lshlrev_b32 v74, 16, v67
    v_and_b32 v75, 0xffff0000, v67
    v_add_f32 v54, v54, v68
    v_add_f32 v55, v55, v69
    v_fmac_f32 v56, v68, v68
    v_fmac_f32 v57, v69, v69
    buffer_load_dwordx4 v14, s[12:15], s57 offen offset:2048  lds
    v_add_f32 v54, v54, v70
    v_add_f32 v55, v55, v71
    v_fmac_f32 v56, v70, v70
    v_fmac_f32 v57, v71, v71
    v_add_f32 v54, v54, v72
    v_add_f32 v55, v55, v73
    buffer_load_dwordx4 v15, s[12:15], s57 offen offset:3072  lds
    s_add_u32 s62, s62, 1
    s_and_b32 s62, s62, 7
    s_mul_i32 s57, s62, 131072
    s_lshl_b32 s59, s62, 7
    v_fmac_f32 v56, v72, v72
    v_fmac_f32 v57, v73, v73
    v_add_f32 v54, v54, v74
    v_add_f32 v55, v55, v75
    v_fmac_f32 v56, v74, v74
    v_fmac_f32 v57, v75, v75
    s_waitcnt vmcnt(8)
    s_barrier
    s_add_u32 m0, s58, 49152
    s_nop 0
    buffer_load_dwordx4 v16, s[8:11], s59 offen offset:0  lds
    v_add_u32 v76, 98304, v52
    ds_read_b128 v[60:63], v76
    v_add_u32 v76, 98304, v53
    ds_read_b128 v[64:67], v76
    s_waitcnt lgkmcnt(0)
    v_lshlrev_b32 v68, 16, v60
    v_and_b32 v69, 0xffff0000, v60
    v_lshlrev_b32 v70, 16, v61
    v_and_b32 v71, 0xffff0000, v61
    buffer_load_dwordx4 v17, s[8:11], s59 offen offset:1024  lds
    v_lshlrev_b32 v72, 16, v62
    v_and_b32 v73, 0xffff0000, v62
    v_lshlrev_b32 v74, 16, v63
    v_and_b32 v75, 0xffff0000, v63
    v_add_f32 v54, v54, v68
    v_add_f32 v55, v55, v69
    v_fmac_f32 v56, v68, v68
    buffer_load_dwordx4 v18, s[8:11], s59 offen offset:2048  lds
    v_fmac_f32 v57, v69, v69
    v_add_f32 v54, v54, v70
    v_add_f32 v55, v55, v71
    v_fmac_f32 v56, v70, v70
    v_fmac_f32 v57, v71, v71
    v_add_f32 v54, v54, v72
    v_add_f32 v55, v55, v73
    s_mov_b64 exec, s[60:61]
    buffer_load_dwordx4 v19, s[8:11], s59 offen offset:3072  lds
    s_mov_b64 exec, -1
    v_fmac_f32 v56, v72, v72
    v_fmac_f32 v57, v73, v73
    v_add_f32 v54, v54, v74
    v_add_f32 v55, v55, v75
    v_fmac_f32 v56, v74, v74
    v_fmac_f32 v57, v75, v75
    s_add_u32 m0, s56, 32768
    s_nop 0
    buffer_load_dwordx4 v12, s[12:15], s57 offen offset:0  lds
    v_lshlrev_b32 v68, 16, v64
    v_and_b32 v69, 0xffff0000, v64
    v_lshlrev_b32 v70, 16, v65
    v_and_b32 v71, 0xffff0000, v65
    v_lshlrev_b32 v72, 16, v66
    v_and_b32 v73, 0xffff0000, v66
    buffer_load_dwordx4 v13, s[12:15], s57 offen offset:1024  lds
    v_lshlrev_b32 v74, 16, v67
    v_and_b32 v75, 0xffff0000, v67
    v_add_f32 v54, v54, v68
    v_add_f32 v55, v55, v69
    v_fmac_f32 v56, v68, v68
    v_fmac_f32 v57, v69, v69
    buffer_load_dwordx4 v14, s[12:15], s57 offen offset:2048  lds
    v_add_f32 v54, v54, v70
    v_add_f32 v55, v55, v71
    v_fmac_f32 v56, v70, v70
    v_fmac_f32 v57, v71, v71
    v_add_f32 v54, v54, v72
    v_add_f32 v55, v55, v73
    buffer_load_dwordx4 v15, s[12:15], s57 offen offset:3072  lds
    s_add_u32 s62, s62, 1
    s_and_b32 s62, s62, 7
    s_mul_i32 s57, s62, 131072
    s_lshl_b32 s59, s62, 7
    v_fmac_f32 v56, v72, v72
    v_fmac_f32 v57, v73, v73
    v_add_f32 v54, v54, v74
    v_add_f32 v55, v55, v75
    v_fmac_f32 v56, v74, v74
    v_fmac_f32 v57, v75, v75
    s_cmp_lt_u32 s33, 16
    s_cbranch_scc0 .Lpf2_skip
    s_cmp_eq_u32 s25, 0
    s_cbranch_scc0 .Lpf2_skip
    s_getpc_b64 s[96:97]
.Lpf2_pc:
    s_add_u32 s96, s96, (k1_kernel - .Lpf2_pc) & 0xffffffff
    s_addc_u32 s97, s97, ((k1_kernel - .Lpf2_pc) >> 32) & 0xffffffff
    v_and_b32 v254, 63, v0
    s_lshl_b32 s98, s33, 6
    v_add_u32 v254, s98, v254
    v_lshlrev_b32 v254, 7, v254
    v_min_u32 v254, (k4_exit - k1_kernel - 4), v254
    global_load_dword v255, v254, s[96:97]
.Lpf2_skip:
    s_waitcnt vmcnt(8)
    s_barrier
    s_add_u32 m0, s58, 81920
    s_nop 0
    buffer_load_dwordx4 v16, s[8:11], s59 offen offset:0  lds
    ds_read_b128 v[60:63], v52 offset:0
    ds_read_b128 v[64:67], v53 offset:0
    s_waitcnt lgkmcnt(0)
    v_lshlrev_b32 v68, 16, v60
    v_and_b32 v69, 0xffff0000, v60
    v_lshlrev_b32 v70, 16, v61
    v_and_b32 v71, 0xffff0000, v61
    buffer_load_dwordx4 v17, s[8:11], s59 offen offset:1024  lds
    v_lshlrev_b32 v72, 16, v62
    v_and_b32 v73, 0xffff0000, v62
    v_lshlrev_b32 v74, 16, v63
    v_and_b32 v75, 0xffff0000, v63
    v_add_f32 v54, v54, v68
    v_add_f32 v55, v55, v69
    v_fmac_f32 v56, v68, v68
    buffer_load_dwordx4 v18, s[8:11], s59 offen offset:2048  lds
    v_fmac_f32 v57, v69, v69
    v_add_f32 v54, v54, v70
    v_add_f32 v55, v55, v71
    v_fmac_f32 v56, v70, v70
    v_fmac_f32 v57, v71, v71
    v_add_f32 v54, v54, v72
    v_add_f32 v55, v55, v73
    s_mov_b64 exec, s[60:61]
    buffer_load_dwordx4 v19, s[8:11], s59 offen offset:3072  lds
    s_mov_b64 exec, -1
    v_fmac_f32 v56, v72, v72
    v_fmac_f32 v57, v73, v73
    v_add_f32 v54, v54, v74
    v_add_f32 v55, v55, v75
    v_fmac_f32 v56, v74, v74
    v_fmac_f32 v57, v75, v75
    s_add_u32 m0, s56, 65536
    s_nop 0
    buffer_load_dwordx4 v12, s[12:15], s57 offen offset:0  lds
    v_lshlrev_b32 v68, 16, v64
    v_and_b32 v69, 0xffff0000, v64
    v_lshlrev_b32 v70, 16, v65
    v_and_b32 v71, 0xffff0000, v65
    v_lshlrev_b32 v72, 16, v66
    v_and_b32 v73, 0xffff0000, v66
    buffer_load_dwordx4 v13, s[12:15], s57 offen offset:1024  lds
    v_lshlrev_b32 v74, 16, v67
    v_and_b32 v75, 0xffff0000, v67
    v_add_f32 v54, v54, v68
    v_add_f32 v55, v55, v69
    v_fmac_f32 v56, v68, v68
    v_fmac_f32 v57, v69, v69
    buffer_load_dwordx4 v14, s[12:15], s57 offen offset:2048  lds
    v_add_f32 v54, v54, v70
    v_add_f32 v55, v55, v71
    v_fmac_f32 v56, v70, v70
    v_fmac_f32 v57, v71, v71
    v_add_f32 v54, v54, v72
    v_add_f32 v55, v55, v73
    buffer_load_dwordx4 v15, s[12:15], s57 offen offset:3072  lds
    s_add_u32 s62, s62, 1
    s_and_b32 s62, s62, 7
    s_mul_i32 s57, s62, 131072
    s_lshl_b32 s59, s62, 7
    v_fmac_f32 v56, v72, v72
    v_fmac_f32 v57, v73, v73
    v_add_f32 v54, v54, v74
    v_add_f32 v55, v55, v75
    v_fmac_f32 v56, v74, v74
    v_fmac_f32 v57, v75, v75
    s_waitcnt vmcnt(8)
    s_barrier
    s_add_u32 m0, s58, 114688
    s_nop 0
    buffer_load_dwordx4 v16, s[8:11], s59 offen offset:0  lds
    v_add_u32 v76, 32768, v52
    ds_read_b128 v[60:63], v76
    v_add_u32 v76, 32768, v53
    ds_read_b128 v[64:67], v76
    s_waitcnt lgkmcnt(0)
    v_lshlrev_b32 v68, 16, v60
    v_and_b32 v69, 0xffff0000, v60
    v_lshlrev_b32 v70, 16, v61
    v_and_b32 v71, 0xffff0000, v61
    buffer_load_dwordx4 v17, s[8:11], s59 offen offset:1024  lds
    v_lshlrev_b32 v72, 16, v62
    v_and_b32 v73, 0xffff0000, v62
    v_lshlrev_b32 v74, 16, v63
    v_and_b32 v75, 0xffff0000, v63
    v_add_f32 v54, v54, v68
    v_add_f32 v55, v55, v69
    v_fmac_f32 v56, v68, v68
    buffer_load_dwordx4 v18, s[8:11], s59 offen offset:2048  lds
    v_fmac_f32 v57, v69, v69
    v_add_f32 v54, v54, v70
    v_add_f32 v55, v55, v71
    v_fmac_f32 v56, v70, v70
    v_fmac_f32 v57, v71, v71
    v_add_f32 v54, v54, v72
    v_add_f32 v55, v55, v73
    s_mov_b64 exec, s[60:61]
    buffer_load_dwordx4 v19, s[8:11], s59 offen offset:3072  lds
    s_mov_b64 exec, -1
    v_fmac_f32 v56, v72, v72
    v_fmac_f32 v57, v73, v73
    v_add_f32 v54, v54, v74
    v_add_f32 v55, v55, v75
    v_fmac_f32 v56, v74, v74
    v_fmac_f32 v57, v75, v75
    s_add_u32 m0, s56, 98304
    s_nop 0
    buffer_load_dwordx4 v12, s[12:15], s57 offen offset:0  lds
    v_lshlrev_b32 v68, 16, v64
    v_and_b32 v69, 0xffff0000, v64
    v_lshlrev_b32 v70, 16, v65
    v_and_b32 v71, 0xffff0000, v65
    v_lshlrev_b32 v72, 16, v66
    v_and_b32 v73, 0xffff0000, v66
    buffer_load_dwordx4 v13, s[12:15], s57 offen offset:1024  lds
    v_lshlrev_b32 v74, 16, v67
    v_and_b32 v75, 0xffff0000, v67
    v_add_f32 v54, v54, v68
    v_add_f32 v55, v55, v69
    v_fmac_f32 v56, v68, v68
    v_fmac_f32 v57, v69, v69
    buffer_load_dwordx4 v14, s[12:15], s57 offen offset:2048  lds
    v_add_f32 v54, v54, v70
    v_add_f32 v55, v55, v71
    v_fmac_f32 v56, v70, v70
    v_fmac_f32 v57, v71, v71
    v_add_f32 v54, v54, v72
    v_add_f32 v55, v55, v73
    buffer_load_dwordx4 v15, s[12:15], s57 offen offset:3072  lds
    s_add_u32 s62, s62, 1
    s_and_b32 s62, s62, 7
    s_mul_i32 s57, s62, 131072
    s_lshl_b32 s59, s62, 7
    v_fmac_f32 v56, v72, v72
    v_fmac_f32 v57, v73, v73
    v_add_f32 v54, v54, v74
    v_add_f32 v55, v55, v75
    v_fmac_f32 v56, v74, v74
    v_fmac_f32 v57, v75, v75
    s_lshl_b32 s98, s2, 2
    s_add_u32 s98, s98, s25
    s_lshl_b32 s98, s98, 13
    v_and_b32 v4, 63, v0
    v_lshlrev_b32 v4, 7, v4
    v_add_u32 v4, s98, v4
    s_load_dwordx2 s[76:77], s[0:1], 40
    s_mov_b32 s78, 524288
    s_mov_b32 s79, 0x20000
    s_waitcnt lgkmcnt(0)
    buffer_load_dword v252, v4, s[76:79], 0 offen
    s_load_dwordx2 s[76:77], s[0:1], 56
    s_mov_b32 s78, 1048576
    s_mov_b32 s79, 0x20000
    s_waitcnt lgkmcnt(0)
    buffer_load_dword v252, v4, s[76:79], 0 offen
    s_load_dwordx2 s[76:77], s[0:1], 48
    s_mov_b32 s78, 63488
    s_mov_b32 s79, 0x20000
    s_waitcnt lgkmcnt(0)
    buffer_load_dword v252, v4, s[76:79], 0 offen
    s_waitcnt vmcnt(11)
    s_barrier
    v_add_u32 v76, 65536, v52
    ds_read_b128 v[60:63], v76
    v_add_u32 v76, 65536, v53
    ds_read_b128 v[64:67], v76
    s_waitcnt lgkmcnt(0)
    v_lshlrev_b32 v68, 16, v60
    v_and_b32 v69, 0xffff0000, v60
    v_lshlrev_b32 v70, 16, v61
    v_and_b32 v71, 0xffff0000, v61
    v_lshlrev_b32 v72, 16, v62
    v_and_b32 v73, 0xffff0000, v62
    v_lshlrev_b32 v74, 16, v63
    v_and_b32 v75, 0xffff0000, v63
    v_add_f32 v54, v54, v68
    v_add_f32 v55, v55, v69
    v_fmac_f32 v56, v68, v68
    v_fmac_f32 v57, v69, v69
    v_add_f32 v54, v54, v70
    v_add_f32 v55, v55, v71
    v_fmac_f32 v56, v70, v70
    v_fmac_f32 v57, v71, v71
    v_add_f32 v54, v54, v72
    v_add_f32 v55, v55, v73
    v_fmac_f32 v56, v72, v72
    v_fmac_f32 v57, v73, v73
    v_add_f32 v54, v54, v74
    v_add_f32 v55, v55, v75
    v_fmac_f32 v56, v74, v74
    v_fmac_f32 v57, v75, v75
    v_lshlrev_b32 v68, 16, v64
    v_and_b32 v69, 0xffff0000, v64
    v_lshlrev_b32 v70, 16, v65
    v_and_b32 v71, 0xffff0000, v65
    v_lshlrev_b32 v72, 16, v66
    v_and_b32 v73, 0xffff0000, v66
    v_lshlrev_b32 v74, 16, v67
    v_and_b32 v75, 0xffff0000, v67
    v_add_f32 v54, v54, v68
    v_add_f32 v55, v55, v69
    v_fmac_f32 v56, v68, v68
    v_fmac_f32 v57, v69, v69
    v_add_f32 v54, v54, v70
    v_add_f32 v55, v55, v71
    v_fmac_f32 v56, v70, v70
    v_fmac_f32 v57, v71, v71
    v_add_f32 v54, v54, v72
    v_add_f32 v55, v55, v73
    v_fmac_f32 v56, v72, v72
    v_fmac_f32 v57, v73, v73
    v_add_f32 v54, v54, v74
    v_add_f32 v55, v55, v75
    v_fmac_f32 v56, v74, v74
    v_fmac_f32 v57, v75, v75
    s_lshl_b32 s98, s33, 2
    s_add_u32 s98, s98, s25
    s_lshl_b32 s98, s98, 13
    v_and_b32 v4, 63, v0
    v_lshlrev_b32 v4, 7, v4
    v_add_u32 v4, s98, v4
    s_load_dwordx2 s[76:77], s[0:1], 16
    s_mov_b32 s78, 524288
    s_mov_b32 s79, 0x20000
    s_waitcnt lgkmcnt(0)
    buffer_load_dword v252, v4, s[76:79], 0 offen
    s_load_dwordx2 s[76:77], s[0:1], 32
    s_mov_b32 s78, 31744
    s_mov_b32 s79, 0x20000
    s_waitcnt lgkmcnt(0)
    buffer_load_dword v252, v4, s[76:79], 0 offen
    s_waitcnt vmcnt(5)
    s_barrier
    v_add_u32 v76, 98304, v52
    ds_read_b128 v[60:63], v76
    v_add_u32 v76, 98304, v53
    ds_read_b128 v[64:67], v76
    s_waitcnt lgkmcnt(0)
    v_lshlrev_b32 v68, 16, v60
    v_and_b32 v69, 0xffff0000, v60
    v_lshlrev_b32 v70, 16, v61
    v_and_b32 v71, 0xffff0000, v61
    v_lshlrev_b32 v72, 16, v62
    v_and_b32 v73, 0xffff0000, v62
    v_lshlrev_b32 v74, 16, v63
    v_and_b32 v75, 0xffff0000, v63
    v_add_f32 v54, v54, v68
    v_add_f32 v55, v55, v69
    v_fmac_f32 v56, v68, v68
    v_fmac_f32 v57, v69, v69
    v_add_f32 v54, v54, v70
    v_add_f32 v55, v55, v71
    v_fmac_f32 v56, v70, v70
    v_fmac_f32 v57, v71, v71
    v_add_f32 v54, v54, v72
    v_add_f32 v55, v55, v73
    v_fmac_f32 v56, v72, v72
    v_fmac_f32 v57, v73, v73
    v_add_f32 v54, v54, v74
    v_add_f32 v55, v55, v75
    v_fmac_f32 v56, v74, v74
    v_fmac_f32 v57, v75, v75
    v_lshlrev_b32 v68, 16, v64
    v_and_b32 v69, 0xffff0000, v64
    v_lshlrev_b32 v70, 16, v65
    v_and_b32 v71, 0xffff0000, v65
    v_lshlrev_b32 v72, 16, v66
    v_and_b32 v73, 0xffff0000, v66
    v_lshlrev_b32 v74, 16, v67
    v_and_b32 v75, 0xffff0000, v67
    v_add_f32 v54, v54, v68
    v_add_f32 v55, v55, v69
    v_fmac_f32 v56, v68, v68
    v_fmac_f32 v57, v69, v69
    v_add_f32 v54, v54, v70
    v_add_f32 v55, v55, v71
    v_fmac_f32 v56, v70, v70
    v_fmac_f32 v57, v71, v71
    v_add_f32 v54, v54, v72
    v_add_f32 v55, v55, v73
    v_fmac_f32 v56, v72, v72
    v_fmac_f32 v57, v73, v73
    v_add_f32 v54, v54, v74
    v_add_f32 v55, v55, v75
    v_fmac_f32 v56, v74, v74
    v_fmac_f32 v57, v75, v75
    v_add_f32 v76, v54, v55
    v_add_f32 v77, v56, v57
    s_nop 1
    v_add_f32_dpp v76, v76, v76 quad_perm:[1,0,3,2] row_mask:0xf bank_mask:0xf
    v_add_f32_dpp v77, v77, v77 quad_perm:[1,0,3,2] row_mask:0xf bank_mask:0xf
    s_nop 1
    v_add_f32_dpp v76, v76, v76 quad_perm:[2,3,0,1] row_mask:0xf bank_mask:0xf
    v_add_f32_dpp v77, v77, v77 quad_perm:[2,3,0,1] row_mask:0xf bank_mask:0xf
    v_mul_f32 v76, 989855744, v76
    v_mul_f32 v77, 989855744, v77
    v_fma_f32 v77, -v76, v76, v77
    v_max_f32 v77, 0, v77
    v_add_f32 v77, 925353388, v77
    v_rsq_f32 v78, v77
    s_nop 0
    v_mul_f32 v79, v76, v78
    v_lshrrev_b32 v80, 2, v0
    v_lshlrev_b32 v80, 3, v80
    v_add_u32 v80, 131840, v80
    ds_write_b64 v80, v[78:79]
    s_waitcnt lgkmcnt(0)
    s_barrier
    s_barrier
    s_lshr_b32 s99, s25, 1
    s_lshl_b32 s99, s99, 6
    s_and_b32 s66, s25, 1
    s_lshl_b32 s66, s66, 4
    s_add_u32 s66, s66, s99
    v_lshrrev_b32 v5, 4, v1
    v_and_b32 v4, 15, v1
    v_add_u32 v84, s66, v5
    v_mul_u32_u24 v6, 272, v84
    v_lshl_add_u32 v82, v4, 4, v6
    v_mul_u32_u24 v6, 5120, v84
    v_lshl_add_u32 v6, v4, 4, v6
    v_add_u32 v83, s27, v6
    ds_read_b128 v[20:23], v82 offset:0
    ds_read_b128 v[24:27], v82 offset:1088
    ds_read_b128 v[28:31], v82 offset:2176
    ds_read_b128 v[32:35], v82 offset:3264
    s_mov_b32 s64, 0
    s_waitcnt lgkmcnt(3)
    buffer_store_dwordx4 v[20:23], v83, s[16:19], s64 offen sc1
    s_mov_b32 s64, 20480
    s_waitcnt lgkmcnt(2)
    buffer_store_dwordx4 v[24:27], v83, s[16:19], s64 offen sc1
    s_mov_b32 s64, 40960
    s_waitcnt lgkmcnt(1)
    buffer_store_dwordx4 v[28:31], v83, s[16:19], s64 offen sc1
    s_mov_b32 s64, 61440
    s_waitcnt lgkmcnt(0)
    buffer_store_dwordx4 v[32:35], v83, s[16:19], s64 offen sc1
    s_barrier
    s_lshr_b32 s99, s20, 2
    s_lshl_b32 s99, s99, 6
    s_and_b32 s66, s20, 3
    s_lshl_b32 s66, s66, 3
    s_add_u32 s66, s66, s99
    s_add_u32 s66, s66, 32
    v_lshrrev_b32 v5, 4, v1
    v_and_b32 v4, 15, v1
    v_add_u32 v84, s66, v5
    v_mul_u32_u24 v6, 272, v84
    v_lshl_add_u32 v82, v4, 4, v6
    v_mul_u32_u24 v6, 5120, v84
    v_lshl_add_u32 v6, v4, 4, v6
    v_add_u32 v83, s27, v6
    ds_read_b128 v[20:23], v82 offset:0
    ds_read_b128 v[24:27], v82 offset:1088
    s_mov_b32 s64, 0
    s_waitcnt lgkmcnt(1)
    buffer_store_dwordx4 v[20:23], v83, s[16:19], s64 offen sc1
    v_add_u32 v4, 4, v84
    v_cmp_gt_u32 vcc, 125, v4
    v_mov_b32 v5, 0x80000000
    v_add_u32 v6, 20480, v83
    v_cndmask_b32 v6, v5, v6, vcc
    s_waitcnt lgkmcnt(0)
    buffer_store_dwordx4 v[24:27], v6, s[16:19], 0 offen sc1
    s_endpgm
k1_exit:
    s_endpgm
.globl k2_kernel
.p2align 8
.type k2_kernel,@function
k2_kernel:
    s_cmp_ge_u32 s2, 256
    s_cbranch_scc1 k2_exit
k2_begin:
    s_load_dwordx2 s[30:31], s[0:1], 80
    s_load_dwordx2 s[4:5], s[0:1], 16
    s_load_dwordx2 s[6:7], s[0:1], 32
    v_lshrrev_b32 v1, 6, v0
    s_and_b32 s32, s2, 7
    s_lshr_b32 s33, s2, 3
    v_readfirstlane_b32 s20, v1
    s_lshr_b32 s21, s32, 2
    s_and_b32 s34, s32, 3
    s_and_b32 s35, s33, 3
    s_bfe_u32 s36, s33, 0x20002
    s_and_b32 s37, s34, 1
    s_lshl_b32 s37, s37, 2
    s_add_u32 s23, s37, s35
    s_lshr_b32 s37, s34, 1
    s_lshl_b32 s37, s37, 2
    s_add_u32 s22, s37, s36
    s_lshl_b32 s24, s35, 1
    s_add_u32 s24, s24, s36
    s_and_b32 s24, s24, 7
    s_mov_b32 s24, 0
    s_cmp_ge_u32 s33, 16
    s_cbranch_scc1 k2_typeV
    s_lshl_b32 s99, s21, 10
    s_lshl_b32 s98, s22, 7
    s_add_u32 s99, s99, s98
    s_mul_i32 s26, s99, 2048
    s_lshl_b32 s98, s23, 8
    s_add_u32 s26, s26, s98
    s_and_b32 s25, s20, 3
    s_cmp_ge_u32 s20, 4
    s_cbranch_scc1 k2S_loader
    v_and_b32 v1, 63, v0
    s_and_b32 s56, s20, 1
    s_lshr_b32 s57, s20, 1
    v_and_b32 v4, 31, v1
    s_lshl_b32 s99, s56, 6
    v_add_u32 v156, s99, v4
    s_lshl_b32 s99, s57, 6
    v_add_u32 v157, s99, v4
    v_bfe_u32 v4, v156, 1, 3
    v_lshrrev_b32 v5, 5, v1
    v_xor_b32 v4, v4, v5
    v_lshlrev_b32 v4, 4, v4
    v_lshl_add_u32 v4, v156, 7, v4
    v_add_u32 v12, 0, v4
    v_add_u32 v16, 32768, v4
    v_add_u32 v20, 65536, v4
    v_add_u32 v24, 98304, v4
    v_xor_b32 v5, 32, v4
    v_add_u32 v13, 0, v5
    v_add_u32 v17, 32768, v5
    v_add_u32 v21, 65536, v5
    v_add_u32 v25, 98304, v5
    v_xor_b32 v5, 64, v4
    v_add_u32 v14, 0, v5
    v_add_u32 v18, 32768, v5
    v_add_u32 v22, 65536, v5
    v_add_u32 v26, 98304, v5
    v_xor_b32 v5, 96, v4
    v_add_u32 v15, 0, v5
    v_add_u32 v19, 32768, v5
    v_add_u32 v23, 65536, v5
    v_add_u32 v27, 98304, v5
    v_bfe_u32 v4, v157, 1, 3
    v_lshrrev_b32 v5, 5, v1
    v_xor_b32 v4, v4, v5
    v_lshlrev_b32 v4, 4, v4
    v_lshl_add_u32 v4, v157, 7, v4
    v_add_u32 v28, 16384, v4
    v_add_u32 v32, 49152, v4
    v_add_u32 v36, 81920, v4
    v_add_u32 v40, 114688, v4
    v_xor_b32 v5, 32, v4
    v_add_u32 v29, 16384, v5
    v_add_u32 v33, 49152, v5
    v_add_u32 v37, 81920, v5
    v_add_u32 v41, 114688, v5
    v_xor_b32 v5, 64, v4
    v_add_u32 v30, 16384, v5
    v_add_u32 v34, 49152, v5
    v_add_u32 v38, 81920, v5
    v_add_u32 v42, 114688, v5
    v_xor_b32 v5, 96, v4
    v_add_u32 v31, 16384, v5
    v_add_u32 v35, 49152, v5
    v_add_u32 v39, 81920, v5
    v_add_u32 v43, 114688, v5
    v_mul_u32_u24 v158, 272, v157
    v_lshrrev_b32 v4, 5, v1
    v_lshl_add_u32 v158, v4, 3, v158
    s_lshl_b32 s99, s56, 7
    v_add_u32 v158, s99, v158
    s_lshl_b32 s99, s21, 10
    s_lshl_b32 s98, s22, 7
    s_add_u32 s99, s99, s98
    v_add_u32 v159, s99, v157
    v_lshlrev_b32 v159, 6, v159
    s_lshl_b32 s99, s23, 3
    v_add_u32 v159, s99, v159
    v_lshlrev_b32 v4, 2, v157
    s_lshl_b32 s99, s56, 9
    s_add_u32 s99, s99, 131072
    v_add_u32 v160, s99, v4
    s_xor_b32 s99, s56, 1
    s_lshl_b32 s99, s99, 9
    s_add_u32 s99, s99, 131072
    v_add_u32 v161, s99, v4
    s_mov_b32 s60, 1031967726
    s_mov_b32 s61, 1031967726
    s_waitcnt lgkmcnt(0)
    s_add_u32 s12, s30, 11534336
    s_addc_u32 s13, s31, 0
    s_mov_b32 s14, 4194304
    s_mov_b32 s15, 0x20000
    s_add_u32 s16, s30, 15728640
    s_addc_u32 s17, s31, 0
    s_mov_b32 s18, 131072
    s_mov_b32 s19, 0x20000
    s_barrier
    ds_read_b128 v[108:111], v12 offset:0
    ds_read_b128 v[112:115], v12 offset:4096
    ds_read_b128 v[116:119], v28 offset:0
    ds_read_b128 v[120:123], v28 offset:4096
    ds_read_b128 v[124:127], v13 offset:0
    ds_read_b128 v[128:131], v13 offset:4096
    ds_read_b128 v[132:135], v29 offset:0
    ds_read_b128 v[136:139], v29 offset:4096
    s_waitcnt lgkmcnt(4)
    v_mfma_f32_32x32x16_bf16 v[44:59], v[108:111], v[116:119], 0
    ds_read_b128 v[140:143], v14 offset:0
    ds_read_b128 v[144:147], v14 offset:4096
    ds_read_b128 v[148:151], v30 offset:0
    v_mfma_f32_32x32x16_bf16 v[60:75], v[108:111], v[120:123], 0
    ds_read_b128 v[152:155], v30 offset:4096
    v_mfma_f32_32x32x16_bf16 v[76:91], v[112:115], v[116:119], 0
    v_mfma_f32_32x32x16_bf16 v[92:107], v[112:115], v[120:123], 0
    s_waitcnt lgkmcnt(4)
    v_mfma_f32_32x32x16_bf16 v[44:59], v[124:127], v[132:135], v[44:59]
    ds_read_b128 v[108:111], v15 offset:0
    ds_read_b128 v[112:115], v15 offset:4096
    ds_read_b128 v[116:119], v31 offset:0
    v_mfma_f32_32x32x16_bf16 v[60:75], v[124:127], v[136:139], v[60:75]
    ds_read_b128 v[120:123], v31 offset:4096
    v_mfma_f32_32x32x16_bf16 v[76:91], v[128:131], v[132:135], v[76:91]
    v_mfma_f32_32x32x16_bf16 v[92:107], v[128:131], v[136:139], v[92:107]
    s_waitcnt lgkmcnt(4)
    v_mfma_f32_32x32x16_bf16 v[44:59], v[140:143], v[148:151], v[44:59]
    s_barrier
    ds_read_b128 v[124:127], v16 offset:0
    ds_read_b128 v[128:131], v16 offset:4096
    ds_read_b128 v[132:135], v32 offset:0
    v_mfma_f32_32x32x16_bf16 v[60:75], v[140:143], v[152:155], v[60:75]
    ds_read_b128 v[136:139], v32 offset:4096
    v_mfma_f32_32x32x16_bf16 v[76:91], v[144:147], v[148:151], v[76:91]
    v_mfma_f32_32x32x16_bf16 v[92:107], v[144:147], v[152:155], v[92:107]
    s_waitcnt lgkmcnt(4)
    v_mfma_f32_32x32x16_bf16 v[44:59], v[108:111], v[116:119], v[44:59]
    ds_read_b128 v[140:143], v17 offset:0
    ds_read_b128 v[144:147], v17 offset:4096
    ds_read_b128 v[148:151], v33 offset:0
    v_mfma_f32_32x32x16_bf16 v[60:75], v[108:111], v[120:123], v[60:75]
    ds_read_b128 v[152:155], v33 offset:4096
    v_mfma_f32_32x32x16_bf16 v[76:91], v[112:115], v[116:119], v[76:91]
    v_mfma_f32_32x32x16_bf16 v[92:107], v[112:115], v[120:123], v[92:107]
    s_waitcnt lgkmcnt(4)
    v_mfma_f32_32x32x16_bf16 v[44:59], v[124:127], v[132:135], v[44:59]
    ds_read_b128 v[108:111], v18 offset:0
    ds_read_b128 v[112:115], v18 offset:4096
    ds_read_b128 v[116:119], v34 offset:0
    v_mfma_f32_32x32x16_bf16 v[60:75], v[124:127], v[136:139], v[60:75]
    ds_read_b128 v[120:123], v34 offset:4096
    v_mfma_f32_32x32x16_bf16 v[76:91], v[128:131], v[132:135], v[76:91]
    v_mfma_f32_32x32x16_bf16 v[92:107], v[128:131], v[136:139], v[92:107]
    s_waitcnt lgkmcnt(4)
    v_mfma_f32_32x32x16_bf16 v[44:59], v[140:143], v[148:151], v[44:59]
    ds_read_b128 v[124:127], v19 offset:0
    ds_read_b128 v[128:131], v19 offset:4096
    ds_read_b128 v[132:135], v35 offset:0
    v_mfma_f32_32x32x16_bf16 v[60:75], v[140:143], v[152:155], v[60:75]
    ds_read_b128 v[136:139], v35 offset:4096
    v_mfma_f32_32x32x16_bf16 v[76:91], v[144:147], v[148:151], v[76:91]
    v_mfma_f32_32x32x16_bf16 v[92:107], v[144:147], v[152:155], v[92:107]
    s_waitcnt lgkmcnt(4)
    v_mfma_f32_32x32x16_bf16 v[44:59], v[108:111], v[116:119], v[44:59]
    s_barrier
    ds_read_b128 v[140:143], v20 offset:0
    ds_read_b128 v[144:147], v20 offset:4096
    ds_read_b128 v[148:151], v36 offset:0
    v_mfma_f32_32x32x16_bf16 v[60:75], v[108:111], v[120:123], v[60:75]
    ds_read_b128 v[152:155], v36 offset:4096
    v_mfma_f32_32x32x16_bf16 v[76:91], v[112:115], v[116:119], v[76:91]
    v_mfma_f32_32x32x16_bf16 v[92:107], v[112:115], v[120:123], v[92:107]
    s_waitcnt lgkmcnt(4)
    v_mfma_f32_32x32x16_bf16 v[44:59], v[124:127], v[132:135], v[44:59]
    ds_read_b128 v[108:111], v21 offset:0
    ds_read_b128 v[112:115], v21 offset:4096
    ds_read_b128 v[116:119], v37 offset:0
    v_mfma_f32_32x32x16_bf16 v[60:75], v[124:127], v[136:139], v[60:75]
    ds_read_b128 v[120:123], v37 offset:4096
    v_mfma_f32_32x32x16_bf16 v[76:91], v[128:131], v[132:135], v[76:91]
    v_mfma_f32_32x32x16_bf16 v[92:107], v[128:131], v[136:139], v[92:107]
    s_waitcnt lgkmcnt(4)
    v_mfma_f32_32x32x16_bf16 v[44:59], v[140:143], v[148:151], v[44:59]
    ds_read_b128 v[124:127], v22 offset:0
    ds_read_b128 v[128:131], v22 offset:4096
    ds_read_b128 v[132:135], v38 offset:0
    v_mfma_f32_32x32x16_bf16 v[60:75], v[140:143], v[152:155], v[60:75]
    ds_read_b128 v[136:139], v38 offset:4096
    v_mfma_f32_32x32x16_bf16 v[76:91], v[144:147], v[148:151], v[76:91]
    v_mfma_f32_32x32x16_bf16 v[92:107], v[144:147], v[152:155], v[92:107]
    s_waitcnt lgkmcnt(4)
    v_mfma_f32_32x32x16_bf16 v[44:59], v[108:111], v[116:119], v[44:59]
    ds_read_b128 v[140:143], v23 offset:0
    ds_read_b128 v[144:147], v23 offset:4096
    ds_read_b128 v[148:151], v39 offset:0
    v_mfma_f32_32x32x16_bf16 v[60:75], v[108:111], v[120:123], v[60:75]
    ds_read_b128 v[152:155], v39 offset:4096
    v_mfma_f32_32x32x16_bf16 v[76:91], v[112:115], v[116:119], v[76:91]
    v_mfma_f32_32x32x16_bf16 v[92:107], v[112:115], v[120:123], v[92:107]
    s_waitcnt lgkmcnt(4)
    v_mfma_f32_32x32x16_bf16 v[44:59], v[124:127], v[132:135], v[44:59]
    s_barrier
    ds_read_b128 v[108:111], v24 offset:0
    ds_read_b128 v[112:115], v24 offset:4096
    ds_read_b128 v[116:119], v40 offset:0
    v_mfma_f32_32x32x16_bf16 v[60:75], v[124:127], v[136:139], v[60:75]
    ds_read_b128 v[120:123], v40 offset:4096
    v_mfma_f32_32x32x16_bf16 v[76:91], v[128:131], v[132:135], v[76:91]
    v_mfma_f32_32x32x16_bf16 v[92:107], v[128:131], v[136:139], v[92:107]
    s_waitcnt lgkmcnt(4)
    v_mfma_f32_32x32x16_bf16 v[44:59], v[140:143], v[148:151], v[44:59]
    ds_read_b128 v[124:127], v25 offset:0
    ds_read_b128 v[128:131], v25 offset:4096
    ds_read_b128 v[132:135], v41 offset:0
    v_mfma_f32_32x32x16_bf16 v[60:75], v[140:143], v[152:155], v[60:75]
    ds_read_b128 v[136:139], v41 offset:4096
    v_mfma_f32_32x32x16_bf16 v[76:91], v[144:147], v[148:151], v[76:91]
    v_mfma_f32_32x32x16_bf16 v[92:107], v[144:147], v[152:155], v[92:107]
    s_waitcnt lgkmcnt(4)
    v_mfma_f32_32x32x16_bf16 v[44:59], v[108:111], v[116:119], v[44:59]
    ds_read_b128 v[140:143], v26 offset:0
    ds_read_b128 v[144:147], v26 offset:4096
    ds_read_b128 v[148:151], v42 offset:0
    v_mfma_f32_32x32x16_bf16 v[60:75], v[108:111], v[120:123], v[60:75]
    ds_read_b128 v[152:155], v42 offset:4096
    v_mfma_f32_32x32x16_bf16 v[76:91], v[112:115], v[116:119], v[76:91]
    v_mfma_f32_32x32x16_bf16 v[92:107], v[112:115], v[120:123], v[92:107]
    s_waitcnt lgkmcnt(4)
    v_mfma_f32_32x32x16_bf16 v[44:59], v[124:127], v[132:135], v[44:59]
    ds_read_b128 v[108:111], v27 offset:0
    ds_read_b128 v[112:115], v27 offset:4096
    ds_read_b128 v[116:119], v43 offset:0
    v_mfma_f32_32x32x16_bf16 v[60:75], v[124:127], v[136:139], v[60:75]
    ds_read_b128 v[120:123], v43 offset:4096
    v_mfma_f32_32x32x16_bf16 v[76:91], v[128:131], v[132:135], v[76:91]
    v_mfma_f32_32x32x16_bf16 v[92:107], v[128:131], v[136:139], v[92:107]
    s_waitcnt lgkmcnt(4)
    v_mfma_f32_32x32x16_bf16 v[44:59], v[140:143], v[148:151], v[44:59]
    s_barrier
    ds_read_b128 v[124:127], v12 offset:0
    ds_read_b128 v[128:131], v12 offset:4096
    ds_read_b128 v[132:135], v28 offset:0
    v_mfma_f32_32x32x16_bf16 v[60:75], v[140:143], v[152:155], v[60:75]
    ds_read_b128 v[136:139], v28 offset:4096
    v_mfma_f32_32x32x16_bf16 v[76:91], v[144:147], v[148:151], v[76:91]
    v_mfma_f32_32x32x16_bf16 v[92:107], v[144:147], v[152:155], v[92:107]
    s_waitcnt lgkmcnt(4)
    v_mfma_f32_32x32x16_bf16 v[44:59], v[108:111], v[116:119], v[44:59]
    ds_read_b128 v[140:143], v13 offset:0
    ds_read_b128 v[144:147], v13 offset:4096
    ds_read_b128 v[148:151], v29 offset:0
    v_mfma_f32_32x32x16_bf16 v[60:75], v[108:111], v[120:123], v[60:75]
    ds_read_b128 v[152:155], v29 offset:4096
    v_mfma_f32_32x32x16_bf16 v[76:91], v[112:115], v[116:119], v[76:91]
    v_mfma_f32_32x32x16_bf16 v[92:107], v[112:115], v[120:123], v[92:107]
    s_waitcnt lgkmcnt(4)
    v_mfma_f32_32x32x16_bf16 v[44:59], v[124:127], v[132:135], v[44:59]
    ds_read_b128 v[108:111], v14 offset:0
    ds_read_b128 v[112:115], v14 offset:4096
    ds_read_b128 v[116:119], v30 offset:0
    v_mfma_f32_32x32x16_bf16 v[60:75], v[124:127], v[136:139], v[60:75]
    ds_read_b128 v[120:123], v30 offset:4096
    v_mfma_f32_32x32x16_bf16 v[76:91], v[128:131], v[132:135], v[76:91]
    v_mfma_f32_32x32x16_bf16 v[92:107], v[128:131], v[136:139], v[92:107]
    s_waitcnt lgkmcnt(4)
    v_mfma_f32_32x32x16_bf16 v[44:59], v[140:143], v[148:151], v[44:59]
    ds_read_b128 v[124:127], v15 offset:0
    ds_read_b128 v[128:131], v15 offset:4096
    ds_read_b128 v[132:135], v31 offset:0
    v_mfma_f32_32x32x16_bf16 v[60:75], v[140:143], v[152:155], v[60:75]
    ds_read_b128 v[136:139], v31 offset:4096
    v_mfma_f32_32x32x16_bf16 v[76:91], v[144:147], v[148:151], v[76:91]
    v_mfma_f32_32x32x16_bf16 v[92:107], v[144:147], v[152:155], v[92:107]
    s_waitcnt lgkmcnt(4)
    v_mfma_f32_32x32x16_bf16 v[44:59], v[108:111], v[116:119], v[44:59]
    s_barrier
    ds_read_b128 v[140:143], v16 offset:0
    ds_read_b128 v[144:147], v16 offset:4096
    ds_read_b128 v[148:151], v32 offset:0
    v_mfma_f32_32x32x16_bf16 v[60:75], v[108:111], v[120:123], v[60:75]
    ds_read_b128 v[152:155], v32 offset:4096
    v_mfma_f32_32x32x16_bf16 v[76:91], v[112:115], v[116:119], v[76:91]
    v_mfma_f32_32x32x16_bf16 v[92:107], v[112:115], v[120:123], v[92:107]
    s_waitcnt lgkmcnt(4)
    v_mfma_f32_32x32x16_bf16 v[44:59], v[124:127], v[132:135], v[44:59]
    ds_read_b128 v[108:111], v17 offset:0
    ds_read_b128 v[112:115], v17 offset:4096
    ds_read_b128 v[116:119], v33 offset:0
    v_mfma_f32_32x32x16_bf16 v[60:75], v[124:127], v[136:139], v[60:75]
    ds_read_b128 v[120:123], v33 offset:4096
    v_mfma_f32_32x32x16_bf16 v[76:91], v[128:131], v[132:135], v[76:91]
    v_mfma_f32_32x32x16_bf16 v[92:107], v[128:131], v[136:139], v[92:107]
    s_waitcnt lgkmcnt(4)
    v_mfma_f32_32x32x16_bf16 v[44:59], v[140:143], v[148:151], v[44:59]
    ds_read_b128 v[124:127], v18 offset:0
    ds_read_b128 v[128:131], v18 offset:4096
    ds_read_b128 v[132:135], v34 offset:0
    v_mfma_f32_32x32x16_bf16 v[60:75], v[140:143], v[152:155], v[60:75]
    ds_read_b128 v[136:139], v34 offset:4096
    v_mfma_f32_32x32x16_bf16 v[76:91], v[144:147], v[148:151], v[76:91]
    v_mfma_f32_32x32x16_bf16 v[92:107], v[144:147], v[152:155], v[92:107]
    s_waitcnt lgkmcnt(4)
    v_mfma_f32_32x32x16_bf16 v[44:59], v[108:111], v[116:119], v[44:59]
    ds_read_b128 v[140:143], v19 offset:0
    ds_read_b128 v[144:147], v19 offset:4096
    ds_read_b128 v[148:151], v35 offset:0
    v_mfma_f32_32x32x16_bf16 v[60:75], v[108:111], v[120:123], v[60:75]
    ds_read_b128 v[152:155], v35 offset:4096
    v_mfma_f32_32x32x16_bf16 v[76:91], v[112:115], v[116:119], v[76:91]
    v_mfma_f32_32x32x16_bf16 v[92:107], v[112:115], v[120:123], v[92:107]
    s_waitcnt lgkmcnt(4)
    v_mfma_f32_32x32x16_bf16 v[44:59], v[124:127], v[132:135], v[44:59]
    s_barrier
    ds_read_b128 v[108:111], v20 offset:0
    ds_read_b128 v[112:115], v20 offset:4096
    ds_read_b128 v[116:119], v36 offset:0
    v_mfma_f32_32x32x16_bf16 v[60:75], v[124:127], v[136:139], v[60:75]
    ds_read_b128 v[120:123], v36 offset:4096
    v_mfma_f32_32x32x16_bf16 v[76:91], v[128:131], v[132:135], v[76:91]
    v_mfma_f32_32x32x16_bf16 v[92:107], v[128:131], v[136:139], v[92:107]
    s_waitcnt lgkmcnt(4)
    v_mfma_f32_32x32x16_bf16 v[44:59], v[140:143], v[148:151], v[44:59]
    ds_read_b128 v[124:127], v21 offset:0
    ds_read_b128 v[128:131], v21 offset:4096
    ds_read_b128 v[132:135], v37 offset:0
    v_mfma_f32_32x32x16_bf16 v[60:75], v[140:143], v[152:155], v[60:75]
    ds_read_b128 v[136:139], v37 offset:4096
    v_mfma_f32_32x32x16_bf16 v[76:91], v[144:147], v[148:151], v[76:91]
    v_mfma_f32_32x32x16_bf16 v[92:107], v[144:147], v[152:155], v[92:107]
    s_waitcnt lgkmcnt(4)
    v_mfma_f32_32x32x16_bf16 v[44:59], v[108:111], v[116:119], v[44:59]
    ds_read_b128 v[140:143], v22 offset:0
    ds_read_b128 v[144:147], v22 offset:4096
    ds_read_b128 v[148:151], v38 offset:0
    v_mfma_f32_32x32x16_bf16 v[60:75], v[108:111], v[120:123], v[60:75]
    ds_read_b128 v[152:155], v38 offset:4096
    v_mfma_f32_32x32x16_bf16 v[76:91], v[112:115], v[116:119], v[76:91]
    v_mfma_f32_32x32x16_bf16 v[92:107], v[112:115], v[120:123], v[92:107]
    s_waitcnt lgkmcnt(4)
    v_mfma_f32_32x32x16_bf16 v[44:59], v[124:127], v[132:135], v[44:59]
    ds_read_b128 v[108:111], v23 offset:0
    ds_read_b128 v[112:115], v23 offset:4096
    ds_read_b128 v[116:119], v39 offset:0
    v_mfma_f32_32x32x16_bf16 v[60:75], v[124:127], v[136:139], v[60:75]
    ds_read_b128 v[120:123], v39 offset:4096
    v_mfma_f32_32x32x16_bf16 v[76:91], v[128:131], v[132:135], v[76:91]
    v_mfma_f32_32x32x16_bf16 v[92:107], v[128:131], v[136:139], v[92:107]
    s_waitcnt lgkmcnt(4)
    v_mfma_f32_32x32x16_bf16 v[44:59], v[140:143], v[148:151], v[44:59]
    s_barrier
    ds_read_b128 v[124:127], v24 offset:0
    ds_read_b128 v[128:131], v24 offset:4096
    ds_read_b128 v[132:135], v40 offset:0
    v_mfma_f32_32x32x16_bf16 v[60:75], v[140:143], v[152:155], v[60:75]
    ds_read_b128 v[136:139], v40 offset:4096
    v_mfma_f32_32x32x16_bf16 v[76:91], v[144:147], v[148:151], v[76:91]
    v_mfma_f32_32x32x16_bf16 v[92:107], v[144:147], v[152:155], v[92:107]
    s_waitcnt lgkmcnt(4)
    v_mfma_f32_32x32x16_bf16 v[44:59], v[108:111], v[116:119], v[44:59]
    ds_read_b128 v[140:143], v25 offset:0
    ds_read_b128 v[144:147], v25 offset:4096
    ds_read_b128 v[148:151], v41 offset:0
    v_mfma_f32_32x32x16_bf16 v[60:75], v[108:111], v[120:123], v[60:75]
    ds_read_b128 v[152:155], v41 offset:4096
    v_mfma_f32_32x32x16_bf16 v[76:91], v[112:115], v[116:119], v[76:91]
    v_mfma_f32_32x32x16_bf16 v[92:107], v[112:115], v[120:123], v[92:107]
    s_waitcnt lgkmcnt(4)
    v_mfma_f32_32x32x16_bf16 v[44:59], v[124:127], v[132:135], v[44:59]
    ds_read_b128 v[108:111], v26 offset:0
    ds_read_b128 v[112:115], v26 offset:4096
    ds_read_b128 v[116:119], v42 offset:0
    v_mfma_f32_32x32x16_bf16 v[60:75], v[124:127], v[136:139], v[60:75]
    ds_read_b128 v[120:123], v42 offset:4096
    v_mfma_f32_32x32x16_bf16 v[76:91], v[128:131], v[132:135], v[76:91]
    v_mfma_f32_32x32x16_bf16 v[92:107], v[128:131], v[136:139], v[92:107]
    s_waitcnt lgkmcnt(4)
    v_mfma_f32_32x32x16_bf16 v[44:59], v[140:143], v[148:151], v[44:59]
    ds_read_b128 v[124:127], v27 offset:0
    ds_read_b128 v[128:131], v27 offset:4096
    ds_read_b128 v[132:135], v43 offset:0
    v_mfma_f32_32x32x16_bf16 v[60:75], v[140:143], v[152:155], v[60:75]
    ds_read_b128 v[136:139], v43 offset:4096
    v_mfma_f32_32x32x16_bf16 v[76:91], v[144:147], v[148:151], v[76:91]
    v_mfma_f32_32x32x16_bf16 v[92:107], v[144:147], v[152:155], v[92:107]
    s_waitcnt lgkmcnt(4)
    v_mfma_f32_32x32x16_bf16 v[44:59], v[108:111], v[116:119], v[44:59]
    v_mfma_f32_32x32x16_bf16 v[60:75], v[108:111], v[120:123], v[60:75]
    v_mfma_f32_32x32x16_bf16 v[76:91], v[112:115], v[116:119], v[76:91]
    v_mfma_f32_32x32x16_bf16 v[92:107], v[112:115], v[120:123], v[92:107]
    s_waitcnt lgkmcnt(0)
    v_mfma_f32_32x32x16_bf16 v[44:59], v[124:127], v[132:135], v[44:59]
    v_mfma_f32_32x32x16_bf16 v[60:75], v[124:127], v[136:139], v[60:75]
    v_mfma_f32_32x32x16_bf16 v[76:91], v[128:131], v[132:135], v[76:91]
    v_mfma_f32_32x32x16_bf16 v[92:107], v[128:131], v[136:139], v[92:107]
    s_nop 7
    s_nop 3
    s_cmp_eq_u32 s23, 7
    s_cbranch_scc0 k2S_nomask
    s_cmp_eq_u32 s56, 1
    s_cbranch_scc0 k2S_nomask
    v_mov_b32 v80, 0xff800000
    v_mov_b32 v81, 0xff800000
    v_mov_b32 v82, 0xff800000
    v_mov_b32 v83, 0xff800000
    v_mov_b32 v84, 0xff800000
    v_mov_b32 v85, 0xff800000
    v_mov_b32 v86, 0xff800000
    v_mov_b32 v87, 0xff800000
    v_mov_b32 v88, 0xff800000
    v_mov_b32 v89, 0xff800000
    v_mov_b32 v90, 0xff800000
    v_mov_b32 v91, 0xff800000
    v_mov_b32 v96, 0xff800000
    v_mov_b32 v97, 0xff800000
    v_mov_b32 v98, 0xff800000
    v_mov_b32 v99, 0xff800000
    v_mov_b32 v100, 0xff800000
    v_mov_b32 v101, 0xff800000
    v_mov_b32 v102, 0xff800000
    v_mov_b32 v103, 0xff800000
    v_mov_b32 v104, 0xff800000
    v_mov_b32 v105, 0xff800000
    v_mov_b32 v106, 0xff800000
    v_mov_b32 v107, 0xff800000
k2S_nomask:
    v_max3_f32 v162, v44, v45, v46
    v_max3_f32 v163, v47, v48, v49
    v_max3_f32 v162, v162, v50, v51
    v_max3_f32 v163, v163, v52, v53
    v_max3_f32 v162, v162, v54, v55
    v_max3_f32 v163, v163, v56, v57
    v_max3_f32 v162, v162, v58, v59
    v_max3_f32 v163, v163, v76, v77
    v_max3_f32 v162, v162, v78, v79
    v_max3_f32 v163, v163, v80, v81
    v_max3_f32 v162, v162, v82, v83
    v_max3_f32 v163, v163, v84, v85
    v_max3_f32 v162, v162, v86, v87
    v_max3_f32 v163, v163, v88, v89
    v_max3_f32 v162, v162, v90, v91
    v_max_f32 v162, v162, v163
    v_mov_b32 v4, v162
    s_nop 1
    v_permlane32_swap_b32 v162, v4
    s_nop 1
    v_max_f32 v162, v162, v4
    ds_write_b32 v160, v162 offset:0
    v_max3_f32 v164, v60, v61, v62
    v_max3_f32 v165, v63, v64, v65
    v_max3_f32 v164, v164, v66, v67
    v_max3_f32 v165, v165, v68, v69
    v_max3_f32 v164, v164, v70, v71
    v_max3_f32 v165, v165, v72, v73
    v_max3_f32 v164, v164, v74, v75
    v_max3_f32 v165, v165, v92, v93
    v_max3_f32 v164, v164, v94, v95
    v_max3_f32 v165, v165, v96, v97
    v_max3_f32 v164, v164, v98, v99
    v_max3_f32 v165, v165, v100, v101
    v_max3_f32 v164, v164, v102, v103
    v_max3_f32 v165, v165, v104, v105
    v_max3_f32 v164, v164, v106, v107
    v_max_f32 v164, v164, v165
    v_mov_b32 v4, v164
    s_nop 1
    v_permlane32_swap_b32 v164, v4
    s_nop 1
    v_max_f32 v164, v164, v4
    ds_write_b32 v160, v164 offset:128
    s_waitcnt lgkmcnt(0)
    s_barrier
    ds_read_b32 v178, v161 offset:0
    ds_read_b32 v179, v161 offset:128
    s_waitcnt lgkmcnt(0)
    v_max_f32 v162, v162, v178
    v_mul_f32 v162, 1031967726, v162
    v_sub_f32 v163, 0, v162
    v_mov_b32 v166, 0
    v_mov_b32 v167, 0
    v_pk_fma_f32 v[44:45], v[44:45], s[60:61], v[162:163] op_sel:[0,0,1] op_sel_hi:[1,1,1]
    v_pk_fma_f32 v[46:47], v[46:47], s[60:61], v[162:163] op_sel:[0,0,1] op_sel_hi:[1,1,1]
    v_pk_fma_f32 v[48:49], v[48:49], s[60:61], v[162:163] op_sel:[0,0,1] op_sel_hi:[1,1,1]
    v_pk_fma_f32 v[50:51], v[50:51], s[60:61], v[162:163] op_sel:[0,0,1] op_sel_hi:[1,1,1]
    v_pk_fma_f32 v[52:53], v[52:53], s[60:61], v[162:163] op_sel:[0,0,1] op_sel_hi:[1,1,1]
    v_pk_fma_f32 v[54:55], v[54:55], s[60:61], v[162:163] op_sel:[0,0,1] op_sel_hi:[1,1,1]
    v_pk_fma_f32 v[56:57], v[56:57], s[60:61], v[162:163] op_sel:[0,0,1] op_sel_hi:[1,1,1]
    v_pk_fma_f32 v[58:59], v[58:59], s[60:61], v[162:163] op_sel:[0,0,1] op_sel_hi:[1,1,1]
    v_exp_f32 v44, v44
    v_exp_f32 v45, v45
    v_exp_f32 v46, v46
    v_exp_f32 v47, v47
    v_exp_f32 v48, v48
    v_exp_f32 v49, v49
    v_exp_f32 v50, v50
    v_exp_f32 v51, v51
    v_exp_f32 v52, v52
    v_exp_f32 v53, v53
    v_exp_f32 v54, v54
    v_exp_f32 v55, v55
    v_exp_f32 v56, v56
    v_exp_f32 v57, v57
    v_exp_f32 v58, v58
    v_exp_f32 v59, v59
    v_pk_add_f32 v[166:167], v[166:167], v[44:45]
    v_pk_add_f32 v[166:167], v[166:167], v[46:47]
    v_pk_add_f32 v[166:167], v[166:167], v[48:49]
    v_pk_add_f32 v[166:167], v[166:167], v[50:51]
    v_pk_add_f32 v[166:167], v[166:167], v[52:53]
    v_pk_add_f32 v[166:167], v[166:167], v[54:55]
    v_pk_add_f32 v[166:167], v[166:167], v[56:57]
    v_pk_add_f32 v[166:167], v[166:167], v[58:59]
    v_cvt_pk_bf16_f32 v170, v44, v45
    v_cvt_pk_bf16_f32 v171, v46, v47
    v_cvt_pk_bf16_f32 v172, v48, v49
    v_cvt_pk_bf16_f32 v173, v50, v51
    v_cvt_pk_bf16_f32 v174, v52, v53
    v_cvt_pk_bf16_f32 v175, v54, v55
    v_cvt_pk_bf16_f32 v176, v56, v57
    v_cvt_pk_bf16_f32 v177, v58, v59
    ds_write_b64 v158, v[170:171] offset:0
    ds_write_b64 v158, v[172:173] offset:16
    ds_write_b64 v158, v[174:175] offset:32
    ds_write_b64 v158, v[176:177] offset:48
    v_pk_fma_f32 v[76:77], v[76:77], s[60:61], v[162:163] op_sel:[0,0,1] op_sel_hi:[1,1,1]
    v_pk_fma_f32 v[78:79], v[78:79], s[60:61], v[162:163] op_sel:[0,0,1] op_sel_hi:[1,1,1]
    v_pk_fma_f32 v[80:81], v[80:81], s[60:61], v[162:163] op_sel:[0,0,1] op_sel_hi:[1,1,1]
    v_pk_fma_f32 v[82:83], v[82:83], s[60:61], v[162:163] op_sel:[0,0,1] op_sel_hi:[1,1,1]
    v_pk_fma_f32 v[84:85], v[84:85], s[60:61], v[162:163] op_sel:[0,0,1] op_sel_hi:[1,1,1]
    v_pk_fma_f32 v[86:87], v[86:87], s[60:61], v[162:163] op_sel:[0,0,1] op_sel_hi:[1,1,1]
    v_pk_fma_f32 v[88:89], v[88:89], s[60:61], v[162:163] op_sel:[0,0,1] op_sel_hi:[1,1,1]
    v_pk_fma_f32 v[90:91], v[90:91], s[60:61], v[162:163] op_sel:[0,0,1] op_sel_hi:[1,1,1]
    v_exp_f32 v76, v76
    v_exp_f32 v77, v77
    v_exp_f32 v78, v78
    v_exp_f32 v79, v79
    v_exp_f32 v80, v80
    v_exp_f32 v81, v81
    v_exp_f32 v82, v82
    v_exp_f32 v83, v83
    v_exp_f32 v84, v84
    v_exp_f32 v85, v85
    v_exp_f32 v86, v86
    v_exp_f32 v87, v87
    v_exp_f32 v88, v88
    v_exp_f32 v89, v89
    v_exp_f32 v90, v90
    v_exp_f32 v91, v91
    v_pk_add_f32 v[166:167], v[166:167], v[76:77]
    v_pk_add_f32 v[166:167], v[166:167], v[78:79]
    v_pk_add_f32 v[166:167], v[166:167], v[80:81]
    v_pk_add_f32 v[166:167], v[166:167], v[82:83]
    v_pk_add_f32 v[166:167], v[166:167], v[84:85]
    v_pk_add_f32 v[166:167], v[166:167], v[86:87]
    v_pk_add_f32 v[166:167], v[166:167], v[88:89]
    v_pk_add_f32 v[166:167], v[166:167], v[90:91]
    v_cvt_pk_bf16_f32 v170, v76, v77
    v_cvt_pk_bf16_f32 v171, v78, v79
    v_cvt_pk_bf16_f32 v172, v80, v81
    v_cvt_pk_bf16_f32 v173, v82, v83
    v_cvt_pk_bf16_f32 v174, v84, v85
    v_cvt_pk_bf16_f32 v175, v86, v87
    v_cvt_pk_bf16_f32 v176, v88, v89
    v_cvt_pk_bf16_f32 v177, v90, v91
    ds_write_b64 v158, v[170:171] offset:64
    ds_write_b64 v158, v[172:173] offset:80
    ds_write_b64 v158, v[174:175] offset:96
    ds_write_b64 v158, v[176:177] offset:112
    v_add_f32 v166, v166, v167
    v_mov_b32 v4, v166
    s_nop 1
    v_permlane32_swap_b32 v166, v4
    s_nop 1
    v_add_f32 v166, v166, v4
    ds_write_b32 v160, v166 offset:1024
    s_waitcnt lgkmcnt(0)
    s_barrier
    v_max_f32 v164, v164, v179
    v_mul_f32 v164, 1031967726, v164
    v_sub_f32 v165, 0, v164
    v_mov_b32 v168, 0
    v_mov_b32 v169, 0
    v_pk_fma_f32 v[60:61], v[60:61], s[60:61], v[164:165] op_sel:[0,0,1] op_sel_hi:[1,1,1]
    v_pk_fma_f32 v[62:63], v[62:63], s[60:61], v[164:165] op_sel:[0,0,1] op_sel_hi:[1,1,1]
    v_pk_fma_f32 v[64:65], v[64:65], s[60:61], v[164:165] op_sel:[0,0,1] op_sel_hi:[1,1,1]
    v_pk_fma_f32 v[66:67], v[66:67], s[60:61], v[164:165] op_sel:[0,0,1] op_sel_hi:[1,1,1]
    v_pk_fma_f32 v[68:69], v[68:69], s[60:61], v[164:165] op_sel:[0,0,1] op_sel_hi:[1,1,1]
    v_pk_fma_f32 v[70:71], v[70:71], s[60:61], v[164:165] op_sel:[0,0,1] op_sel_hi:[1,1,1]
    v_pk_fma_f32 v[72:73], v[72:73], s[60:61], v[164:165] op_sel:[0,0,1] op_sel_hi:[1,1,1]
    v_pk_fma_f32 v[74:75], v[74:75], s[60:61], v[164:165] op_sel:[0,0,1] op_sel_hi:[1,1,1]
    v_exp_f32 v60, v60
    v_exp_f32 v61, v61
    v_exp_f32 v62, v62
    v_exp_f32 v63, v63
    v_exp_f32 v64, v64
    v_exp_f32 v65, v65
    v_exp_f32 v66, v66
    v_exp_f32 v67, v67
    v_exp_f32 v68, v68
    v_exp_f32 v69, v69
    v_exp_f32 v70, v70
    v_exp_f32 v71, v71
    v_exp_f32 v72, v72
    v_exp_f32 v73, v73
    v_exp_f32 v74, v74
    v_exp_f32 v75, v75
    v_pk_add_f32 v[168:169], v[168:169], v[60:61]
    v_pk_add_f32 v[168:169], v[168:169], v[62:63]
    v_pk_add_f32 v[168:169], v[168:169], v[64:65]
    v_pk_add_f32 v[168:169], v[168:169], v[66:67]
    v_pk_add_f32 v[168:169], v[168:169], v[68:69]
    v_pk_add_f32 v[168:169], v[168:169], v[70:71]
    v_pk_add_f32 v[168:169], v[168:169], v[72:73]
    v_pk_add_f32 v[168:169], v[168:169], v[74:75]
    v_cvt_pk_bf16_f32 v170, v60, v61
    v_cvt_pk_bf16_f32 v171, v62, v63
    v_cvt_pk_bf16_f32 v172, v64, v65
    v_cvt_pk_bf16_f32 v173, v66, v67
    v_cvt_pk_bf16_f32 v174, v68, v69
    v_cvt_pk_bf16_f32 v175, v70, v71
    v_cvt_pk_bf16_f32 v176, v72, v73
    v_cvt_pk_bf16_f32 v177, v74, v75
    ds_write_b64 v158, v[170:171] offset:8704
    ds_write_b64 v158, v[172:173] offset:8720
    ds_write_b64 v158, v[174:175] offset:8736
    ds_write_b64 v158, v[176:177] offset:8752
    v_pk_fma_f32 v[92:93], v[92:93], s[60:61], v[164:165] op_sel:[0,0,1] op_sel_hi:[1,1,1]
    v_pk_fma_f32 v[94:95], v[94:95], s[60:61], v[164:165] op_sel:[0,0,1] op_sel_hi:[1,1,1]
    v_pk_fma_f32 v[96:97], v[96:97], s[60:61], v[164:165] op_sel:[0,0,1] op_sel_hi:[1,1,1]
    v_pk_fma_f32 v[98:99], v[98:99], s[60:61], v[164:165] op_sel:[0,0,1] op_sel_hi:[1,1,1]
    v_pk_fma_f32 v[100:101], v[100:101], s[60:61], v[164:165] op_sel:[0,0,1] op_sel_hi:[1,1,1]
    v_pk_fma_f32 v[102:103], v[102:103], s[60:61], v[164:165] op_sel:[0,0,1] op_sel_hi:[1,1,1]
    v_pk_fma_f32 v[104:105], v[104:105], s[60:61], v[164:165] op_sel:[0,0,1] op_sel_hi:[1,1,1]
    v_pk_fma_f32 v[106:107], v[106:107], s[60:61], v[164:165] op_sel:[0,0,1] op_sel_hi:[1,1,1]
    v_exp_f32 v92, v92
    v_exp_f32 v93, v93
    v_exp_f32 v94, v94
    v_exp_f32 v95, v95
    v_exp_f32 v96, v96
    v_exp_f32 v97, v97
    v_exp_f32 v98, v98
    v_exp_f32 v99, v99
    v_exp_f32 v100, v100
    v_exp_f32 v101, v101
    v_exp_f32 v102, v102
    v_exp_f32 v103, v103
    v_exp_f32 v104, v104
    v_exp_f32 v105, v105
    v_exp_f32 v106, v106
    v_exp_f32 v107, v107
    v_pk_add_f32 v[168:169], v[168:169], v[92:93]
    v_pk_add_f32 v[168:169], v[168:169], v[94:95]
    v_pk_add_f32 v[168:169], v[168:169], v[96:97]
    v_pk_add_f32 v[168:169], v[168:169], v[98:99]
    v_pk_add_f32 v[168:169], v[168:169], v[100:101]
    v_pk_add_f32 v[168:169], v[168:169], v[102:103]
    v_pk_add_f32 v[168:169], v[168:169], v[104:105]
    v_pk_add_f32 v[168:169], v[168:169], v[106:107]
    v_cvt_pk_bf16_f32 v170, v92, v93
    v_cvt_pk_bf16_f32 v171, v94, v95
    v_cvt_pk_bf16_f32 v172, v96, v97
    v_cvt_pk_bf16_f32 v173, v98, v99
    v_cvt_pk_bf16_f32 v174, v100, v101
    v_cvt_pk_bf16_f32 v175, v102, v103
    v_cvt_pk_bf16_f32 v176, v104, v105
    v_cvt_pk_bf16_f32 v177, v106, v107
    ds_write_b64 v158, v[170:171] offset:8768
    ds_write_b64 v158, v[172:173] offset:8784
    ds_write_b64 v158, v[174:175] offset:8800
    ds_write_b64 v158, v[176:177] offset:8816
    v_add_f32 v168, v168, v169
    v_mov_b32 v4, v168
    s_nop 1
    v_permlane32_swap_b32 v168, v4
    s_nop 1
    v_add_f32 v168, v168, v4
    ds_write_b32 v160, v168 offset:1152
    s_waitcnt lgkmcnt(0)
    s_barrier
    s_cmp_eq_u32 s56, 0
    s_cbranch_scc0 k2S_noml
    ds_read_b32 v178, v161 offset:1024
    ds_read_b32 v179, v161 offset:1152
    s_waitcnt lgkmcnt(0)
    v_add_f32 v163, v166, v178
    v_add_f32 v165, v168, v179
    v_add_u32 v4, 2048, v159
    s_mov_b32 exec_hi, 0
    buffer_store_dwordx2 v[162:163], v159, s[16:19], 0 offen sc1
    buffer_store_dwordx2 v[164:165], v4, s[16:19], 0 offen sc1
    s_mov_b32 exec_hi, -1
k2S_noml:
    s_lshr_b32 s99, s20, 2
    s_lshl_b32 s99, s99, 6
    s_and_b32 s62, s20, 3
    s_lshl_b32 s62, s62, 3
    s_add_u32 s62, s62, s99
    s_add_u32 s62, s62, 32
    v_lshrrev_b32 v5, 4, v1
    v_and_b32 v4, 15, v1
    v_add_u32 v182, s62, v5
    v_mul_u32_u24 v6, 272, v182
    v_lshl_add_u32 v180, v4, 4, v6
    v_mul_u32_u24 v6, 2048, v182
    v_lshl_add_u32 v6, v4, 4, v6
    v_add_u32 v181, s26, v6
    ds_read_b128 v[108:111], v180 offset:0
    ds_read_b128 v[112:115], v180 offset:1088
    s_mov_b32 s58, 0
    s_waitcnt lgkmcnt(1)
    buffer_store_dwordx4 v[108:111], v181, s[12:15], s58 offen sc1
    s_mov_b32 s58, 8192
    s_waitcnt lgkmcnt(0)
    buffer_store_dwordx4 v[112:115], v181, s[12:15], s58 offen sc1
    s_endpgm
k2S_loader:
    v_and_b32 v1, 63, v0
    s_lshl_b32 s57, s23, 7
    s_mul_i32 s99, s25, 32
    s_mul_i32 s52, s25, 4096
    s_add_u32 s99, s99, s57
    v_lshrrev_b32 v4, 3, v1
    v_lshrrev_b32 v5, 4, v1
    v_and_b32 v6, 7, v1
    v_xor_b32 v5, v5, v6
    v_add_u32 v4, s99, v4
    v_mul_i32_i24 v4, 5120, v4
    v_lshl_add_u32 v12, v5, 4, v4
    v_xor_b32 v5, 4, v5
    v_lshl_add_u32 v6, v5, 4, v4
    v_add_u32 v13, 39936, v6
    v_add_u32 v14, 79872, v12
    v_add_u32 v15, 119808, v6
    s_lshl_b32 s57, s22, 7
    s_mul_i32 s99, s25, 32
    s_mul_i32 s54, s25, 4096
    s_add_u32 s99, s99, s57
    v_lshrrev_b32 v4, 3, v1
    v_lshrrev_b32 v5, 4, v1
    v_and_b32 v6, 7, v1
    v_xor_b32 v5, v5, v6
    v_add_u32 v4, s99, v4
    v_mul_i32_i24 v4, 5120, v4
    v_lshl_add_u32 v16, v5, 4, v4
    v_xor_b32 v5, 4, v5
    v_lshl_add_u32 v6, v5, 4, v4
    v_add_u32 v17, 39936, v6
    v_add_u32 v18, 79872, v16
    v_add_u32 v19, 119808, v6
    s_mov_b32 s56, s24
    s_lshl_b32 s55, s56, 7
    s_add_u32 s53, s55, 1024
    s_waitcnt lgkmcnt(0)
    s_mul_i32 s38, s21, 5120000
    s_add_u32 s8, s30, s38
    s_addc_u32 s9, s31, 0
    s_mov_b32 s10, 5120000
    s_mov_b32 s11, 0x20000
    s_add_u32 m0, s52, 0
    s_nop 0
    buffer_load_dwordx4 v12, s[8:11], s53 offen offset:0  lds
    buffer_load_dwordx4 v13, s[8:11], s53 offen offset:1024  lds
    buffer_load_dwordx4 v14, s[8:11], s53 offen offset:2048  lds
    buffer_load_dwordx4 v15, s[8:11], s53 offen offset:3072  lds
    s_add_u32 m0, s54, 16384
    s_nop 0
    buffer_load_dwordx4 v16, s[8:11], s55 offen offset:0  lds
    buffer_load_dwordx4 v17, s[8:11], s55 offen offset:1024  lds
    buffer_load_dwordx4 v18, s[8:11], s55 offen offset:2048  lds
    buffer_load_dwordx4 v19, s[8:11], s55 offen offset:3072  lds
    s_add_u32 s56, s56, 1
    s_and_b32 s56, s56, 7
    s_lshl_b32 s55, s56, 7
    s_add_u32 s53, s55, 1024
    s_add_u32 m0, s52, 32768
    s_nop 0
    buffer_load_dwordx4 v12, s[8:11], s53 offen offset:0  lds
    buffer_load_dwordx4 v13, s[8:11], s53 offen offset:1024  lds
    buffer_load_dwordx4 v14, s[8:11], s53 offen offset:2048  lds
    buffer_load_dwordx4 v15, s[8:11], s53 offen offset:3072  lds
    s_add_u32 m0, s54, 49152
    s_nop 0
    buffer_load_dwordx4 v16, s[8:11], s55 offen offset:0  lds
    buffer_load_dwordx4 v17, s[8:11], s55 offen offset:1024  lds
    buffer_load_dwordx4 v18, s[8:11], s55 offen offset:2048  lds
    buffer_load_dwordx4 v19, s[8:11], s55 offen offset:3072  lds
    s_add_u32 s56, s56, 1
    s_and_b32 s56, s56, 7
    s_lshl_b32 s55, s56, 7
    s_add_u32 s53, s55, 1024
    s_waitcnt vmcnt(8)
    s_barrier
    s_add_u32 m0, s52, 65536
    s_nop 0
    buffer_load_dwordx4 v12, s[8:11], s53 offen offset:0  lds
    buffer_load_dwordx4 v13, s[8:11], s53 offen offset:1024  lds
    buffer_load_dwordx4 v14, s[8:11], s53 offen offset:2048  lds
    buffer_load_dwordx4 v15, s[8:11], s53 offen offset:3072  lds
    s_add_u32 m0, s54, 81920
    s_nop 0
    buffer_load_dwordx4 v16, s[8:11], s55 offen offset:0  lds
    buffer_load_dwordx4 v17, s[8:11], s55 offen offset:1024  lds
    buffer_load_dwordx4 v18, s[8:11], s55 offen offset:2048  lds
    buffer_load_dwordx4 v19, s[8:11], s55 offen offset:3072  lds
    s_add_u32 s56, s56, 1
    s_and_b32 s56, s56, 7
    s_lshl_b32 s55, s56, 7
    s_add_u32 s53, s55, 1024
    s_add_u32 s12, s30, 11534336
    s_addc_u32 s13, s31, 0
    s_mov_b32 s14, 4194304
    s_mov_b32 s15, 0x20000
    s_waitcnt vmcnt(8)
    s_barrier
    s_add_u32 m0, s52, 98304
    s_nop 0
    buffer_load_dwordx4 v12, s[8:11], s53 offen offset:0  lds
    buffer_load_dwordx4 v13, s[8:11], s53 offen offset:1024  lds
    buffer_load_dwordx4 v14, s[8:11], s53 offen offset:2048  lds
    buffer_load_dwordx4 v15, s[8:11], s53 offen offset:3072  lds
    s_add_u32 m0, s54, 114688
    s_nop 0
    buffer_load_dwordx4 v16, s[8:11], s55 offen offset:0  lds
    buffer_load_dwordx4 v17, s[8:11], s55 offen offset:1024  lds
    buffer_load_dwordx4 v18, s[8:11], s55 offen offset:2048  lds
    buffer_load_dwordx4 v19, s[8:11], s55 offen offset:3072  lds
    s_add_u32 s56, s56, 1
    s_and_b32 s56, s56, 7
    s_lshl_b32 s55, s56, 7
    s_add_u32 s53, s55, 1024
    s_cmp_lt_u32 s33, 16
    s_cbranch_scc0 .Lpf3_skip
    s_cmp_eq_u32 s25, 0
    s_cbranch_scc0 .Lpf3_skip
    s_getpc_b64 s[96:97]
.Lpf3_pc:
    s_add_u32 s96, s96, (k2_kernel - .Lpf3_pc) & 0xffffffff
    s_addc_u32 s97, s97, ((k2_kernel - .Lpf3_pc) >> 32) & 0xffffffff
    v_and_b32 v254, 63, v0
    s_lshl_b32 s98, s33, 6
    v_add_u32 v254, s98, v254
    v_lshlrev_b32 v254, 7, v254
    v_min_u32 v254, (k3_exit - k2_kernel - 4), v254
    global_load_dword v255, v254, s[96:97]
.Lpf3_skip:
    s_waitcnt vmcnt(8)
    s_barrier
    s_add_u32 m0, s52, 0
    s_nop 0
    buffer_load_dwordx4 v12, s[8:11], s53 offen offset:0  lds
    buffer_load_dwordx4 v13, s[8:11], s53 offen offset:1024  lds
    buffer_load_dwordx4 v14, s[8:11], s53 offen offset:2048  lds
    buffer_load_dwordx4 v15, s[8:11], s53 offen offset:3072  lds
    s_add_u32 m0, s54, 16384
    s_nop 0
    buffer_load_dwordx4 v16, s[8:11], s55 offen offset:0  lds
    buffer_load_dwordx4 v17, s[8:11], s55 offen offset:1024  lds
    buffer_load_dwordx4 v18, s[8:11], s55 offen offset:2048  lds
    buffer_load_dwordx4 v19, s[8:11], s55 offen offset:3072  lds
    s_add_u32 s56, s56, 1
    s_and_b32 s56, s56, 7
    s_lshl_b32 s55, s56, 7
    s_add_u32 s53, s55, 1024
    s_waitcnt vmcnt(8)
    s_barrier
    s_add_u32 m0, s52, 32768
    s_nop 0
    buffer_load_dwordx4 v12, s[8:11], s53 offen offset:0  lds
    buffer_load_dwordx4 v13, s[8:11], s53 offen offset:1024  lds
    buffer_load_dwordx4 v14, s[8:11], s53 offen offset:2048  lds
    buffer_load_dwordx4 v15, s[8:11], s53 offen offset:3072  lds
    s_add_u32 m0, s54, 49152
    s_nop 0
    buffer_load_dwordx4 v16, s[8:11], s55 offen offset:0  lds
    buffer_load_dwordx4 v17, s[8:11], s55 offen offset:1024  lds
    buffer_load_dwordx4 v18, s[8:11], s55 offen offset:2048  lds
    buffer_load_dwordx4 v19, s[8:11], s55 offen offset:3072  lds
    s_add_u32 s56, s56, 1
    s_and_b32 s56, s56, 7
    s_lshl_b32 s55, s56, 7
    s_add_u32 s53, s55, 1024
    s_waitcnt vmcnt(8)
    s_barrier
    s_add_u32 m0, s52, 65536
    s_nop 0
    buffer_load_dwordx4 v12, s[8:11], s53 offen offset:0  lds
    buffer_load_dwordx4 v13, s[8:11], s53 offen offset:1024  lds
    buffer_load_dwordx4 v14, s[8:11], s53 offen offset:2048  lds
    buffer_load_dwordx4 v15, s[8:11], s53 offen offset:3072  lds
    s_add_u32 m0, s54, 81920
    s_nop 0
    buffer_load_dwordx4 v16, s[8:11], s55 offen offset:0  lds
    buffer_load_dwordx4 v17, s[8:11], s55 offen offset:1024  lds
    buffer_load_dwordx4 v18, s[8:11], s55 offen offset:2048  lds
    buffer_load_dwordx4 v19, s[8:11], s55 offen offset:3072  lds
    s_add_u32 s56, s56, 1
    s_and_b32 s56, s56, 7
    s_lshl_b32 s55, s56, 7
    s_add_u32 s53, s55, 1024
    s_waitcnt vmcnt(8)
    s_barrier
    s_add_u32 m0, s52, 98304
    s_nop 0
    buffer_load_dwordx4 v12, s[8:11], s53 offen offset:0  lds
    buffer_load_dwordx4 v13, s[8:11], s53 offen offset:1024  lds
    buffer_load_dwordx4 v14, s[8:11], s53 offen offset:2048  lds
    buffer_load_dwordx4 v15, s[8:11], s53 offen offset:3072  lds
    s_add_u32 m0, s54, 114688
    s_nop 0
    buffer_load_dwordx4 v16, s[8:11], s55 offen offset:0  lds
    buffer_load_dwordx4 v17, s[8:11], s55 offen offset:1024  lds
    buffer_load_dwordx4 v18, s[8:11], s55 offen offset:2048  lds
    buffer_load_dwordx4 v19, s[8:11], s55 offen offset:3072  lds
    s_add_u32 s56, s56, 1
    s_and_b32 s56, s56, 7
    s_lshl_b32 s55, s56, 7
    s_add_u32 s53, s55, 1024
    s_waitcnt vmcnt(8)
    s_barrier
    s_waitcnt vmcnt(0)
    s_barrier
    s_lshl_b32 s98, s33, 2
    s_add_u32 s98, s98, s25
    s_lshl_b32 s98, s98, 13
    v_and_b32 v4, 63, v0
    v_lshlrev_b32 v4, 7, v4
    v_add_u32 v4, s98, v4
    s_load_dwordx2 s[76:77], s[0:1], 40
    s_mov_b32 s78, 524288
    s_mov_b32 s79, 0x20000
    s_waitcnt lgkmcnt(0)
    buffer_load_dword v252, v4, s[76:79], 0 offen
    s_load_dwordx2 s[76:77], s[0:1], 48
    s_mov_b32 s78, 63488
    s_mov_b32 s79, 0x20000
    s_waitcnt lgkmcnt(0)
    buffer_load_dword v252, v4, s[76:79], 0 offen
    s_barrier
    s_barrier
    s_lshr_b32 s99, s25, 1
    s_lshl_b32 s99, s99, 6
    s_and_b32 s59, s25, 1
    s_lshl_b32 s59, s59, 4
    s_add_u32 s59, s59, s99
    v_lshrrev_b32 v5, 4, v1
    v_and_b32 v4, 15, v1
    v_add_u32 v54, s59, v5
    v_mul_u32_u24 v6, 272, v54
    v_lshl_add_u32 v52, v4, 4, v6
    v_mul_u32_u24 v6, 2048, v54
    v_lshl_add_u32 v6, v4, 4, v6
    v_add_u32 v53, s26, v6
    ds_read_b128 v[20:23], v52 offset:0
    ds_read_b128 v[24:27], v52 offset:1088
    ds_read_b128 v[28:31], v52 offset:2176
    ds_read_b128 v[32:35], v52 offset:3264
    s_mov_b32 s58, 0
    s_waitcnt lgkmcnt(3)
    buffer_store_dwordx4 v[20:23], v53, s[12:15], s58 offen sc1
    s_mov_b32 s58, 8192
    s_waitcnt lgkmcnt(2)
    buffer_store_dwordx4 v[24:27], v53, s[12:15], s58 offen sc1
    s_mov_b32 s58, 16384
    s_waitcnt lgkmcnt(1)
    buffer_store_dwordx4 v[28:31], v53, s[12:15], s58 offen sc1
    s_mov_b32 s58, 24576
    s_waitcnt lgkmcnt(0)
    buffer_store_dwordx4 v[32:35], v53, s[12:15], s58 offen sc1
    s_barrier
    s_lshr_b32 s99, s20, 2
    s_lshl_b32 s99, s99, 6
    s_and_b32 s59, s20, 3
    s_lshl_b32 s59, s59, 3
    s_add_u32 s59, s59, s99
    s_add_u32 s59, s59, 32
    v_lshrrev_b32 v5, 4, v1
    v_and_b32 v4, 15, v1
    v_add_u32 v54, s59, v5
    v_mul_u32_u24 v6, 272, v54
    v_lshl_add_u32 v52, v4, 4, v6
    v_mul_u32_u24 v6, 2048, v54
    v_lshl_add_u32 v6, v4, 4, v6
    v_add_u32 v53, s26, v6
    ds_read_b128 v[20:23], v52 offset:0
    ds_read_b128 v[24:27], v52 offset:1088
    s_mov_b32 s58, 0
    s_waitcnt lgkmcnt(1)
    buffer_store_dwordx4 v[20:23], v53, s[12:15], s58 offen sc1
    s_mov_b32 s58, 8192
    s_waitcnt lgkmcnt(0)
    buffer_store_dwordx4 v[24:27], v53, s[12:15], s58 offen sc1
    s_endpgm
k2_typeV:
    s_lshl_b32 s26, s23, 7
    s_lshl_b32 s27, s22, 7
    s_lshl_b32 s99, s21, 9
    s_lshl_b32 s98, s22, 6
    s_add_u32 s99, s99, s98
    s_mul_i32 s28, s99, 2048
    s_lshl_b32 s98, s23, 8
    s_add_u32 s28, s28, s98
    s_and_b32 s25, s20, 3
    s_cmp_ge_u32 s20, 4
    s_cbranch_scc1 k2V_loader
    v_and_b32 v1, 63, v0
    s_and_b32 s68, s20, 1
    s_lshr_b32 s69, s20, 1
    v_and_b32 v4, 31, v1
    s_lshl_b32 s99, s68, 6
    v_add_u32 v100, s99, v4
    v_bfe_u32 v4, v100, 1, 3
    v_lshrrev_b32 v5, 5, v1
    v_xor_b32 v4, v4, v5
    v_lshlrev_b32 v4, 4, v4
    v_lshl_add_u32 v4, v100, 7, v4
    v_add_u32 v12, 0, v4
    v_add_u32 v16, 24576, v4
    v_add_u32 v20, 49152, v4
    v_add_u32 v24, 73728, v4
    v_xor_b32 v5, 32, v4
    v_add_u32 v13, 0, v5
    v_add_u32 v17, 24576, v5
    v_add_u32 v21, 49152, v5
    v_add_u32 v25, 73728, v5
    v_xor_b32 v5, 64, v4
    v_add_u32 v14, 0, v5
    v_add_u32 v18, 24576, v5
    v_add_u32 v22, 49152, v5
    v_add_u32 v26, 73728, v5
    v_xor_b32 v5, 96, v4
    v_add_u32 v15, 0, v5
    v_add_u32 v19, 24576, v5
    v_add_u32 v23, 49152, v5
    v_add_u32 v27, 73728, v5
    v_bfe_u32 v4, v1, 2, 2
    v_lshrrev_b32 v5, 5, v1
    v_lshl_add_u32 v4, v5, 3, v4
    v_bfe_u32 v5, v4, 1, 1
    v_mul_u32_u24 v4, 128, v4
    v_bfe_u32 v6, v1, 4, 1
    v_lshl_add_u32 v4, v6, 5, v4
    v_and_b32 v6, 3, v1
    v_lshl_add_u32 v4, v6, 3, v4
    s_add_u32 s99, s69, 0
    v_xor_b32 v7, s99, v5
    v_lshl_add_u32 v7, v7, 6, v4
    v_add_u32 v28, 16384, v7
    v_add_u32 v29, 40960, v7
    v_add_u32 v30, 65536, v7
    v_add_u32 v31, 90112, v7
    v_and_b32 v4, 31, v1
    s_lshl_b32 s99, s69, 5
    v_add_u32 v4, s99, v4
    v_mul_u32_u24 v101, 272, v4
    v_lshrrev_b32 v4, 5, v1
    v_lshl_add_u32 v101, v4, 3, v101
    s_lshl_b32 s99, s68, 7
    s_add_u32 s99, s99, 0
    v_add_u32 v101, s99, v101
    s_sub_u32 s99, s26, 16
    v_add_u32 v4, s99, v0
    v_max_i32 v5, 0, v4
    v_min_i32 v5, 999, v5
    s_mul_i32 s99, s21, 1000
    v_add_u32 v5, s99, v5
    v_lshlrev_b32 v232, 3, v5
    v_cmp_gt_u32 vcc, 1000, v4
    v_mov_b32 v6, 0
    v_mov_b32 v7, 1.0
    v_cndmask_b32 v213, v6, v7, vcc
    v_lshrrev_b32 v4, 5, v1
    v_lshlrev_b32 v4, 2, v4
    s_lshl_b32 s99, s20, 3
    s_add_u32 s99, s99, s26
    s_sub_u32 s99, s99, 16
    v_add_u32 v4, s99, v4
    v_mul_i32_i24 v4, 5120, v4
    v_and_b32 v5, 31, v1
    v_lshl_add_u32 v4, v5, 2, v4
    s_add_u32 s99, s27, 4096
    v_add_u32 v212, s99, v4
    v_lshrrev_b32 v4, 5, v1
    s_lshl_b32 s99, s20, 6
    v_lshl_add_u32 v216, v4, 5, s99
    v_add_u32 v216, 145664, v216
    v_and_b32 v5, 31, v1
    v_and_b32 v6, 7, v5
    v_xor_b32 v6, s20, v6
    v_mul_u32_u24 v5, 768, v5
    v_lshl_add_u32 v5, v4, 3, v5
    v_add_u32 v5, 98304, v5
    v_lshl_add_u32 v214, v6, 4, v5
    v_xor_b32 v6, 4, v6
    v_lshl_add_u32 v215, v6, 4, v5
    s_waitcnt lgkmcnt(0)
    s_mul_i32 s38, s21, 5120000
    s_add_u32 s8, s30, s38
    s_addc_u32 s9, s31, 0
    s_mov_b32 s10, 5120000
    s_mov_b32 s11, 0x20000
    s_add_u32 s52, s30, 10485760
    s_addc_u32 s53, s31, 0
    s_mov_b32 s54, 131072
    s_mov_b32 s55, 0x20000
    s_mov_b32 s56, s6
    s_mov_b32 s57, s7
    s_mov_b32 s58, 31744
    s_mov_b32 s59, 0x20000
    s_mov_b32 s99, 0
    buffer_load_dwordx2 v[108:109], v232, s[52:55], s99 offen
    s_mov_b32 s99, 16384
    buffer_load_dwordx2 v[110:111], v232, s[52:55], s99 offen
    s_mov_b32 s99, 32768
    buffer_load_dwordx2 v[112:113], v232, s[52:55], s99 offen
    s_mov_b32 s99, 49152
    buffer_load_dwordx2 v[114:115], v232, s[52:55], s99 offen
    s_mov_b32 s99, 65536
    buffer_load_dwordx2 v[116:117], v232, s[52:55], s99 offen
    s_mov_b32 s99, 81920
    buffer_load_dwordx2 v[118:119], v232, s[52:55], s99 offen
    s_mov_b32 s99, 98304
    buffer_load_dwordx2 v[120:121], v232, s[52:55], s99 offen
    s_mov_b32 s99, 114688
    buffer_load_dwordx2 v[122:123], v232, s[52:55], s99 offen
    s_add_u32 s48, s30, 16777216
    s_addc_u32 s49, s31, 0
    s_mov_b32 s50, 2097152
    s_mov_b32 s51, 0x20000
    s_mul_i32 s38, s21, 1024000
    s_add_u32 s60, s30, s38
    s_addc_u32 s61, s31, 0
    s_add_u32 s60, s60, 19922944
    s_addc_u32 s61, s61, 0
    s_mov_b32 s62, 1024000
    s_mov_b32 s63, 0x20000
    s_barrier
    ds_read_b128 v[64:67], v12 offset:0
    ds_read_b128 v[68:71], v12 offset:4096
    ds_read_b64_tr_b16 v[72:73], v28 offset:0
    ds_read_b64_tr_b16 v[74:75], v28 offset:512
    ds_read_b128 v[76:79], v13 offset:0
    ds_read_b128 v[80:83], v13 offset:4096
    ds_read_b64_tr_b16 v[84:85], v28 offset:2048
    ds_read_b64_tr_b16 v[86:87], v28 offset:2560
    s_waitcnt lgkmcnt(4)
    v_mfma_f32_32x32x16_bf16 v[32:47], v[64:67], v[72:75], 0
    ds_read_b128 v[88:91], v14 offset:0
    ds_read_b128 v[92:95], v14 offset:4096
    ds_read_b64_tr_b16 v[96:97], v28 offset:4096
    v_and_b32 v218, 63, v0
    v_lshrrev_b32 v219, 6, v0
    v_mul_u32_u24 v219, 1024, v219
    v_lshl_add_u32 v218, v218, 1, v219
    v_add_u32 v218, s27, v218
    s_mov_b32 s99, 0
    buffer_load_ushort v124, v218, s[56:59], s99 offen
    s_mov_b32 s99, 4096
    buffer_load_ushort v125, v218, s[56:59], s99 offen
    s_mov_b32 s99, 8192
    buffer_load_ushort v126, v218, s[56:59], s99 offen
    v_mfma_f32_32x32x16_bf16 v[48:63], v[68:71], v[72:75], 0
    ds_read_b64_tr_b16 v[98:99], v28 offset:4608
    s_mov_b32 s99, 12288
    buffer_load_ushort v127, v218, s[56:59], s99 offen
    s_mov_b32 s99, 16384
    buffer_load_ushort v128, v218, s[56:59], s99 offen
    s_mov_b32 s99, 20480
    buffer_load_ushort v129, v218, s[56:59], s99 offen
    s_mov_b32 s99, 24576
    buffer_load_ushort v130, v218, s[56:59], s99 offen
    s_mov_b32 s99, 28672
    buffer_load_ushort v131, v218, s[56:59], s99 offen
    v_add_u32 v218, 0, v212
    buffer_load_dword v132, v218, s[8:11], 0 offen
    v_add_u32 v218, 5120, v212
    buffer_load_dword v133, v218, s[8:11], 0 offen
    s_waitcnt lgkmcnt(4)
    v_mfma_f32_32x32x16_bf16 v[32:47], v[76:79], v[84:87], v[32:47]
    ds_read_b128 v[64:67], v15 offset:0
    ds_read_b128 v[68:71], v15 offset:4096
    ds_read_b64_tr_b16 v[72:73], v28 offset:6144
    v_add_u32 v218, 10240, v212
    buffer_load_dword v134, v218, s[8:11], 0 offen
    v_add_u32 v218, 15360, v212
    buffer_load_dword v135, v218, s[8:11], 0 offen
    v_add_u32 v218, 163840, v212
    buffer_load_dword v136, v218, s[8:11], 0 offen
    v_add_u32 v218, 168960, v212
    buffer_load_dword v137, v218, s[8:11], 0 offen
    v_add_u32 v218, 174080, v212
    buffer_load_dword v138, v218, s[8:11], 0 offen
    v_add_u32 v218, 179200, v212
    buffer_load_dword v139, v218, s[8:11], 0 offen
    v_add_u32 v218, 327680, v212
    buffer_load_dword v140, v218, s[8:11], 0 offen
    v_add_u32 v218, 332800, v212
    buffer_load_dword v141, v218, s[8:11], 0 offen
    v_mfma_f32_32x32x16_bf16 v[48:63], v[80:83], v[84:87], v[48:63]
    ds_read_b64_tr_b16 v[74:75], v28 offset:6656
    v_add_u32 v218, 337920, v212
    buffer_load_dword v142, v218, s[8:11], 0 offen
    v_add_u32 v218, 343040, v212
    buffer_load_dword v143, v218, s[8:11], 0 offen
    v_add_u32 v218, 491520, v212
    buffer_load_dword v144, v218, s[8:11], 0 offen
    v_add_u32 v218, 496640, v212
    buffer_load_dword v145, v218, s[8:11], 0 offen
    v_add_u32 v218, 501760, v212
    buffer_load_dword v146, v218, s[8:11], 0 offen
    v_add_u32 v218, 506880, v212
    buffer_load_dword v147, v218, s[8:11], 0 offen
    v_add_u32 v218, 655360, v212
    buffer_load_dword v148, v218, s[8:11], 0 offen
    s_waitcnt lgkmcnt(4)
    v_mfma_f32_32x32x16_bf16 v[32:47], v[88:91], v[96:99], v[32:47]
    s_barrier
    ds_read_b128 v[76:79], v16 offset:0
    ds_read_b128 v[80:83], v16 offset:4096
    ds_read_b64_tr_b16 v[84:85], v29 offset:0
    v_add_u32 v218, 660480, v212
    buffer_load_dword v149, v218, s[8:11], 0 offen
    v_add_u32 v218, 665600, v212
    buffer_load_dword v150, v218, s[8:11], 0 offen
    v_add_u32 v218, 670720, v212
    buffer_load_dword v151, v218, s[8:11], 0 offen
    v_lshrrev_b32 v218, 3, v0
    v_add_u32 v218, s26, v218
    v_mul_u32_u24 v218, 5120, v218
    v_and_b32 v219, 7, v0
    v_lshl_add_u32 v218, v219, 4, v218
    v_mfma_f32_32x32x16_bf16 v[48:63], v[92:95], v[96:99], v[48:63]
    ds_read_b64_tr_b16 v[86:87], v29 offset:512
    s_add_u32 s99, s27, 3072
    v_add_u32 v218, s99, v218
    s_mov_b32 s99, 0
    buffer_load_dwordx4 v[236:239], v218, s[8:11], s99 offen
    s_mov_b32 s99, 327680
    buffer_load_dwordx4 v[240:243], v218, s[8:11], s99 offen
    v_mov_b32 v204, 0
    v_mov_b32 v205, 0
    v_mov_b32 v206, 0
    v_mov_b32 v207, 0
    s_waitcnt lgkmcnt(4)
    v_mfma_f32_32x32x16_bf16 v[32:47], v[64:67], v[72:75], v[32:47]
    ds_read_b128 v[88:91], v17 offset:0
    ds_read_b128 v[92:95], v17 offset:4096
    ds_read_b64_tr_b16 v[96:97], v29 offset:2048
    v_lshlrev_b32 v218, 4, v0
    v_add_u32 v218, 98304, v218
    ds_write_b128 v218, v[204:207] offset:0
    ds_write_b128 v218, v[204:207] offset:4096
    ds_write_b128 v218, v[204:207] offset:8192
    ds_write_b128 v218, v[204:207] offset:12288
    ds_write_b128 v218, v[204:207] offset:16384
    v_mfma_f32_32x32x16_bf16 v[48:63], v[68:71], v[72:75], v[48:63]
    ds_read_b64_tr_b16 v[98:99], v29 offset:2560
    ds_write_b128 v218, v[204:207] offset:20480
    ds_write_b128 v218, v[204:207] offset:24576
    ds_write_b128 v218, v[204:207] offset:28672
    ds_write_b128 v218, v[204:207] offset:32768
    ds_write_b128 v218, v[204:207] offset:36864
    ds_write_b128 v218, v[204:207] offset:40960
    v_cmp_gt_u32 vcc, 144, v0
    s_and_saveexec_b64 s[96:97], vcc
    ds_write_b128 v218, v[204:207] offset:45056
    s_mov_b64 exec, s[96:97]
    s_waitcnt lgkmcnt(0)
    v_mfma_f32_32x32x16_bf16 v[32:47], v[76:79], v[84:87], v[32:47]
    ds_read_b128 v[64:67], v18 offset:0
    ds_read_b128 v[68:71], v18 offset:4096
    ds_read_b64_tr_b16 v[72:73], v29 offset:4096
    s_waitcnt vmcnt(30)
    v_add_f32 v218, v108, v110
    v_add_f32 v219, v109, v111
    v_add_f32 v218, v218, v112
    v_mfma_f32_32x32x16_bf16 v[48:63], v[80:83], v[84:87], v[48:63]
    ds_read_b64_tr_b16 v[74:75], v29 offset:4608
    v_add_f32 v219, v219, v113
    v_add_f32 v218, v218, v114
    v_add_f32 v219, v219, v115
    s_waitcnt lgkmcnt(0)
    v_mfma_f32_32x32x16_bf16 v[32:47], v[88:91], v[96:99], v[32:47]
    ds_read_b128 v[76:79], v19 offset:0
    ds_read_b128 v[80:83], v19 offset:4096
    ds_read_b64_tr_b16 v[84:85], v29 offset:6144
    v_add_f32 v218, v218, v116
    v_add_f32 v219, v219, v117
    v_add_f32 v218, v218, v118
    v_mfma_f32_32x32x16_bf16 v[48:63], v[92:95], v[96:99], v[48:63]
    ds_read_b64_tr_b16 v[86:87], v29 offset:6656
    v_add_f32 v219, v219, v119
    v_add_f32 v218, v218, v120
    v_add_f32 v219, v219, v121
    s_waitcnt lgkmcnt(4)
    v_mfma_f32_32x32x16_bf16 v[32:47], v[64:67], v[72:75], v[32:47]
    s_barrier
    ds_read_b128 v[88:91], v20 offset:0
    ds_read_b128 v[92:95], v20 offset:4096
    ds_read_b64_tr_b16 v[96:97], v30 offset:0
    v_add_f32 v218, v218, v122
    v_add_f32 v219, v219, v123
    v_mul_f32 v218, 989855744, v218
    v_mfma_f32_32x32x16_bf16 v[48:63], v[68:71], v[72:75], v[48:63]
    ds_read_b64_tr_b16 v[98:99], v30 offset:512
    v_mul_f32 v219, 989855744, v219
    v_fma_f32 v219, -v218, v218, v219
    v_max_f32 v219, 0, v219
    s_waitcnt lgkmcnt(4)
    v_mfma_f32_32x32x16_bf16 v[32:47], v[76:79], v[84:87], v[32:47]
    ds_read_b128 v[64:67], v21 offset:0
    ds_read_b128 v[68:71], v21 offset:4096
    ds_read_b64_tr_b16 v[72:73], v30 offset:2048
    v_add_f32 v219, 925353388, v219
    v_rsq_f32 v220, v219
    s_nop 0
    v_mul_f32 v220, v220, v213
    v_mul_f32 v221, -v218, v220
    v_mfma_f32_32x32x16_bf16 v[48:63], v[80:83], v[84:87], v[48:63]
    ds_read_b64_tr_b16 v[74:75], v30 offset:2560
    v_lshlrev_b32 v222, 3, v0
    v_add_u32 v222, 145664, v222
    ds_write_b64 v222, v[220:221]
    s_waitcnt lgkmcnt(0)
    v_mfma_f32_32x32x16_bf16 v[32:47], v[88:91], v[96:99], v[32:47]
    ds_read_b128 v[76:79], v22 offset:0
    ds_read_b128 v[80:83], v22 offset:4096
    ds_read_b64_tr_b16 v[84:85], v30 offset:4096
    s_waitcnt vmcnt(22)
    v_and_b32 v218, 63, v0
    v_lshrrev_b32 v219, 6, v0
    v_mfma_f32_32x32x16_bf16 v[48:63], v[92:95], v[96:99], v[48:63]
    ds_read_b64_tr_b16 v[86:87], v30 offset:4608
    v_mul_u32_u24 v218, 356, v218
    v_lshl_add_u32 v218, v219, 1, v218
    v_add_u32 v218, 122880, v218
    s_waitcnt lgkmcnt(0)
    v_mfma_f32_32x32x16_bf16 v[32:47], v[64:67], v[72:75], v[32:47]
    ds_read_b128 v[88:91], v23 offset:0
    ds_read_b128 v[92:95], v23 offset:4096
    ds_read_b64_tr_b16 v[96:97], v30 offset:6144
    ds_write_b16 v218, v124 offset:32
    ds_write_b16 v218, v124 offset:206
    ds_write_b16 v218, v125 offset:40
    v_mfma_f32_32x32x16_bf16 v[48:63], v[68:71], v[72:75], v[48:63]
    ds_read_b64_tr_b16 v[98:99], v30 offset:6656
    ds_write_b16 v218, v125 offset:214
    ds_write_b16 v218, v126 offset:48
    s_waitcnt lgkmcnt(0)
    v_mfma_f32_32x32x16_bf16 v[32:47], v[76:79], v[84:87], v[32:47]
    s_barrier
    ds_read_b128 v[64:67], v24 offset:0
    ds_read_b128 v[68:71], v24 offset:4096
    ds_read_b64_tr_b16 v[72:73], v31 offset:0
    ds_write_b16 v218, v126 offset:222
    ds_write_b16 v218, v127 offset:56
    ds_write_b16 v218, v127 offset:230
    v_mfma_f32_32x32x16_bf16 v[48:63], v[80:83], v[84:87], v[48:63]
    ds_read_b64_tr_b16 v[74:75], v31 offset:512
    ds_write_b16 v218, v128 offset:64
    ds_write_b16 v218, v128 offset:238
    s_waitcnt lgkmcnt(0)
    v_mfma_f32_32x32x16_bf16 v[32:47], v[88:91], v[96:99], v[32:47]
    ds_read_b128 v[76:79], v25 offset:0
    ds_read_b128 v[80:83], v25 offset:4096
    ds_read_b64_tr_b16 v[84:85], v31 offset:2048
    ds_write_b16 v218, v129 offset:72
    ds_write_b16 v218, v129 offset:246
    ds_write_b16 v218, v130 offset:80
    v_mfma_f32_32x32x16_bf16 v[48:63], v[92:95], v[96:99], v[48:63]
    ds_read_b64_tr_b16 v[86:87], v31 offset:2560
    ds_write_b16 v218, v130 offset:254
    v_cmp_gt_u32 vcc, 3, v219
    s_and_saveexec_b64 s[96:97], vcc
    ds_write_b16 v218, v131 offset:88
    ds_write_b16 v218, v131 offset:262
    s_mov_b64 exec, s[96:97]
    s_waitcnt lgkmcnt(0)
    v_mfma_f32_32x32x16_bf16 v[32:47], v[64:67], v[72:75], v[32:47]
    ds_read_b128 v[88:91], v26 offset:0
    ds_read_b128 v[92:95], v26 offset:4096
    ds_read_b64_tr_b16 v[96:97], v31 offset:4096
    ds_read_b128 v[152:155], v216 offset:0
    ds_read_b128 v[156:159], v216 offset:16
    v_mfma_f32_32x32x16_bf16 v[48:63], v[68:71], v[72:75], v[48:63]
    ds_read_b64_tr_b16 v[98:99], v31 offset:4608
    ds_read_b128 v[160:163], v216 offset:256
    ds_read_b128 v[164:167], v216 offset:272
    s_waitcnt lgkmcnt(0)
    v_mfma_f32_32x32x16_bf16 v[32:47], v[76:79], v[84:87], v[32:47]
    ds_read_b128 v[64:67], v27 offset:0
    ds_read_b128 v[68:71], v27 offset:4096
    ds_read_b64_tr_b16 v[72:73], v31 offset:6144
    ds_read_b128 v[168:171], v216 offset:512
    ds_read_b128 v[172:175], v216 offset:528
    v_mfma_f32_32x32x16_bf16 v[48:63], v[80:83], v[84:87], v[48:63]
    ds_read_b64_tr_b16 v[74:75], v31 offset:6656
    ds_read_b128 v[176:179], v216 offset:768
    s_waitcnt lgkmcnt(0)
    v_mfma_f32_32x32x16_bf16 v[32:47], v[88:91], v[96:99], v[32:47]
    s_barrier
    ds_read_b128 v[76:79], v12 offset:0
    ds_read_b128 v[80:83], v12 offset:4096
    ds_read_b64_tr_b16 v[84:85], v28 offset:0
    ds_read_b128 v[180:183], v216 offset:784
    ds_read_b128 v[184:187], v216 offset:1024
    v_mfma_f32_32x32x16_bf16 v[48:63], v[92:95], v[96:99], v[48:63]
    ds_read_b64_tr_b16 v[86:87], v28 offset:512
    ds_read_b128 v[188:191], v216 offset:1040
    s_waitcnt lgkmcnt(0)
    v_mfma_f32_32x32x16_bf16 v[32:47], v[64:67], v[72:75], v[32:47]
    ds_read_b128 v[88:91], v13 offset:0
    ds_read_b128 v[92:95], v13 offset:4096
    ds_read_b64_tr_b16 v[96:97], v28 offset:2048
    v_mfma_f32_32x32x16_bf16 v[48:63], v[68:71], v[72:75], v[48:63]
    ds_read_b64_tr_b16 v[98:99], v28 offset:2560
    s_waitcnt lgkmcnt(0)
    v_mfma_f32_32x32x16_bf16 v[32:47], v[76:79], v[84:87], v[32:47]
    ds_read_b128 v[64:67], v14 offset:0
    ds_read_b128 v[68:71], v14 offset:4096
    ds_read_b64_tr_b16 v[72:73], v28 offset:4096
    s_waitcnt vmcnt(2)
    v_lshlrev_b32 v192, 16, v132
    v_and_b32 v193, 0xffff0000, v132
    v_lshlrev_b32 v194, 16, v133
    v_and_b32 v195, 0xffff0000, v133
    v_mfma_f32_32x32x16_bf16 v[48:63], v[80:83], v[84:87], v[48:63]
    ds_read_b64_tr_b16 v[74:75], v28 offset:4608
    v_lshlrev_b32 v196, 16, v134
    v_and_b32 v197, 0xffff0000, v134
    v_lshlrev_b32 v198, 16, v135
    v_and_b32 v199, 0xffff0000, v135
    v_fma_f32 v192, v192, v152, v153
    s_waitcnt lgkmcnt(4)
    v_mfma_f32_32x32x16_bf16 v[32:47], v[88:91], v[96:99], v[32:47]
    ds_read_b128 v[76:79], v15 offset:0
    ds_read_b128 v[80:83], v15 offset:4096
    ds_read_b64_tr_b16 v[84:85], v28 offset:6144
    v_fma_f32 v193, v193, v152, v153
    v_fma_f32 v194, v194, v154, v155
    v_fma_f32 v195, v195, v154, v155
    v_fma_f32 v196, v196, v156, v157
    v_fma_f32 v197, v197, v156, v157
    v_mfma_f32_32x32x16_bf16 v[48:63], v[92:95], v[96:99], v[48:63]
    ds_read_b64_tr_b16 v[86:87], v28 offset:6656
    v_fma_f32 v198, v198, v158, v159
    v_fma_f32 v199, v199, v158, v159
    v_cvt_pk_bf16_f32 v200, v192, v194
    v_cvt_pk_bf16_f32 v201, v196, v198
    v_cvt_pk_bf16_f32 v202, v193, v195
    s_waitcnt lgkmcnt(4)
    v_mfma_f32_32x32x16_bf16 v[32:47], v[64:67], v[72:75], v[32:47]
    s_barrier
    ds_read_b128 v[88:91], v16 offset:0
    ds_read_b128 v[92:95], v16 offset:4096
    ds_read_b64_tr_b16 v[96:97], v29 offset:0
    v_cvt_pk_bf16_f32 v203, v197, v199
    ds_write_b64 v214, v[200:201] offset:0
    ds_write_b64 v214, v[202:203] offset:384
    v_lshlrev_b32 v192, 16, v136
    v_and_b32 v193, 0xffff0000, v136
    v_mfma_f32_32x32x16_bf16 v[48:63], v[68:71], v[72:75], v[48:63]
    ds_read_b64_tr_b16 v[98:99], v29 offset:512
    v_lshlrev_b32 v194, 16, v137
    v_and_b32 v195, 0xffff0000, v137
    v_lshlrev_b32 v196, 16, v138
    v_and_b32 v197, 0xffff0000, v138
    v_lshlrev_b32 v198, 16, v139
    s_waitcnt lgkmcnt(0)
    v_mfma_f32_32x32x16_bf16 v[32:47], v[76:79], v[84:87], v[32:47]
    ds_read_b128 v[64:67], v17 offset:0
    ds_read_b128 v[68:71], v17 offset:4096
    ds_read_b64_tr_b16 v[72:73], v29 offset:2048
    v_and_b32 v199, 0xffff0000, v139
    v_fma_f32 v192, v192, v160, v161
    v_fma_f32 v193, v193, v160, v161
    v_fma_f32 v194, v194, v162, v163
    v_fma_f32 v195, v195, v162, v163
    v_mfma_f32_32x32x16_bf16 v[48:63], v[80:83], v[84:87], v[48:63]
    ds_read_b64_tr_b16 v[74:75], v29 offset:2560
    v_fma_f32 v196, v196, v164, v165
    v_fma_f32 v197, v197, v164, v165
    v_fma_f32 v198, v198, v166, v167
    v_fma_f32 v199, v199, v166, v167
    s_waitcnt lgkmcnt(0)
    v_mfma_f32_32x32x16_bf16 v[32:47], v[88:91], v[96:99], v[32:47]
    ds_read_b128 v[76:79], v18 offset:0
    ds_read_b128 v[80:83], v18 offset:4096
    ds_read_b64_tr_b16 v[84:85], v29 offset:4096
    v_cvt_pk_bf16_f32 v200, v192, v194
    v_cvt_pk_bf16_f32 v201, v196, v198
    v_cvt_pk_bf16_f32 v202, v193, v195
    v_cvt_pk_bf16_f32 v203, v197, v199
    ds_write_b64 v215, v[200:201] offset:0
    v_mfma_f32_32x32x16_bf16 v[48:63], v[92:95], v[96:99], v[48:63]
    ds_read_b64_tr_b16 v[86:87], v29 offset:4608
    ds_write_b64 v215, v[202:203] offset:384
    v_lshlrev_b32 v192, 16, v140
    v_and_b32 v193, 0xffff0000, v140
    v_lshlrev_b32 v194, 16, v141
    s_waitcnt lgkmcnt(0)
    v_mfma_f32_32x32x16_bf16 v[32:47], v[64:67], v[72:75], v[32:47]
    ds_read_b128 v[88:91], v19 offset:0
    ds_read_b128 v[92:95], v19 offset:4096
    ds_read_b64_tr_b16 v[96:97], v29 offset:6144
    v_and_b32 v195, 0xffff0000, v141
    v_lshlrev_b32 v196, 16, v142
    v_and_b32 v197, 0xffff0000, v142
    v_lshlrev_b32 v198, 16, v143
    v_and_b32 v199, 0xffff0000, v143
    v_mfma_f32_32x32x16_bf16 v[48:63], v[68:71], v[72:75], v[48:63]
    ds_read_b64_tr_b16 v[98:99], v29 offset:6656
    v_fma_f32 v192, v192, v168, v169
    v_fma_f32 v193, v193, v168, v169
    v_fma_f32 v194, v194, v170, v171
    v_fma_f32 v195, v195, v170, v171
    s_waitcnt lgkmcnt(0)
    v_mfma_f32_32x32x16_bf16 v[32:47], v[76:79], v[84:87], v[32:47]
    s_barrier
    ds_read_b128 v[64:67], v20 offset:0
    ds_read_b128 v[68:71], v20 offset:4096
    ds_read_b64_tr_b16 v[72:73], v30 offset:0
    v_fma_f32 v196, v196, v172, v173
    v_fma_f32 v197, v197, v172, v173
    v_fma_f32 v198, v198, v174, v175
    v_fma_f32 v199, v199, v174, v175
    v_cvt_pk_bf16_f32 v200, v192, v194
    v_mfma_f32_32x32x16_bf16 v[48:63], v[80:83], v[84:87], v[48:63]
    ds_read_b64_tr_b16 v[74:75], v30 offset:512
    v_cvt_pk_bf16_f32 v201, v196, v198
    v_cvt_pk_bf16_f32 v202, v193, v195
    v_cvt_pk_bf16_f32 v203, v197, v199
    ds_write_b64 v214, v[200:201] offset:128
    s_waitcnt lgkmcnt(0)
    v_mfma_f32_32x32x16_bf16 v[32:47], v[88:91], v[96:99], v[32:47]
    ds_read_b128 v[76:79], v21 offset:0
    ds_read_b128 v[80:83], v21 offset:4096
    ds_read_b64_tr_b16 v[84:85], v30 offset:2048
    ds_write_b64 v214, v[202:203] offset:512
    v_lshlrev_b32 v192, 16, v144
    v_and_b32 v193, 0xffff0000, v144
    v_lshlrev_b32 v194, 16, v145
    v_and_b32 v195, 0xffff0000, v145
    v_mfma_f32_32x32x16_bf16 v[48:63], v[92:95], v[96:99], v[48:63]
    ds_read_b64_tr_b16 v[86:87], v30 offset:2560
    v_lshlrev_b32 v196, 16, v146
    v_and_b32 v197, 0xffff0000, v146
    v_lshlrev_b32 v198, 16, v147
    v_and_b32 v199, 0xffff0000, v147
    s_waitcnt lgkmcnt(0)
    v_mfma_f32_32x32x16_bf16 v[32:47], v[64:67], v[72:75], v[32:47]
    ds_read_b128 v[88:91], v22 offset:0
    ds_read_b128 v[92:95], v22 offset:4096
    ds_read_b64_tr_b16 v[96:97], v30 offset:4096
    v_fma_f32 v192, v192, v176, v177
    v_fma_f32 v193, v193, v176, v177
    v_fma_f32 v194, v194, v178, v179
    v_fma_f32 v195, v195, v178, v179
    v_fma_f32 v196, v196, v180, v181
    v_mfma_f32_32x32x16_bf16 v[48:63], v[68:71], v[72:75], v[48:63]
    ds_read_b64_tr_b16 v[98:99], v30 offset:4608
    v_fma_f32 v197, v197, v180, v181
    v_fma_f32 v198, v198, v182, v183
    v_fma_f32 v199, v199, v182, v183
    v_cvt_pk_bf16_f32 v200, v192, v194
    s_waitcnt lgkmcnt(0)
    v_mfma_f32_32x32x16_bf16 v[32:47], v[76:79], v[84:87], v[32:47]
    ds_read_b128 v[64:67], v23 offset:0
    ds_read_b128 v[68:71], v23 offset:4096
    ds_read_b64_tr_b16 v[72:73], v30 offset:6144
    v_cvt_pk_bf16_f32 v201, v196, v198
    v_cvt_pk_bf16_f32 v202, v193, v195
    v_cvt_pk_bf16_f32 v203, v197, v199
    ds_write_b64 v215, v[200:201] offset:128
    ds_write_b64 v215, v[202:203] offset:512
    v_mfma_f32_32x32x16_bf16 v[48:63], v[80:83], v[84:87], v[48:63]
    ds_read_b64_tr_b16 v[74:75], v30 offset:6656
    v_lshlrev_b32 v192, 16, v148
    v_and_b32 v193, 0xffff0000, v148
    v_lshlrev_b32 v194, 16, v149
    v_and_b32 v195, 0xffff0000, v149
    s_waitcnt lgkmcnt(0)
    v_mfma_f32_32x32x16_bf16 v[32:47], v[88:91], v[96:99], v[32:47]
    s_barrier
    ds_read_b128 v[76:79], v24 offset:0
    ds_read_b128 v[80:83], v24 offset:4096
    ds_read_b64_tr_b16 v[84:85], v31 offset:0
    v_lshlrev_b32 v196, 16, v150
    v_and_b32 v197, 0xffff0000, v150
    v_lshlrev_b32 v198, 16, v151
    v_and_b32 v199, 0xffff0000, v151
    v_fma_f32 v192, v192, v184, v185
    v_mfma_f32_32x32x16_bf16 v[48:63], v[92:95], v[96:99], v[48:63]
    ds_read_b64_tr_b16 v[86:87], v31 offset:512
    v_fma_f32 v193, v193, v184, v185
    v_fma_f32 v194, v194, v186, v187
    v_fma_f32 v195, v195, v186, v187
    v_fma_f32 v196, v196, v188, v189
    s_waitcnt lgkmcnt(0)
    v_mfma_f32_32x32x16_bf16 v[32:47], v[64:67], v[72:75], v[32:47]
    ds_read_b128 v[88:91], v25 offset:0
    ds_read_b128 v[92:95], v25 offset:4096
    ds_read_b64_tr_b16 v[96:97], v31 offset:2048
    v_fma_f32 v197, v197, v188, v189
    v_fma_f32 v198, v198, v190, v191
    v_fma_f32 v199, v199, v190, v191
    v_cvt_pk_bf16_f32 v200, v192, v194
    v_cvt_pk_bf16_f32 v201, v196, v198
    v_mfma_f32_32x32x16_bf16 v[48:63], v[68:71], v[72:75], v[48:63]
    ds_read_b64_tr_b16 v[98:99], v31 offset:2560
    v_cvt_pk_bf16_f32 v202, v193, v195
    v_cvt_pk_bf16_f32 v203, v197, v199
    ds_write_b64 v214, v[200:201] offset:256
    ds_write_b64 v214, v[202:203] offset:640
    s_waitcnt lgkmcnt(0)
    v_mfma_f32_32x32x16_bf16 v[32:47], v[76:79], v[84:87], v[32:47]
    ds_read_b128 v[64:67], v26 offset:0
    ds_read_b128 v[68:71], v26 offset:4096
    ds_read_b64_tr_b16 v[72:73], v31 offset:4096
    v_and_b32 v218, 15, v1
    v_lshrrev_b32 v219, 4, v1
    v_lshlrev_b32 v220, 3, v219
    v_sub_u32 v220, v220, v218
    v_add_u32 v220, 15, v220
    v_and_b32 v224, 1, v220
    v_mfma_f32_32x32x16_bf16 v[48:63], v[80:83], v[84:87], v[48:63]
    ds_read_b64_tr_b16 v[74:75], v31 offset:4608
    v_mul_u32_u24 v224, 176, v224
    v_lshrrev_b32 v220, 1, v220
    v_lshl_add_u32 v224, v220, 2, v224
    s_mul_i32 s99, s20, 2848
    s_add_u32 s99, s99, 122880
    v_add_u32 v224, s99, v224
    v_lshl_add_u32 v220, v218, 1, v219
    s_waitcnt lgkmcnt(0)
    v_mfma_f32_32x32x16_bf16 v[32:47], v[88:91], v[96:99], v[32:47]
    ds_read_b128 v[76:79], v27 offset:0
    ds_read_b128 v[80:83], v27 offset:4096
    ds_read_b64_tr_b16 v[84:85], v31 offset:6144
    v_lshlrev_b32 v220, 4, v220
    s_mul_i32 s99, s20, 3072
    s_add_u32 s99, s99, 98304
    v_add_u32 v225, s99, v220
    v_add_u32 v226, 64, v225
    s_and_b32 s99, s20, 1
    s_lshl_b32 s99, s99, 6
    v_xor_b32 v225, s99, v225
    s_and_b32 s99, s20, 1
    s_lshl_b32 s99, s99, 6
    v_xor_b32 v226, s99, v226
    v_lshlrev_b32 v220, 2, v219
    v_mfma_f32_32x32x16_bf16 v[48:63], v[92:95], v[96:99], v[48:63]
    ds_read_b64_tr_b16 v[86:87], v31 offset:6656
    v_lshl_add_u32 v220, v218, 4, v220
    v_lshlrev_b32 v220, 7, v220
    v_add_u32 v220, 145664, v220
    v_and_b32 v218, 7, v218
    s_mul_i32 s99, s20, 1
    s_add_u32 s99, s99, 0
    v_xor_b32 v219, s99, v218
    s_waitcnt lgkmcnt(4)
    v_mfma_f32_32x32x16_bf16 v[32:47], v[64:67], v[72:75], v[32:47]
    v_lshl_add_u32 v229, v219, 4, v220
    v_lshrrev_b32 v218, 3, v0
    v_and_b32 v219, 7, v0
    v_lshrrev_b32 v220, 4, v218
    v_add_u32 v221, s26, v218
    v_lshlrev_b32 v221, 10, v221
    v_mfma_f32_32x32x16_bf16 v[48:63], v[68:71], v[72:75], v[48:63]
    v_lshl_add_u32 v221, v219, 4, v221
    v_add_u32 v104, s27, v221
    v_add_u32 v105, 65536, v104
    v_add_u32 v221, 0, v220
    v_and_b32 v221, 7, v221
    s_waitcnt lgkmcnt(0)
    v_mfma_f32_32x32x16_bf16 v[32:47], v[76:79], v[84:87], v[32:47]
    v_xor_b32 v221, v221, v219
    v_lshlrev_b32 v221, 4, v221
    v_lshl_add_u32 v221, v218, 7, v221
    v_add_u32 v102, 145664, v221
    v_add_u32 v221, 4, v220
    v_mfma_f32_32x32x16_bf16 v[48:63], v[80:83], v[84:87], v[48:63]
    v_and_b32 v221, 7, v221
    v_xor_b32 v221, v221, v219
    v_lshlrev_b32 v221, 4, v221
    v_lshl_add_u32 v221, v218, 7, v221
    v_add_u32 v103, 153856, v221
    s_nop 7
    s_nop 1
    s_barrier
    v_cvt_pk_bf16_f32 v80, v32, v33
    v_cvt_pk_bf16_f32 v81, v34, v35
    v_cvt_pk_bf16_f32 v82, v36, v37
    v_cvt_pk_bf16_f32 v83, v38, v39
    v_cvt_pk_bf16_f32 v84, v40, v41
    v_cvt_pk_bf16_f32 v85, v42, v43
    v_cvt_pk_bf16_f32 v86, v44, v45
    v_cvt_pk_bf16_f32 v87, v46, v47
    ds_write_b64 v101, v[80:81] offset:0
    ds_write_b64 v101, v[82:83] offset:16
    ds_write_b64 v101, v[84:85] offset:32
    ds_write_b64 v101, v[86:87] offset:48
    v_cvt_pk_bf16_f32 v80, v48, v49
    v_cvt_pk_bf16_f32 v81, v50, v51
    v_cvt_pk_bf16_f32 v82, v52, v53
    v_cvt_pk_bf16_f32 v83, v54, v55
    v_cvt_pk_bf16_f32 v84, v56, v57
    v_cvt_pk_bf16_f32 v85, v58, v59
    v_cvt_pk_bf16_f32 v86, v60, v61
    v_cvt_pk_bf16_f32 v87, v62, v63
    ds_write_b64 v101, v[80:81] offset:64
    ds_write_b64 v101, v[82:83] offset:80
    ds_write_b64 v101, v[84:85] offset:96
    ds_write_b64 v101, v[86:87] offset:112
    s_waitcnt vmcnt(0) lgkmcnt(0)
    s_barrier
    v_lshrrev_b32 v5, 4, v1
    v_and_b32 v4, 15, v1
    s_mul_i32 s99, s20, 8
    v_add_u32 v246, s99, v5
    v_mul_u32_u24 v6, 272, v246
    v_lshl_add_u32 v244, v4, 4, v6
    v_mul_u32_u24 v6, 2048, v246
    v_lshl_add_u32 v6, v4, 4, v6
    v_add_u32 v245, s28, v6
    ds_read_b128 v[64:67], v244 offset:0
    ds_read_b128 v[68:71], v244 offset:1088
    s_mov_b32 s70, 0
    s_waitcnt lgkmcnt(1)
    buffer_store_dwordx4 v[64:67], v245, s[48:51], s70 offen sc1
    s_mov_b32 s70, 8192
    s_waitcnt lgkmcnt(0)
    buffer_store_dwordx4 v[68:71], v245, s[48:51], s70 offen sc1
    v_add_u32 v231, 0, v224
    ds_read2_b32 v[108:109], v231 offset0:0 offset1:1
    ds_read2_b32 v[110:111], v231 offset0:2 offset1:3
    ds_read2_b32 v[112:113], v231 offset0:16 offset1:17
    ds_read2_b32 v[114:115], v231 offset0:18 offset1:19
    v_xor_b32 v227, 0, v225
    v_xor_b32 v228, 0, v226
    ds_read_b128 v[140:143], v227 offset:0
    ds_read_b128 v[144:147], v228 offset:0
    v_add_u32 v231, 356, v224
    ds_read2_b32 v[116:117], v231 offset0:0 offset1:1
    ds_read2_b32 v[118:119], v231 offset0:2 offset1:3
    ds_read2_b32 v[120:121], v231 offset0:16 offset1:17
    ds_read2_b32 v[122:123], v231 offset0:18 offset1:19
    ds_read_b128 v[148:151], v227 offset:384
    ds_read_b128 v[152:155], v228 offset:384
    v_add_u32 v231, 712, v224
    ds_read2_b32 v[124:125], v231 offset0:0 offset1:1
    ds_read2_b32 v[126:127], v231 offset0:2 offset1:3
    ds_read2_b32 v[128:129], v231 offset0:16 offset1:17
    ds_read2_b32 v[130:131], v231 offset0:18 offset1:19
    v_xor_b32 v227, 16, v225
    v_xor_b32 v228, 16, v226
    ds_read_b128 v[156:159], v227 offset:768
    ds_read_b128 v[160:163], v228 offset:768
    v_add_u32 v231, 1068, v224
    ds_read2_b32 v[132:133], v231 offset0:0 offset1:1
    ds_read2_b32 v[134:135], v231 offset0:2 offset1:3
    ds_read2_b32 v[136:137], v231 offset0:16 offset1:17
    ds_read2_b32 v[138:139], v231 offset0:18 offset1:19
    ds_read_b128 v[164:167], v227 offset:1152
    ds_read_b128 v[168:171], v228 offset:1152
    s_waitcnt lgkmcnt(15)
    v_mfma_f32_16x16x32_bf16 v[172:175], v[108:111], v[140:143], 0
    v_mfma_f32_16x16x32_bf16 v[172:175], v[112:115], v[144:147], v[172:175]
    v_add_u32 v231, 1424, v224
    ds_read2_b32 v[108:109], v231 offset0:0 offset1:1
    ds_read2_b32 v[110:111], v231 offset0:2 offset1:3
    ds_read2_b32 v[112:113], v231 offset0:16 offset1:17
    ds_read2_b32 v[114:115], v231 offset0:18 offset1:19
    v_xor_b32 v227, 32, v225
    v_xor_b32 v228, 32, v226
    ds_read_b128 v[140:143], v227 offset:1536
    ds_read_b128 v[144:147], v228 offset:1536
    s_waitcnt lgkmcnt(15)
    v_mfma_f32_16x16x32_bf16 v[176:179], v[116:119], v[148:151], 0
    v_mfma_f32_16x16x32_bf16 v[176:179], v[120:123], v[152:155], v[176:179]
    v_add_u32 v231, 1780, v224
    ds_read2_b32 v[116:117], v231 offset0:0 offset1:1
    ds_read2_b32 v[118:119], v231 offset0:2 offset1:3
    ds_read2_b32 v[120:121], v231 offset0:16 offset1:17
    ds_read2_b32 v[122:123], v231 offset0:18 offset1:19
    ds_read_b128 v[148:151], v227 offset:1920
    ds_read_b128 v[152:155], v228 offset:1920
    s_waitcnt lgkmcnt(15)
    v_mfma_f32_16x16x32_bf16 v[180:183], v[124:127], v[156:159], 0
    v_mfma_f32_16x16x32_bf16 v[180:183], v[128:131], v[160:163], v[180:183]
    v_add_u32 v231, 2136, v224
    ds_read2_b32 v[124:125], v231 offset0:0 offset1:1
    ds_read2_b32 v[126:127], v231 offset0:2 offset1:3
    ds_read2_b32 v[128:129], v231 offset0:16 offset1:17
    ds_read2_b32 v[130:131], v231 offset0:18 offset1:19
    v_xor_b32 v227, 48, v225
    v_xor_b32 v228, 48, v226
    ds_read_b128 v[156:159], v227 offset:2304
    ds_read_b128 v[160:163], v228 offset:2304
    s_waitcnt lgkmcnt(15)
    v_mfma_f32_16x16x32_bf16 v[184:187], v[132:135], v[164:167], 0
    v_mfma_f32_16x16x32_bf16 v[184:187], v[136:139], v[168:171], v[184:187]
    v_add_u32 v231, 2492, v224
    ds_read2_b32 v[132:133], v231 offset0:0 offset1:1
    ds_read2_b32 v[134:135], v231 offset0:2 offset1:3
    ds_read2_b32 v[136:137], v231 offset0:16 offset1:17
    ds_read2_b32 v[138:139], v231 offset0:18 offset1:19
    ds_read_b128 v[164:167], v227 offset:2688
    ds_read_b128 v[168:171], v228 offset:2688
    s_waitcnt lgkmcnt(15)
    v_mfma_f32_16x16x32_bf16 v[188:191], v[108:111], v[140:143], 0
    v_mfma_f32_16x16x32_bf16 v[188:191], v[112:115], v[144:147], v[188:191]
    s_waitcnt lgkmcnt(12)
    v_mfma_f32_16x16x32_bf16 v[192:195], v[116:119], v[148:151], 0
    v_mfma_f32_16x16x32_bf16 v[192:195], v[120:123], v[152:155], v[192:195]
    v_cvt_pk_bf16_f32 v204, v172, v176
    v_cvt_pk_bf16_f32 v205, v180, v184
    v_cvt_pk_bf16_f32 v206, v173, v177
    v_cvt_pk_bf16_f32 v207, v181, v185
    v_cvt_pk_bf16_f32 v208, v174, v178
    v_cvt_pk_bf16_f32 v209, v182, v186
    v_cvt_pk_bf16_f32 v210, v175, v179
    v_cvt_pk_bf16_f32 v211, v183, v187
    s_mov_b32 exec_lo, 16711935
    s_mov_b32 exec_hi, 16711935
    ds_write_b64 v229, v[204:205] offset:0
    ds_write_b64 v229, v[206:207] offset:128
    ds_write_b64 v229, v[208:209] offset:256
    ds_write_b64 v229, v[210:211] offset:384
    s_mov_b64 exec, -1
    s_waitcnt lgkmcnt(6)
    v_mfma_f32_16x16x32_bf16 v[196:199], v[124:127], v[156:159], 0
    v_mfma_f32_16x16x32_bf16 v[196:199], v[128:131], v[160:163], v[196:199]
    s_waitcnt lgkmcnt(0)
    v_mfma_f32_16x16x32_bf16 v[200:203], v[132:135], v[164:167], 0
    v_mfma_f32_16x16x32_bf16 v[200:203], v[136:139], v[168:171], v[200:203]
    s_nop 7
    s_nop 1
    v_cvt_pk_bf16_f32 v204, v188, v192
    v_cvt_pk_bf16_f32 v205, v196, v200
    v_cvt_pk_bf16_f32 v206, v189, v193
    v_cvt_pk_bf16_f32 v207, v197, v201
    v_cvt_pk_bf16_f32 v208, v190, v194
    v_cvt_pk_bf16_f32 v209, v198, v202
    v_cvt_pk_bf16_f32 v210, v191, v195
    v_cvt_pk_bf16_f32 v211, v199, v203
    s_mov_b32 exec_lo, 16711935
    s_mov_b32 exec_hi, 16711935
    ds_write_b64 v229, v[204:205] offset:8
    ds_write_b64 v229, v[206:207] offset:136
    ds_write_b64 v229, v[208:209] offset:264
    ds_write_b64 v229, v[210:211] offset:392
    s_mov_b64 exec, -1
    s_waitcnt lgkmcnt(0)
    s_barrier
    ds_read_b128 v[32:35], v102
    ds_read_b128 v[36:39], v103
    s_waitcnt lgkmcnt(0)
    v_lshlrev_b32 v8, 16, v32
    v_and_b32 v9, 0xffff0000, v32
    v_lshlrev_b32 v10, 16, v236
    v_and_b32 v11, 0xffff0000, v236
    v_pk_mul_f32 v[8:9], v[8:9], v[10:11]
    v_cvt_pk_bf16_f32 v32, v8, v9
    v_lshlrev_b32 v8, 16, v33
    v_and_b32 v9, 0xffff0000, v33
    v_lshlrev_b32 v10, 16, v237
    v_and_b32 v11, 0xffff0000, v237
    v_pk_mul_f32 v[8:9], v[8:9], v[10:11]
    v_cvt_pk_bf16_f32 v33, v8, v9
    v_lshlrev_b32 v8, 16, v34
    v_and_b32 v9, 0xffff0000, v34
    v_lshlrev_b32 v10, 16, v238
    v_and_b32 v11, 0xffff0000, v238
    v_pk_mul_f32 v[8:9], v[8:9], v[10:11]
    v_cvt_pk_bf16_f32 v34, v8, v9
    v_lshlrev_b32 v8, 16, v35
    v_and_b32 v9, 0xffff0000, v35
    v_lshlrev_b32 v10, 16, v239
    v_and_b32 v11, 0xffff0000, v239
    v_pk_mul_f32 v[8:9], v[8:9], v[10:11]
    v_cvt_pk_bf16_f32 v35, v8, v9
    buffer_store_dwordx4 v[32:35], v104, s[60:63], 0 offen sc1
    v_lshlrev_b32 v8, 16, v36
    v_and_b32 v9, 0xffff0000, v36
    v_lshlrev_b32 v10, 16, v240
    v_and_b32 v11, 0xffff0000, v240
    v_pk_mul_f32 v[8:9], v[8:9], v[10:11]
    v_cvt_pk_bf16_f32 v36, v8, v9
    v_lshlrev_b32 v8, 16, v37
    v_and_b32 v9, 0xffff0000, v37
    v_lshlrev_b32 v10, 16, v241
    v_and_b32 v11, 0xffff0000, v241
    v_pk_mul_f32 v[8:9], v[8:9], v[10:11]
    v_cvt_pk_bf16_f32 v37, v8, v9
    v_lshlrev_b32 v8, 16, v38
    v_and_b32 v9, 0xffff0000, v38
    v_lshlrev_b32 v10, 16, v242
    v_and_b32 v11, 0xffff0000, v242
    v_pk_mul_f32 v[8:9], v[8:9], v[10:11]
    v_cvt_pk_bf16_f32 v38, v8, v9
    v_lshlrev_b32 v8, 16, v39
    v_and_b32 v9, 0xffff0000, v39
    v_lshlrev_b32 v10, 16, v243
    v_and_b32 v11, 0xffff0000, v243
    v_pk_mul_f32 v[8:9], v[8:9], v[10:11]
    v_cvt_pk_bf16_f32 v39, v8, v9
    buffer_store_dwordx4 v[36:39], v105, s[60:63], 0 offen sc1
    s_endpgm
k2V_loader:
    v_and_b32 v1, 63, v0
    v_and_b32 v12, 255, v0
    s_mul_i32 s99, s25, 32
    s_mul_i32 s64, s25, 4096
    s_add_u32 s99, s99, s26
    v_lshrrev_b32 v4, 3, v1
    v_lshrrev_b32 v5, 4, v1
    v_and_b32 v6, 7, v1
    v_xor_b32 v5, v5, v6
    v_add_u32 v4, s99, v4
    v_mul_i32_i24 v4, 5120, v4
    v_lshl_add_u32 v13, v5, 4, v4
    v_xor_b32 v5, 4, v5
    v_lshl_add_u32 v6, v5, 4, v4
    v_add_u32 v14, 39936, v6
    v_add_u32 v15, 79872, v13
    v_add_u32 v16, 119808, v6
    s_mul_i32 s66, s25, 2048
    s_mul_i32 s99, s25, 16384
    s_add_u32 s99, s99, s27
    v_lshrrev_b32 v5, 3, v1
    v_and_b32 v4, 7, v1
    v_bfe_u32 v6, v5, 1, 1
    v_lshlrev_b32 v6, 2, v6
    v_xor_b32 v4, v4, v6
    v_mul_u32_u24 v5, 1024, v5
    v_lshl_add_u32 v17, v4, 4, v5
    v_add_u32 v17, s99, v17
    v_add_u32 v18, 7168, v17
    s_mov_b32 s68, s24
    s_lshl_b32 s65, s68, 7
    s_add_u32 s65, s65, 2048
    s_lshl_b32 s67, s68, 16
    s_waitcnt lgkmcnt(0)
    s_mul_i32 s38, s21, 5120000
    s_add_u32 s8, s30, s38
    s_addc_u32 s9, s31, 0
    s_mov_b32 s10, 5120000
    s_mov_b32 s11, 0x20000
    s_mov_b32 s44, s4
    s_mov_b32 s45, s5
    s_mov_b32 s46, 524288
    s_mov_b32 s47, 0x20000
    s_add_u32 m0, s64, 0
    s_nop 0
    buffer_load_dwordx4 v13, s[8:11], s65 offen offset:0  lds
    buffer_load_dwordx4 v14, s[8:11], s65 offen offset:1024  lds
    buffer_load_dwordx4 v15, s[8:11], s65 offen offset:2048  lds
    buffer_load_dwordx4 v16, s[8:11], s65 offen offset:3072  lds
    s_add_u32 m0, s66, 16384
    s_nop 0
    buffer_load_dwordx4 v17, s[44:47], s67 offen offset:0  lds
    buffer_load_dwordx4 v18, s[44:47], s67 offen offset:1024  lds
    s_add_u32 s68, s68, 1
    s_and_b32 s68, s68, 7
    s_lshl_b32 s65, s68, 7
    s_add_u32 s65, s65, 2048
    s_lshl_b32 s67, s68, 16
    s_add_u32 m0, s64, 24576
    s_nop 0
    buffer_load_dwordx4 v13, s[8:11], s65 offen offset:0  lds
    buffer_load_dwordx4 v14, s[8:11], s65 offen offset:1024  lds
    buffer_load_dwordx4 v15, s[8:11], s65 offen offset:2048  lds
    buffer_load_dwordx4 v16, s[8:11], s65 offen offset:3072  lds
    s_add_u32 m0, s66, 40960
    s_nop 0
    buffer_load_dwordx4 v17, s[44:47], s67 offen offset:0  lds
    buffer_load_dwordx4 v18, s[44:47], s67 offen offset:1024  lds
    s_add_u32 s68, s68, 1
    s_and_b32 s68, s68, 7
    s_lshl_b32 s65, s68, 7
    s_add_u32 s65, s65, 2048
    s_lshl_b32 s67, s68, 16
    s_waitcnt vmcnt(6)
    s_barrier
    s_add_u32 m0, s64, 49152
    s_nop 0
    buffer_load_dwordx4 v13, s[8:11], s65 offen offset:0  lds
    buffer_load_dwordx4 v14, s[8:11], s65 offen offset:1024  lds
    buffer_load_dwordx4 v15, s[8:11], s65 offen offset:2048  lds
    buffer_load_dwordx4 v16, s[8:11], s65 offen offset:3072  lds
    s_add_u32 m0, s66, 65536
    s_nop 0
    buffer_load_dwordx4 v17, s[44:47], s67 offen offset:0  lds
    buffer_load_dwordx4 v18, s[44:47], s67 offen offset:1024  lds
    s_add_u32 s68, s68, 1
    s_and_b32 s68, s68, 7
    s_lshl_b32 s65, s68, 7
    s_add_u32 s65, s65, 2048
    s_lshl_b32 s67, s68, 16
    s_add_u32 s48, s30, 16777216
    s_addc_u32 s49, s31, 0
    s_mov_b32 s50, 2097152
    s_mov_b32 s51, 0x20000
    s_mul_i32 s38, s21, 1024000
    s_add_u32 s60, s30, s38
    s_addc_u32 s61, s31, 0
    s_add_u32 s60, s60, 19922944
    s_addc_u32 s61, s61, 0
    s_mov_b32 s62, 1024000
    s_mov_b32 s63, 0x20000
    s_lshl_b32 s69, s26, 10
    s_waitcnt vmcnt(6)
    s_barrier
    s_add_u32 m0, s64, 73728
    s_nop 0
    buffer_load_dwordx4 v13, s[8:11], s65 offen offset:0  lds
    buffer_load_dwordx4 v14, s[8:11], s65 offen offset:1024  lds
    buffer_load_dwordx4 v15, s[8:11], s65 offen offset:2048  lds
    buffer_load_dwordx4 v16, s[8:11], s65 offen offset:3072  lds
    s_add_u32 m0, s66, 90112
    s_nop 0
    buffer_load_dwordx4 v17, s[44:47], s67 offen offset:0  lds
    buffer_load_dwordx4 v18, s[44:47], s67 offen offset:1024  lds
    s_add_u32 s68, s68, 1
    s_and_b32 s68, s68, 7
    s_lshl_b32 s65, s68, 7
    s_add_u32 s65, s65, 2048
    s_lshl_b32 s67, s68, 16
    s_waitcnt vmcnt(6)
    s_barrier
    s_add_u32 m0, s64, 0
    s_nop 0
    buffer_load_dwordx4 v13, s[8:11], s65 offen offset:0  lds
    buffer_load_dwordx4 v14, s[8:11], s65 offen offset:1024  lds
    buffer_load_dwordx4 v15, s[8:11], s65 offen offset:2048  lds
    buffer_load_dwordx4 v16, s[8:11], s65 offen offset:3072  lds
    s_add_u32 m0, s66, 16384
    s_nop 0
    buffer_load_dwordx4 v17, s[44:47], s67 offen offset:0  lds
    buffer_load_dwordx4 v18, s[44:47], s67 offen offset:1024  lds
    s_add_u32 s68, s68, 1
    s_and_b32 s68, s68, 7
    s_lshl_b32 s65, s68, 7
    s_add_u32 s65, s65, 2048
    s_lshl_b32 s67, s68, 16
    s_waitcnt vmcnt(6)
    s_barrier
    s_add_u32 m0, s64, 24576
    s_nop 0
    buffer_load_dwordx4 v13, s[8:11], s65 offen offset:0  lds
    buffer_load_dwordx4 v14, s[8:11], s65 offen offset:1024  lds
    buffer_load_dwordx4 v15, s[8:11], s65 offen offset:2048  lds
    buffer_load_dwordx4 v16, s[8:11], s65 offen offset:3072  lds
    s_add_u32 m0, s66, 40960
    s_nop 0
    buffer_load_dwordx4 v17, s[44:47], s67 offen offset:0  lds
    buffer_load_dwordx4 v18, s[44:47], s67 offen offset:1024  lds
    s_add_u32 s68, s68, 1
    s_and_b32 s68, s68, 7
    s_lshl_b32 s65, s68, 7
    s_add_u32 s65, s65, 2048
    s_lshl_b32 s67, s68, 16
    s_waitcnt vmcnt(6)
    s_barrier
    s_add_u32 m0, s64, 49152
    s_nop 0
    buffer_load_dwordx4 v13, s[8:11], s65 offen offset:0  lds
    buffer_load_dwordx4 v14, s[8:11], s65 offen offset:1024  lds
    buffer_load_dwordx4 v15, s[8:11], s65 offen offset:2048  lds
    buffer_load_dwordx4 v16, s[8:11], s65 offen offset:3072  lds
    s_add_u32 m0, s66, 65536
    s_nop 0
    buffer_load_dwordx4 v17, s[44:47], s67 offen offset:0  lds
    buffer_load_dwordx4 v18, s[44:47], s67 offen offset:1024  lds
    s_add_u32 s68, s68, 1
    s_and_b32 s68, s68, 7
    s_lshl_b32 s65, s68, 7
    s_add_u32 s65, s65, 2048
    s_lshl_b32 s67, s68, 16
    s_cmp_lt_u32 s33, 16
    s_cbranch_scc0 .Lpf4_skip
    s_cmp_eq_u32 s25, 0
    s_cbranch_scc0 .Lpf4_skip
    s_getpc_b64 s[96:97]
.Lpf4_pc:
    s_add_u32 s96, s96, (k2_kernel - .Lpf4_pc) & 0xffffffff
    s_addc_u32 s97, s97, ((k2_kernel - .Lpf4_pc) >> 32) & 0xffffffff
    v_and_b32 v254, 63, v0
    s_lshl_b32 s98, s33, 6
    v_add_u32 v254, s98, v254
    v_lshlrev_b32 v254, 7, v254
    v_min_u32 v254, (k3_exit - k2_kernel - 4), v254
    global_load_dword v255, v254, s[96:97]
.Lpf4_skip:
    s_waitcnt vmcnt(6)
    s_barrier
    s_add_u32 m0, s64, 73728
    s_nop 0
    buffer_load_dwordx4 v13, s[8:11], s65 offen offset:0  lds
    buffer_load_dwordx4 v14, s[8:11], s65 offen offset:1024  lds
    buffer_load_dwordx4 v15, s[8:11], s65 offen offset:2048  lds
    buffer_load_dwordx4 v16, s[8:11], s65 offen offset:3072  lds
    s_add_u32 m0, s66, 90112
    s_nop 0
    buffer_load_dwordx4 v17, s[44:47], s67 offen offset:0  lds
    buffer_load_dwordx4 v18, s[44:47], s67 offen offset:1024  lds
    s_add_u32 s68, s68, 1
    s_and_b32 s68, s68, 7
    s_lshl_b32 s65, s68, 7
    s_add_u32 s65, s65, 2048
    s_lshl_b32 s67, s68, 16
    s_waitcnt vmcnt(6)
    s_barrier
    v_and_b32 v4, 15, v1
    v_lshrrev_b32 v5, 4, v1
    v_lshlrev_b32 v6, 3, v5
    v_sub_u32 v6, v6, v4
    v_add_u32 v6, 15, v6
    v_and_b32 v124, 1, v6
    v_mul_u32_u24 v124, 176, v124
    v_lshrrev_b32 v6, 1, v6
    v_lshl_add_u32 v124, v6, 2, v124
    s_mul_i32 s99, s20, 2848
    s_add_u32 s99, s99, 122880
    v_add_u32 v124, s99, v124
    v_lshl_add_u32 v6, v4, 1, v5
    v_lshlrev_b32 v6, 4, v6
    s_mul_i32 s99, s20, 3072
    s_add_u32 s99, s99, 98304
    v_add_u32 v125, s99, v6
    v_add_u32 v126, 64, v125
    s_and_b32 s99, s20, 1
    s_lshl_b32 s99, s99, 6
    v_xor_b32 v125, s99, v125
    s_and_b32 s99, s20, 1
    s_lshl_b32 s99, s99, 6
    v_xor_b32 v126, s99, v126
    v_lshlrev_b32 v6, 2, v5
    v_lshl_add_u32 v6, v4, 4, v6
    v_lshlrev_b32 v6, 7, v6
    v_add_u32 v6, 145664, v6
    v_and_b32 v4, 7, v4
    s_mul_i32 s99, s20, 1
    s_add_u32 s99, s99, 0
    v_xor_b32 v5, s99, v4
    v_lshl_add_u32 v129, v5, 4, v6
    v_lshrrev_b32 v4, 3, v0
    v_and_b32 v5, 7, v0
    v_lshrrev_b32 v6, 4, v4
    v_add_u32 v7, s26, v4
    v_lshlrev_b32 v7, 10, v7
    v_lshl_add_u32 v7, v5, 4, v7
    v_add_u32 v134, s27, v7
    v_add_u32 v135, 65536, v134
    v_add_u32 v7, 0, v6
    v_and_b32 v7, 7, v7
    v_xor_b32 v7, v7, v5
    v_lshlrev_b32 v7, 4, v7
    v_lshl_add_u32 v7, v4, 7, v7
    v_add_u32 v132, 145664, v7
    v_add_u32 v7, 4, v6
    v_and_b32 v7, 7, v7
    v_xor_b32 v7, v7, v5
    v_lshlrev_b32 v7, 4, v7
    v_lshl_add_u32 v7, v4, 7, v7
    v_add_u32 v133, 153856, v7
    v_lshrrev_b32 v4, 3, v0
    v_add_u32 v4, s26, v4
    v_mul_u32_u24 v4, 5120, v4
    v_and_b32 v5, 7, v0
    v_lshl_add_u32 v4, v5, 4, v4
    s_add_u32 s99, s27, 3072
    v_add_u32 v4, s99, v4
    s_mov_b32 s99, 0
    buffer_load_dwordx4 v[136:139], v4, s[8:11], s99 offen
    s_mov_b32 s99, 327680
    buffer_load_dwordx4 v[140:143], v4, s[8:11], s99 offen
    s_waitcnt vmcnt(2)
    s_barrier
    s_lshl_b32 s98, s33, 2
    s_add_u32 s98, s98, s25
    s_lshl_b32 s98, s98, 13
    v_and_b32 v4, 63, v0
    v_lshlrev_b32 v4, 7, v4
    v_add_u32 v4, s98, v4
    s_load_dwordx2 s[76:77], s[0:1], 40
    s_mov_b32 s78, 524288
    s_mov_b32 s79, 0x20000
    s_waitcnt lgkmcnt(0)
    buffer_load_dword v252, v4, s[76:79], 0 offen
    s_load_dwordx2 s[76:77], s[0:1], 48
    s_mov_b32 s78, 63488
    s_mov_b32 s79, 0x20000
    s_waitcnt lgkmcnt(0)
    buffer_load_dword v252, v4, s[76:79], 0 offen
    s_waitcnt vmcnt(2)
    s_barrier
    s_barrier
    v_lshrrev_b32 v5, 4, v1
    v_and_b32 v4, 15, v1
    s_mul_i32 s99, s20, 8
    v_add_u32 v162, s99, v5
    v_mul_u32_u24 v6, 272, v162
    v_lshl_add_u32 v160, v4, 4, v6
    v_mul_u32_u24 v6, 2048, v162
    v_lshl_add_u32 v6, v4, 4, v6
    v_add_u32 v161, s28, v6
    ds_read_b128 v[144:147], v160 offset:0
    ds_read_b128 v[148:151], v160 offset:1088
    s_mov_b32 s69, 0
    s_waitcnt lgkmcnt(1)
    buffer_store_dwordx4 v[144:147], v161, s[48:51], s69 offen sc1
    s_mov_b32 s69, 8192
    s_waitcnt lgkmcnt(0)
    buffer_store_dwordx4 v[148:151], v161, s[48:51], s69 offen sc1
    v_add_u32 v131, 0, v124
    ds_read2_b32 v[20:21], v131 offset0:0 offset1:1
    ds_read2_b32 v[22:23], v131 offset0:2 offset1:3
    ds_read2_b32 v[24:25], v131 offset0:16 offset1:17
    ds_read2_b32 v[26:27], v131 offset0:18 offset1:19
    v_xor_b32 v127, 0, v125
    v_xor_b32 v128, 0, v126
    ds_read_b128 v[52:55], v127 offset:0
    ds_read_b128 v[56:59], v128 offset:0
    v_add_u32 v131, 356, v124
    ds_read2_b32 v[28:29], v131 offset0:0 offset1:1
    ds_read2_b32 v[30:31], v131 offset0:2 offset1:3
    ds_read2_b32 v[32:33], v131 offset0:16 offset1:17
    ds_read2_b32 v[34:35], v131 offset0:18 offset1:19
    ds_read_b128 v[60:63], v127 offset:384
    ds_read_b128 v[64:67], v128 offset:384
    v_add_u32 v131, 712, v124
    ds_read2_b32 v[36:37], v131 offset0:0 offset1:1
    ds_read2_b32 v[38:39], v131 offset0:2 offset1:3
    ds_read2_b32 v[40:41], v131 offset0:16 offset1:17
    ds_read2_b32 v[42:43], v131 offset0:18 offset1:19
    v_xor_b32 v127, 16, v125
    v_xor_b32 v128, 16, v126
    ds_read_b128 v[68:71], v127 offset:768
    ds_read_b128 v[72:75], v128 offset:768
    v_add_u32 v131, 1068, v124
    ds_read2_b32 v[44:45], v131 offset0:0 offset1:1
    ds_read2_b32 v[46:47], v131 offset0:2 offset1:3
    ds_read2_b32 v[48:49], v131 offset0:16 offset1:17
    ds_read2_b32 v[50:51], v131 offset0:18 offset1:19
    ds_read_b128 v[76:79], v127 offset:1152
    ds_read_b128 v[80:83], v128 offset:1152
    s_waitcnt lgkmcnt(15)
    v_mfma_f32_16x16x32_bf16 v[84:87], v[20:23], v[52:55], 0
    v_mfma_f32_16x16x32_bf16 v[84:87], v[24:27], v[56:59], v[84:87]
    v_add_u32 v131, 1424, v124
    ds_read2_b32 v[20:21], v131 offset0:0 offset1:1
    ds_read2_b32 v[22:23], v131 offset0:2 offset1:3
    ds_read2_b32 v[24:25], v131 offset0:16 offset1:17
    ds_read2_b32 v[26:27], v131 offset0:18 offset1:19
    v_xor_b32 v127, 32, v125
    v_xor_b32 v128, 32, v126
    ds_read_b128 v[52:55], v127 offset:1536
    ds_read_b128 v[56:59], v128 offset:1536
    s_waitcnt lgkmcnt(15)
    v_mfma_f32_16x16x32_bf16 v[88:91], v[28:31], v[60:63], 0
    v_mfma_f32_16x16x32_bf16 v[88:91], v[32:35], v[64:67], v[88:91]
    v_add_u32 v131, 1780, v124
    ds_read2_b32 v[28:29], v131 offset0:0 offset1:1
    ds_read2_b32 v[30:31], v131 offset0:2 offset1:3
    ds_read2_b32 v[32:33], v131 offset0:16 offset1:17
    ds_read2_b32 v[34:35], v131 offset0:18 offset1:19
    ds_read_b128 v[60:63], v127 offset:1920
    ds_read_b128 v[64:67], v128 offset:1920
    s_waitcnt lgkmcnt(15)
    v_mfma_f32_16x16x32_bf16 v[92:95], v[36:39], v[68:71], 0
    v_mfma_f32_16x16x32_bf16 v[92:95], v[40:43], v[72:75], v[92:95]
    v_add_u32 v131, 2136, v124
    ds_read2_b32 v[36:37], v131 offset0:0 offset1:1
    ds_read2_b32 v[38:39], v131 offset0:2 offset1:3
    ds_read2_b32 v[40:41], v131 offset0:16 offset1:17
    ds_read2_b32 v[42:43], v131 offset0:18 offset1:19
    v_xor_b32 v127, 48, v125
    v_xor_b32 v128, 48, v126
    ds_read_b128 v[68:71], v127 offset:2304
    ds_read_b128 v[72:75], v128 offset:2304
    s_waitcnt lgkmcnt(15)
    v_mfma_f32_16x16x32_bf16 v[96:99], v[44:47], v[76:79], 0
    v_mfma_f32_16x16x32_bf16 v[96:99], v[48:51], v[80:83], v[96:99]
    v_add_u32 v131, 2492, v124
    ds_read2_b32 v[44:45], v131 offset0:0 offset1:1
    ds_read2_b32 v[46:47], v131 offset0:2 offset1:3
    ds_read2_b32 v[48:49], v131 offset0:16 offset1:17
    ds_read2_b32 v[50:51], v131 offset0:18 offset1:19
    ds_read_b128 v[76:79], v127 offset:2688
    ds_read_b128 v[80:83], v128 offset:2688
    s_waitcnt lgkmcnt(15)
    v_mfma_f32_16x16x32_bf16 v[100:103], v[20:23], v[52:55], 0
    v_mfma_f32_16x16x32_bf16 v[100:103], v[24:27], v[56:59], v[100:103]
    s_waitcnt lgkmcnt(12)
    v_mfma_f32_16x16x32_bf16 v[104:107], v[28:31], v[60:63], 0
    v_mfma_f32_16x16x32_bf16 v[104:107], v[32:35], v[64:67], v[104:107]
    v_cvt_pk_bf16_f32 v116, v84, v88
    v_cvt_pk_bf16_f32 v117, v92, v96
    v_cvt_pk_bf16_f32 v118, v85, v89
    v_cvt_pk_bf16_f32 v119, v93, v97
    v_cvt_pk_bf16_f32 v120, v86, v90
    v_cvt_pk_bf16_f32 v121, v94, v98
    v_cvt_pk_bf16_f32 v122, v87, v91
    v_cvt_pk_bf16_f32 v123, v95, v99
    s_mov_b32 exec_lo, 16711935
    s_mov_b32 exec_hi, 16711935
    ds_write_b64 v129, v[116:117] offset:0
    ds_write_b64 v129, v[118:119] offset:128
    ds_write_b64 v129, v[120:121] offset:256
    ds_write_b64 v129, v[122:123] offset:384
    s_mov_b64 exec, -1
    s_waitcnt lgkmcnt(6)
    v_mfma_f32_16x16x32_bf16 v[108:111], v[36:39], v[68:71], 0
    v_mfma_f32_16x16x32_bf16 v[108:111], v[40:43], v[72:75], v[108:111]
    s_waitcnt lgkmcnt(0)
    v_mfma_f32_16x16x32_bf16 v[112:115], v[44:47], v[76:79], 0
    v_mfma_f32_16x16x32_bf16 v[112:115], v[48:51], v[80:83], v[112:115]
    s_nop 7
    s_nop 1
    v_cvt_pk_bf16_f32 v116, v100, v104
    v_cvt_pk_bf16_f32 v117, v108, v112
    v_cvt_pk_bf16_f32 v118, v101, v105
    v_cvt_pk_bf16_f32 v119, v109, v113
    v_cvt_pk_bf16_f32 v120, v102, v106
    v_cvt_pk_bf16_f32 v121, v110, v114
    v_cvt_pk_bf16_f32 v122, v103, v107
    v_cvt_pk_bf16_f32 v123, v111, v115
    s_mov_b32 exec_lo, 16711935
    s_mov_b32 exec_hi, 16711935
    ds_write_b64 v129, v[116:117] offset:8
    ds_write_b64 v129, v[118:119] offset:136
    ds_write_b64 v129, v[120:121] offset:264
    ds_write_b64 v129, v[122:123] offset:392
    s_mov_b64 exec, -1
    s_waitcnt lgkmcnt(0)
    s_barrier
    ds_read_b128 v[152:155], v132
    ds_read_b128 v[156:159], v133
    s_waitcnt lgkmcnt(0)
    v_lshlrev_b32 v8, 16, v152
    v_and_b32 v9, 0xffff0000, v152
    v_lshlrev_b32 v10, 16, v136
    v_and_b32 v11, 0xffff0000, v136
    v_pk_mul_f32 v[8:9], v[8:9], v[10:11]
    v_cvt_pk_bf16_f32 v152, v8, v9
    v_lshlrev_b32 v8, 16, v153
    v_and_b32 v9, 0xffff0000, v153
    v_lshlrev_b32 v10, 16, v137
    v_and_b32 v11, 0xffff0000, v137
    v_pk_mul_f32 v[8:9], v[8:9], v[10:11]
    v_cvt_pk_bf16_f32 v153, v8, v9
    v_lshlrev_b32 v8, 16, v154
    v_and_b32 v9, 0xffff0000, v154
    v_lshlrev_b32 v10, 16, v138
    v_and_b32 v11, 0xffff0000, v138
    v_pk_mul_f32 v[8:9], v[8:9], v[10:11]
    v_cvt_pk_bf16_f32 v154, v8, v9
    v_lshlrev_b32 v8, 16, v155
    v_and_b32 v9, 0xffff0000, v155
    v_lshlrev_b32 v10, 16, v139
    v_and_b32 v11, 0xffff0000, v139
    v_pk_mul_f32 v[8:9], v[8:9], v[10:11]
    v_cvt_pk_bf16_f32 v155, v8, v9
    buffer_store_dwordx4 v[152:155], v134, s[60:63], 0 offen sc1
    v_lshlrev_b32 v8, 16, v156
    v_and_b32 v9, 0xffff0000, v156
    v_lshlrev_b32 v10, 16, v140
    v_and_b32 v11, 0xffff0000, v140
    v_pk_mul_f32 v[8:9], v[8:9], v[10:11]
    v_cvt_pk_bf16_f32 v156, v8, v9
    v_lshlrev_b32 v8, 16, v157
    v_and_b32 v9, 0xffff0000, v157
    v_lshlrev_b32 v10, 16, v141
    v_and_b32 v11, 0xffff0000, v141
    v_pk_mul_f32 v[8:9], v[8:9], v[10:11]
    v_cvt_pk_bf16_f32 v157, v8, v9
    v_lshlrev_b32 v8, 16, v158
    v_and_b32 v9, 0xffff0000, v158
    v_lshlrev_b32 v10, 16, v142
    v_and_b32 v11, 0xffff0000, v142
    v_pk_mul_f32 v[8:9], v[8:9], v[10:11]
    v_cvt_pk_bf16_f32 v158, v8, v9
    v_lshlrev_b32 v8, 16, v159
    v_and_b32 v9, 0xffff0000, v159
    v_lshlrev_b32 v10, 16, v143
    v_and_b32 v11, 0xffff0000, v143
    v_pk_mul_f32 v[8:9], v[8:9], v[10:11]
    v_cvt_pk_bf16_f32 v159, v8, v9
    buffer_store_dwordx4 v[156:159], v135, s[60:63], 0 offen sc1
    s_endpgm
k2_exit:
    s_endpgm
.globl k3_kernel
.p2align 8
.type k3_kernel,@function
k3_kernel:
    s_cmp_ge_u32 s2, 256
    s_cbranch_scc1 k3_exit
k3_begin:
    s_load_dwordx2 s[30:31], s[0:1], 80
    s_load_dwordx2 s[4:5], s[0:1], 40
    s_load_dwordx2 s[6:7], s[0:1], 48
    v_lshrrev_b32 v1, 6, v0
    s_and_b32 s32, s2, 7
    s_lshr_b32 s33, s2, 3
    v_readfirstlane_b32 s20, v1
    s_cmp_ge_u32 s33, 22
    s_cbranch_scc1 k3_typeL
    s_lshr_b32 s21, s32, 2
    s_and_b32 s34, s32, 3
    s_mul_i32 s34, s34, 22
    s_add_u32 s34, s34, s33
    s_lshr_b32 s22, s34, 3
    s_and_b32 s23, s34, 7
    s_mul_i32 s26, s22, 96
    s_lshl_b32 s27, s23, 7
    s_and_b32 s25, s20, 3
    s_cmp_ge_u32 s20, 4
    s_cbranch_scc1 k3P_loader
    v_and_b32 v1, 63, v0
    s_and_b32 s56, s20, 1
    s_lshr_b32 s57, s20, 1
    v_and_b32 v4, 31, v1
    s_lshl_b32 s99, s56, 5
    v_add_u32 v44, s99, v4
    s_lshl_b32 s99, s57, 6
    v_add_u32 v45, s99, v4
    v_bfe_u32 v4, v44, 1, 3
    v_lshrrev_b32 v5, 5, v1
    v_xor_b32 v4, v4, v5
    v_lshlrev_b32 v4, 4, v4
    v_lshl_add_u32 v4, v44, 7, v4
    v_add_u32 v12, 0, v4
    v_add_u32 v16, 24576, v4
    v_add_u32 v20, 49152, v4
    v_add_u32 v24, 73728, v4
    v_xor_b32 v5, 32, v4
    v_add_u32 v13, 0, v5
    v_add_u32 v17, 24576, v5
    v_add_u32 v21, 49152, v5
    v_add_u32 v25, 73728, v5
    v_xor_b32 v5, 64, v4
    v_add_u32 v14, 0, v5
    v_add_u32 v18, 24576, v5
    v_add_u32 v22, 49152, v5
    v_add_u32 v26, 73728, v5
    v_xor_b32 v5, 96, v4
    v_add_u32 v15, 0, v5
    v_add_u32 v19, 24576, v5
    v_add_u32 v23, 49152, v5
    v_add_u32 v27, 73728, v5
    v_bfe_u32 v4, v45, 1, 3
    v_lshrrev_b32 v5, 5, v1
    v_xor_b32 v4, v4, v5
    v_lshlrev_b32 v4, 4, v4
    v_lshl_add_u32 v4, v45, 7, v4
    v_add_u32 v28, 8192, v4
    v_add_u32 v32, 32768, v4
    v_add_u32 v36, 57344, v4
    v_add_u32 v40, 81920, v4
    v_xor_b32 v5, 32, v4
    v_add_u32 v29, 8192, v5
    v_add_u32 v33, 32768, v5
    v_add_u32 v37, 57344, v5
    v_add_u32 v41, 81920, v5
    v_xor_b32 v5, 64, v4
    v_add_u32 v30, 8192, v5
    v_add_u32 v34, 32768, v5
    v_add_u32 v38, 57344, v5
    v_add_u32 v42, 81920, v5
    v_xor_b32 v5, 96, v4
    v_add_u32 v31, 8192, v5
    v_add_u32 v35, 32768, v5
    v_add_u32 v39, 57344, v5
    v_add_u32 v43, 81920, v5
    v_lshlrev_b32 v208, 2, v45
    v_add_u32 v208, 98304, v208
    v_and_b32 v4, 127, v0
    s_sub_u32 s99, s26, 16
    v_add_u32 v4, s99, v4
    v_cmp_gt_u32 vcc, 1000, v4
    v_mov_b32 v6, 0
    v_mov_b32 v7, 1.0
    v_cndmask_b32 v224, v6, v7, vcc
    v_max_i32 v5, 0, v4
    v_min_i32 v5, 999, v5
    s_lshl_b32 s99, s21, 10
    v_add_u32 v5, s99, v5
    v_lshlrev_b32 v108, 6, v5
    s_waitcnt lgkmcnt(0)
    s_add_u32 s16, s30, 15728640
    s_addc_u32 s17, s31, 0
    s_mov_b32 s18, 131072
    s_mov_b32 s19, 0x20000
    buffer_load_dwordx4 v[80:83], v108, s[16:19], 0 offen offset:0
    buffer_load_dwordx4 v[84:87], v108, s[16:19], 0 offen offset:16
    buffer_load_dwordx4 v[88:91], v108, s[16:19], 0 offen offset:32
    buffer_load_dwordx4 v[92:95], v108, s[16:19], 0 offen offset:48
    s_mov_b32 s44, s6
    s_mov_b32 s45, s7
    s_mov_b32 s46, 63488
    s_mov_b32 s47, 0x20000
    v_and_b32 v4, 63, v0
    v_lshrrev_b32 v5, 6, v0
    v_mul_u32_u24 v5, 2048, v5
    v_lshl_add_u32 v4, v4, 1, v5
    v_add_u32 v4, s27, v4
    s_mov_b32 s99, 0
    buffer_load_ushort v216, v4, s[44:47], s99 offen
    s_mov_b32 s99, 8192
    buffer_load_ushort v217, v4, s[44:47], s99 offen
    s_mov_b32 s99, 16384
    buffer_load_ushort v218, v4, s[44:47], s99 offen
    s_mov_b32 s99, 24576
    buffer_load_ushort v219, v4, s[44:47], s99 offen
    s_mov_b32 s99, 32768
    buffer_load_ushort v220, v4, s[44:47], s99 offen
    s_mov_b32 s99, 40960
    buffer_load_ushort v221, v4, s[44:47], s99 offen
    s_mov_b32 s99, 49152
    buffer_load_ushort v222, v4, s[44:47], s99 offen
    s_mov_b32 s99, 57344
    buffer_load_ushort v223, v4, s[44:47], s99 offen
    s_mul_i32 s38, s21, 2048000
    s_add_u32 s48, s30, s38
    s_addc_u32 s49, s31, 0
    s_add_u32 s48, s48, 22020096
    s_addc_u32 s49, s49, 0
    s_mov_b32 s50, 2048000
    s_mov_b32 s51, 0x20000
    s_barrier
    ds_read_b128 v[144:147], v12 offset:0
    ds_read_b128 v[148:151], v28 offset:0
    ds_read_b128 v[152:155], v28 offset:4096
    ds_read_b128 v[156:159], v13 offset:0
    ds_read_b128 v[160:163], v29 offset:0
    ds_read_b128 v[164:167], v29 offset:4096
    ds_read_b128 v[168:171], v14 offset:0
    ds_read_b128 v[172:175], v30 offset:0
    ds_read_b128 v[176:179], v30 offset:4096
    s_waitcnt lgkmcnt(6)
    v_mfma_f32_32x32x16_bf16 v[48:63], v[144:147], v[148:151], 0
    ds_read_b128 v[180:183], v15 offset:0
    ds_read_b128 v[184:187], v31 offset:0
    ds_read_b128 v[188:191], v31 offset:4096
    s_waitcnt vmcnt(8)
    v_max3_f32 v225, v80, v82, v84
    v_max3_f32 v225, v225, v86, v88
    v_max3_f32 v225, v225, v90, v92
    v_max_f32 v225, v225, v94
    v_sub_f32 v80, v80, v225
    v_sub_f32 v82, v82, v225
    v_mfma_f32_32x32x16_bf16 v[64:79], v[144:147], v[152:155], 0
    v_sub_f32 v84, v84, v225
    v_sub_f32 v86, v86, v225
    v_sub_f32 v88, v88, v225
    v_sub_f32 v90, v90, v225
    v_sub_f32 v92, v92, v225
    v_sub_f32 v94, v94, v225
    s_waitcnt lgkmcnt(6)
    v_mfma_f32_32x32x16_bf16 v[48:63], v[156:159], v[160:163], v[48:63]
    s_barrier
    ds_read_b128 v[144:147], v16 offset:0
    ds_read_b128 v[148:151], v32 offset:0
    ds_read_b128 v[152:155], v32 offset:4096
    v_exp_f32 v80, v80
    v_exp_f32 v82, v82
    v_exp_f32 v84, v84
    v_exp_f32 v86, v86
    v_exp_f32 v88, v88
    v_exp_f32 v90, v90
    v_exp_f32 v92, v92
    v_mfma_f32_32x32x16_bf16 v[64:79], v[156:159], v[164:167], v[64:79]
    v_exp_f32 v94, v94
    s_nop 0
    v_mul_f32 v226, v80, v81
    v_fmac_f32 v226, v82, v83
    v_fmac_f32 v226, v84, v85
    v_fmac_f32 v226, v86, v87
    v_fmac_f32 v226, v88, v89
    s_waitcnt lgkmcnt(6)
    v_mfma_f32_32x32x16_bf16 v[48:63], v[168:171], v[172:175], v[48:63]
    ds_read_b128 v[156:159], v17 offset:0
    ds_read_b128 v[160:163], v33 offset:0
    ds_read_b128 v[164:167], v33 offset:4096
    v_fmac_f32 v226, v90, v91
    v_fmac_f32 v226, v92, v93
    v_fmac_f32 v226, v94, v95
    v_rcp_f32 v226, v226
    s_nop 0
    v_mul_f32 v226, v226, v224
    v_and_b32 v227, 127, v0
    v_lshlrev_b32 v227, 2, v227
    v_lshrrev_b32 v228, 7, v0
    v_mfma_f32_32x32x16_bf16 v[64:79], v[168:171], v[176:179], v[64:79]
    v_lshl_add_u32 v227, v228, 12, v227
    v_add_u32 v227, 98304, v227
    v_mul_f32 v80, v80, v226
    v_mul_f32 v82, v82, v226
    v_mul_f32 v84, v84, v226
    v_mul_f32 v86, v86, v226
    s_waitcnt lgkmcnt(6)
    v_mfma_f32_32x32x16_bf16 v[48:63], v[180:183], v[184:187], v[48:63]
    ds_read_b128 v[168:171], v18 offset:0
    ds_read_b128 v[172:175], v34 offset:0
    ds_read_b128 v[176:179], v34 offset:4096
    v_mul_f32 v88, v88, v226
    v_mul_f32 v90, v90, v226
    v_mul_f32 v92, v92, v226
    v_mul_f32 v94, v94, v226
    ds_write_b32 v227, v80 offset:0
    ds_write_b32 v227, v82 offset:512
    v_mfma_f32_32x32x16_bf16 v[64:79], v[180:183], v[188:191], v[64:79]
    ds_write_b32 v227, v84 offset:1024
    ds_write_b32 v227, v86 offset:1536
    ds_write_b32 v227, v88 offset:2048
    ds_write_b32 v227, v90 offset:2560
    ds_write_b32 v227, v92 offset:3072
    ds_write_b32 v227, v94 offset:3584
    s_waitcnt lgkmcnt(0)
    v_mfma_f32_32x32x16_bf16 v[48:63], v[144:147], v[148:151], v[48:63]
    ds_read_b128 v[180:183], v19 offset:0
    ds_read_b128 v[184:187], v35 offset:0
    ds_read_b128 v[188:191], v35 offset:4096
    v_mfma_f32_32x32x16_bf16 v[64:79], v[144:147], v[152:155], v[64:79]
    s_waitcnt lgkmcnt(0)
    v_mfma_f32_32x32x16_bf16 v[48:63], v[156:159], v[160:163], v[48:63]
    s_barrier
    ds_read_b128 v[144:147], v20 offset:0
    ds_read_b128 v[148:151], v36 offset:0
    ds_read_b128 v[152:155], v36 offset:4096
    v_mfma_f32_32x32x16_bf16 v[64:79], v[156:159], v[164:167], v[64:79]
    s_waitcnt lgkmcnt(0)
    v_mfma_f32_32x32x16_bf16 v[48:63], v[168:171], v[172:175], v[48:63]
    ds_read_b128 v[156:159], v21 offset:0
    ds_read_b128 v[160:163], v37 offset:0
    ds_read_b128 v[164:167], v37 offset:4096
    v_mfma_f32_32x32x16_bf16 v[64:79], v[168:171], v[176:179], v[64:79]
    s_waitcnt lgkmcnt(6)
    v_mfma_f32_32x32x16_bf16 v[48:63], v[180:183], v[184:187], v[48:63]
    ds_read_b128 v[168:171], v22 offset:0
    ds_read_b128 v[172:175], v38 offset:0
    ds_read_b128 v[176:179], v38 offset:4096
    v_mfma_f32_32x32x16_bf16 v[64:79], v[180:183], v[188:191], v[64:79]
    s_waitcnt lgkmcnt(6)
    v_mfma_f32_32x32x16_bf16 v[80:95], v[144:147], v[148:151], 0
    ds_read_b128 v[180:183], v23 offset:0
    ds_read_b128 v[184:187], v39 offset:0
    ds_read_b128 v[188:191], v39 offset:4096
    ds_read_b32 v192, v208 offset:0
    ds_read_b32 v193, v208 offset:128
    ds_read_b32 v194, v208 offset:512
    ds_read_b32 v195, v208 offset:640
    ds_read_b32 v196, v208 offset:1024
    ds_read_b32 v197, v208 offset:1152
    ds_read_b32 v198, v208 offset:1536
    ds_read_b32 v199, v208 offset:1664
    v_mfma_f32_32x32x16_bf16 v[96:111], v[144:147], v[152:155], 0
    ds_read_b32 v200, v208 offset:2048
    ds_read_b32 v201, v208 offset:2176
    ds_read_b32 v202, v208 offset:2560
    ds_read_b32 v203, v208 offset:2688
    ds_read_b32 v204, v208 offset:3072
    ds_read_b32 v205, v208 offset:3200
    ds_read_b32 v206, v208 offset:3584
    ds_read_b32 v207, v208 offset:3712
    s_waitcnt lgkmcnt(0)
    v_mfma_f32_32x32x16_bf16 v[80:95], v[156:159], v[160:163], v[80:95]
    s_barrier
    ds_read_b128 v[144:147], v24 offset:0
    ds_read_b128 v[148:151], v40 offset:0
    ds_read_b128 v[152:155], v40 offset:4096
    v_mul_f32 v112, v48, v192
    v_mul_f32 v113, v49, v192
    v_mul_f32 v114, v50, v192
    v_mfma_f32_32x32x16_bf16 v[96:111], v[156:159], v[164:167], v[96:111]
    v_mul_f32 v115, v51, v192
    v_mul_f32 v116, v52, v192
    v_mul_f32 v117, v53, v192
    s_waitcnt lgkmcnt(0)
    v_mfma_f32_32x32x16_bf16 v[80:95], v[168:171], v[172:175], v[80:95]
    ds_read_b128 v[156:159], v25 offset:0
    ds_read_b128 v[160:163], v41 offset:0
    ds_read_b128 v[164:167], v41 offset:4096
    v_mul_f32 v118, v54, v192
    v_mul_f32 v119, v55, v192
    v_mul_f32 v120, v56, v192
    v_mfma_f32_32x32x16_bf16 v[96:111], v[168:171], v[176:179], v[96:111]
    v_mul_f32 v121, v57, v192
    v_mul_f32 v122, v58, v192
    v_mul_f32 v123, v59, v192
    s_waitcnt lgkmcnt(0)
    v_mfma_f32_32x32x16_bf16 v[80:95], v[180:183], v[184:187], v[80:95]
    ds_read_b128 v[168:171], v26 offset:0
    ds_read_b128 v[172:175], v42 offset:0
    ds_read_b128 v[176:179], v42 offset:4096
    v_mul_f32 v124, v60, v192
    v_mul_f32 v125, v61, v192
    v_mul_f32 v126, v62, v192
    v_mfma_f32_32x32x16_bf16 v[96:111], v[180:183], v[188:191], v[96:111]
    v_mul_f32 v127, v63, v192
    v_mul_f32 v128, v64, v193
    s_waitcnt lgkmcnt(6)
    v_mfma_f32_32x32x16_bf16 v[80:95], v[144:147], v[148:151], v[80:95]
    ds_read_b128 v[180:183], v27 offset:0
    ds_read_b128 v[184:187], v43 offset:0
    ds_read_b128 v[188:191], v43 offset:4096
    v_mov_b32 v212, 0
    v_mov_b32 v213, 0
    v_mov_b32 v214, 0
    v_mul_f32 v129, v65, v193
    v_mfma_f32_32x32x16_bf16 v[96:111], v[144:147], v[152:155], v[96:111]
    v_mul_f32 v130, v66, v193
    v_mul_f32 v131, v67, v193
    v_mul_f32 v132, v68, v193
    v_mul_f32 v133, v69, v193
    s_waitcnt lgkmcnt(6)
    v_mfma_f32_32x32x16_bf16 v[80:95], v[156:159], v[160:163], v[80:95]
    s_barrier
    ds_read_b128 v[144:147], v12 offset:0
    ds_read_b128 v[148:151], v28 offset:0
    ds_read_b128 v[152:155], v28 offset:4096
    v_mov_b32 v215, 0
    v_lshlrev_b32 v225, 4, v0
    v_add_u32 v225, 106496, v225
    v_mul_f32 v134, v70, v193
    v_mfma_f32_32x32x16_bf16 v[96:111], v[156:159], v[164:167], v[96:111]
    v_mul_f32 v135, v71, v193
    v_mul_f32 v136, v72, v193
    v_mul_f32 v137, v73, v193
    v_mul_f32 v138, v74, v193
    s_waitcnt lgkmcnt(6)
    v_mfma_f32_32x32x16_bf16 v[80:95], v[168:171], v[172:175], v[80:95]
    ds_read_b128 v[156:159], v13 offset:0
    ds_read_b128 v[160:163], v29 offset:0
    ds_read_b128 v[164:167], v29 offset:4096
    ds_write_b128 v225, v[212:215] offset:0
    ds_write_b128 v225, v[212:215] offset:4096
    v_mul_f32 v139, v75, v193
    v_mul_f32 v140, v76, v193
    v_mfma_f32_32x32x16_bf16 v[96:111], v[168:171], v[176:179], v[96:111]
    v_mul_f32 v141, v77, v193
    v_mul_f32 v142, v78, v193
    v_mul_f32 v143, v79, v193
    s_waitcnt lgkmcnt(0)
    v_mfma_f32_32x32x16_bf16 v[80:95], v[180:183], v[184:187], v[80:95]
    ds_read_b128 v[168:171], v14 offset:0
    ds_read_b128 v[172:175], v30 offset:0
    ds_read_b128 v[176:179], v30 offset:4096
    ds_write_b128 v225, v[212:215] offset:8192
    v_mfma_f32_32x32x16_bf16 v[96:111], v[180:183], v[188:191], v[96:111]
    ds_write_b128 v225, v[212:215] offset:12288
    s_waitcnt lgkmcnt(0)
    v_mfma_f32_32x32x16_bf16 v[48:63], v[144:147], v[148:151], 0
    ds_read_b128 v[180:183], v15 offset:0
    ds_read_b128 v[184:187], v31 offset:0
    ds_read_b128 v[188:191], v31 offset:4096
    ds_write_b128 v225, v[212:215] offset:16384
    v_mfma_f32_32x32x16_bf16 v[64:79], v[144:147], v[152:155], 0
    ds_write_b128 v225, v[212:215] offset:20480
    s_waitcnt lgkmcnt(0)
    v_mfma_f32_32x32x16_bf16 v[48:63], v[156:159], v[160:163], v[48:63]
    s_barrier
    ds_read_b128 v[144:147], v16 offset:0
    ds_read_b128 v[148:151], v32 offset:0
    ds_read_b128 v[152:155], v32 offset:4096
    ds_write_b128 v225, v[212:215] offset:24576
    ds_write_b128 v225, v[212:215] offset:28672
    v_fmac_f32 v112, v80, v194
    v_fmac_f32 v113, v81, v194
    v_mfma_f32_32x32x16_bf16 v[64:79], v[156:159], v[164:167], v[64:79]
    v_fmac_f32 v114, v82, v194
    v_fmac_f32 v115, v83, v194
    v_fmac_f32 v116, v84, v194
    v_fmac_f32 v117, v85, v194
    s_waitcnt lgkmcnt(0)
    v_mfma_f32_32x32x16_bf16 v[48:63], v[168:171], v[172:175], v[48:63]
    ds_read_b128 v[156:159], v17 offset:0
    ds_read_b128 v[160:163], v33 offset:0
    ds_read_b128 v[164:167], v33 offset:4096
    ds_write_b128 v225, v[212:215] offset:32768
    ds_write_b128 v225, v[212:215] offset:36864
    v_fmac_f32 v118, v86, v194
    v_fmac_f32 v119, v87, v194
    v_mfma_f32_32x32x16_bf16 v[64:79], v[168:171], v[176:179], v[64:79]
    v_fmac_f32 v120, v88, v194
    v_fmac_f32 v121, v89, v194
    v_fmac_f32 v122, v90, v194
    v_fmac_f32 v123, v91, v194
    s_waitcnt lgkmcnt(0)
    v_mfma_f32_32x32x16_bf16 v[48:63], v[180:183], v[184:187], v[48:63]
    ds_read_b128 v[168:171], v18 offset:0
    ds_read_b128 v[172:175], v34 offset:0
    ds_read_b128 v[176:179], v34 offset:4096
    ds_write_b128 v225, v[212:215] offset:40960
    v_cmp_gt_u32 vcc, 144, v0
    s_and_saveexec_b64 s[96:97], vcc
    ds_write_b128 v225, v[212:215] offset:45056
    s_mov_b64 exec, s[96:97]
    v_fmac_f32 v124, v92, v194
    v_fmac_f32 v125, v93, v194
    v_mfma_f32_32x32x16_bf16 v[64:79], v[180:183], v[188:191], v[64:79]
    v_fmac_f32 v126, v94, v194
    v_fmac_f32 v127, v95, v194
    v_fmac_f32 v128, v96, v195
    s_waitcnt lgkmcnt(0)
    v_mfma_f32_32x32x16_bf16 v[48:63], v[144:147], v[148:151], v[48:63]
    ds_read_b128 v[180:183], v19 offset:0
    ds_read_b128 v[184:187], v35 offset:0
    ds_read_b128 v[188:191], v35 offset:4096
    v_fmac_f32 v129, v97, v195
    v_fmac_f32 v130, v98, v195
    v_fmac_f32 v131, v99, v195
    v_mfma_f32_32x32x16_bf16 v[64:79], v[144:147], v[152:155], v[64:79]
    v_fmac_f32 v132, v100, v195
    v_fmac_f32 v133, v101, v195
    s_waitcnt lgkmcnt(0)
    v_mfma_f32_32x32x16_bf16 v[48:63], v[156:159], v[160:163], v[48:63]
    s_barrier
    ds_read_b128 v[144:147], v20 offset:0
    ds_read_b128 v[148:151], v36 offset:0
    ds_read_b128 v[152:155], v36 offset:4096
    v_fmac_f32 v134, v102, v195
    v_fmac_f32 v135, v103, v195
    v_fmac_f32 v136, v104, v195
    v_mfma_f32_32x32x16_bf16 v[64:79], v[156:159], v[164:167], v[64:79]
    v_fmac_f32 v137, v105, v195
    v_fmac_f32 v138, v106, v195
    s_waitcnt lgkmcnt(0)
    v_mfma_f32_32x32x16_bf16 v[48:63], v[168:171], v[172:175], v[48:63]
    ds_read_b128 v[156:159], v21 offset:0
    ds_read_b128 v[160:163], v37 offset:0
    ds_read_b128 v[164:167], v37 offset:4096
    v_fmac_f32 v139, v107, v195
    v_fmac_f32 v140, v108, v195
    v_fmac_f32 v141, v109, v195
    v_mfma_f32_32x32x16_bf16 v[64:79], v[168:171], v[176:179], v[64:79]
    v_fmac_f32 v142, v110, v195
    v_fmac_f32 v143, v111, v195
    s_waitcnt lgkmcnt(6)
    v_mfma_f32_32x32x16_bf16 v[48:63], v[180:183], v[184:187], v[48:63]
    ds_read_b128 v[168:171], v22 offset:0
    ds_read_b128 v[172:175], v38 offset:0
    ds_read_b128 v[176:179], v38 offset:4096
    v_mfma_f32_32x32x16_bf16 v[64:79], v[180:183], v[188:191], v[64:79]
    s_waitcnt lgkmcnt(6)
    v_mfma_f32_32x32x16_bf16 v[80:95], v[144:147], v[148:151], 0
    ds_read_b128 v[180:183], v23 offset:0
    ds_read_b128 v[184:187], v39 offset:0
    ds_read_b128 v[188:191], v39 offset:4096
    s_waitcnt vmcnt(0)
    v_and_b32 v225, 63, v0
    v_mfma_f32_32x32x16_bf16 v[96:111], v[144:147], v[152:155], 0
    v_lshrrev_b32 v226, 6, v0
    s_waitcnt lgkmcnt(6)
    v_mfma_f32_32x32x16_bf16 v[80:95], v[156:159], v[160:163], v[80:95]
    s_barrier
    ds_read_b128 v[144:147], v24 offset:0
    ds_read_b128 v[148:151], v40 offset:0
    ds_read_b128 v[152:155], v40 offset:4096
    v_mul_u32_u24 v225, 356, v225
    v_lshl_add_u32 v225, v226, 1, v225
    v_add_u32 v225, 106496, v225
    v_fmac_f32 v112, v48, v196
    v_fmac_f32 v113, v49, v196
    v_mfma_f32_32x32x16_bf16 v[96:111], v[156:159], v[164:167], v[96:111]
    v_fmac_f32 v114, v50, v196
    v_fmac_f32 v115, v51, v196
    v_fmac_f32 v116, v52, v196
    v_fmac_f32 v117, v53, v196
    s_waitcnt lgkmcnt(6)
    v_mfma_f32_32x32x16_bf16 v[80:95], v[168:171], v[172:175], v[80:95]
    ds_read_b128 v[156:159], v25 offset:0
    ds_read_b128 v[160:163], v41 offset:0
    ds_read_b128 v[164:167], v41 offset:4096
    ds_write_b16 v225, v216 offset:32
    ds_write_b16 v225, v216 offset:206
    ds_write_b16 v225, v217 offset:40
    v_fmac_f32 v118, v54, v196
    v_fmac_f32 v119, v55, v196
    v_mfma_f32_32x32x16_bf16 v[96:111], v[168:171], v[176:179], v[96:111]
    v_fmac_f32 v120, v56, v196
    v_fmac_f32 v121, v57, v196
    v_fmac_f32 v122, v58, v196
    v_fmac_f32 v123, v59, v196
    s_waitcnt lgkmcnt(0)
    v_mfma_f32_32x32x16_bf16 v[80:95], v[180:183], v[184:187], v[80:95]
    ds_read_b128 v[168:171], v26 offset:0
    ds_read_b128 v[172:175], v42 offset:0
    ds_read_b128 v[176:179], v42 offset:4096
    ds_write_b16 v225, v217 offset:214
    ds_write_b16 v225, v218 offset:48
    ds_write_b16 v225, v218 offset:222
    v_fmac_f32 v124, v60, v196
    v_mfma_f32_32x32x16_bf16 v[96:111], v[180:183], v[188:191], v[96:111]
    v_fmac_f32 v125, v61, v196
    v_fmac_f32 v126, v62, v196
    v_fmac_f32 v127, v63, v196
    v_fmac_f32 v128, v64, v197
    s_waitcnt lgkmcnt(0)
    v_mfma_f32_32x32x16_bf16 v[80:95], v[144:147], v[148:151], v[80:95]
    ds_read_b128 v[180:183], v27 offset:0
    ds_read_b128 v[184:187], v43 offset:0
    ds_read_b128 v[188:191], v43 offset:4096
    ds_write_b16 v225, v219 offset:56
    ds_write_b16 v225, v219 offset:230
    ds_write_b16 v225, v220 offset:64
    v_fmac_f32 v129, v65, v197
    v_mfma_f32_32x32x16_bf16 v[96:111], v[144:147], v[152:155], v[96:111]
    v_fmac_f32 v130, v66, v197
    v_fmac_f32 v131, v67, v197
    v_fmac_f32 v132, v68, v197
    v_fmac_f32 v133, v69, v197
    s_waitcnt lgkmcnt(0)
    v_mfma_f32_32x32x16_bf16 v[80:95], v[156:159], v[160:163], v[80:95]
    s_barrier
    ds_read_b128 v[144:147], v12 offset:0
    ds_read_b128 v[148:151], v28 offset:0
    ds_read_b128 v[152:155], v28 offset:4096
    ds_write_b16 v225, v220 offset:238
    ds_write_b16 v225, v221 offset:72
    v_fmac_f32 v134, v70, v197
    v_fmac_f32 v135, v71, v197
    v_mfma_f32_32x32x16_bf16 v[96:111], v[156:159], v[164:167], v[96:111]
    v_fmac_f32 v136, v72, v197
    v_fmac_f32 v137, v73, v197
    v_fmac_f32 v138, v74, v197
    s_waitcnt lgkmcnt(0)
    v_mfma_f32_32x32x16_bf16 v[80:95], v[168:171], v[172:175], v[80:95]
    ds_read_b128 v[156:159], v13 offset:0
    ds_read_b128 v[160:163], v29 offset:0
    ds_read_b128 v[164:167], v29 offset:4096
    ds_write_b16 v225, v221 offset:246
    ds_write_b16 v225, v222 offset:80
    v_fmac_f32 v139, v75, v197
    v_fmac_f32 v140, v76, v197
    v_mfma_f32_32x32x16_bf16 v[96:111], v[168:171], v[176:179], v[96:111]
    v_fmac_f32 v141, v77, v197
    v_fmac_f32 v142, v78, v197
    v_fmac_f32 v143, v79, v197
    s_waitcnt lgkmcnt(0)
    v_mfma_f32_32x32x16_bf16 v[80:95], v[180:183], v[184:187], v[80:95]
    ds_read_b128 v[168:171], v14 offset:0
    ds_read_b128 v[172:175], v30 offset:0
    ds_read_b128 v[176:179], v30 offset:4096
    ds_write_b16 v225, v222 offset:254
    v_mfma_f32_32x32x16_bf16 v[96:111], v[180:183], v[188:191], v[96:111]
    v_cmp_gt_u32 vcc, 3, v226
    s_and_saveexec_b64 s[96:97], vcc
    ds_write_b16 v225, v223 offset:88
    ds_write_b16 v225, v223 offset:262
    s_mov_b64 exec, s[96:97]
    s_waitcnt lgkmcnt(0)
    v_mfma_f32_32x32x16_bf16 v[48:63], v[144:147], v[148:151], 0
    ds_read_b128 v[180:183], v15 offset:0
    ds_read_b128 v[184:187], v31 offset:0
    ds_read_b128 v[188:191], v31 offset:4096
    v_mfma_f32_32x32x16_bf16 v[64:79], v[144:147], v[152:155], 0
    s_waitcnt lgkmcnt(0)
    v_mfma_f32_32x32x16_bf16 v[48:63], v[156:159], v[160:163], v[48:63]
    s_barrier
    ds_read_b128 v[144:147], v16 offset:0
    ds_read_b128 v[148:151], v32 offset:0
    ds_read_b128 v[152:155], v32 offset:4096
    v_fmac_f32 v112, v80, v198
    v_fmac_f32 v113, v81, v198
    v_fmac_f32 v114, v82, v198
    v_mfma_f32_32x32x16_bf16 v[64:79], v[156:159], v[164:167], v[64:79]
    v_fmac_f32 v115, v83, v198
    v_fmac_f32 v116, v84, v198
    v_fmac_f32 v117, v85, v198
    s_waitcnt lgkmcnt(0)
    v_mfma_f32_32x32x16_bf16 v[48:63], v[168:171], v[172:175], v[48:63]
    ds_read_b128 v[156:159], v17 offset:0
    ds_read_b128 v[160:163], v33 offset:0
    ds_read_b128 v[164:167], v33 offset:4096
    v_fmac_f32 v118, v86, v198
    v_fmac_f32 v119, v87, v198
    v_fmac_f32 v120, v88, v198
    v_mfma_f32_32x32x16_bf16 v[64:79], v[168:171], v[176:179], v[64:79]
    v_fmac_f32 v121, v89, v198
    v_fmac_f32 v122, v90, v198
    v_fmac_f32 v123, v91, v198
    s_waitcnt lgkmcnt(6)
    v_mfma_f32_32x32x16_bf16 v[48:63], v[180:183], v[184:187], v[48:63]
    ds_read_b128 v[168:171], v18 offset:0
    ds_read_b128 v[172:175], v34 offset:0
    ds_read_b128 v[176:179], v34 offset:4096
    v_fmac_f32 v124, v92, v198
    v_fmac_f32 v125, v93, v198
    v_fmac_f32 v126, v94, v198
    v_mfma_f32_32x32x16_bf16 v[64:79], v[180:183], v[188:191], v[64:79]
    v_fmac_f32 v127, v95, v198
    v_fmac_f32 v128, v96, v199
    s_waitcnt lgkmcnt(6)
    v_mfma_f32_32x32x16_bf16 v[48:63], v[144:147], v[148:151], v[48:63]
    ds_read_b128 v[180:183], v19 offset:0
    ds_read_b128 v[184:187], v35 offset:0
    ds_read_b128 v[188:191], v35 offset:4096
    v_add_u32 v225, 0, v45
    v_lshrrev_b32 v226, 3, v225
    v_lshrrev_b32 v227, 5, v1
    v_lshlrev_b32 v228, 1, v227
    v_xor_b32 v226, v226, v228
    v_mfma_f32_32x32x16_bf16 v[64:79], v[144:147], v[152:155], v[64:79]
    v_fmac_f32 v129, v97, v199
    v_fmac_f32 v130, v98, v199
    v_fmac_f32 v131, v99, v199
    v_fmac_f32 v132, v100, v199
    v_fmac_f32 v133, v101, v199
    s_waitcnt lgkmcnt(6)
    v_mfma_f32_32x32x16_bf16 v[48:63], v[156:159], v[160:163], v[48:63]
    s_barrier
    ds_read_b128 v[144:147], v20 offset:0
    ds_read_b128 v[148:151], v36 offset:0
    ds_read_b128 v[152:155], v36 offset:4096
    v_and_b32 v225, 7, v225
    v_lshlrev_b32 v225, 1, v225
    v_mul_u32_u24 v227, 1536, v227
    v_add_u32 v225, v225, v227
    s_mul_i32 s99, s56, 12288
    s_add_u32 s99, s99, 129280
    v_add_u32 v225, s99, v225
    v_mfma_f32_32x32x16_bf16 v[64:79], v[156:159], v[164:167], v[64:79]
    v_fmac_f32 v134, v102, v199
    v_fmac_f32 v135, v103, v199
    v_fmac_f32 v136, v104, v199
    v_fmac_f32 v137, v105, v199
    v_fmac_f32 v138, v106, v199
    s_waitcnt lgkmcnt(6)
    v_mfma_f32_32x32x16_bf16 v[48:63], v[168:171], v[172:175], v[48:63]
    ds_read_b128 v[156:159], v21 offset:0
    ds_read_b128 v[160:163], v37 offset:0
    ds_read_b128 v[164:167], v37 offset:4096
    v_xor_b32 v227, 0, v226
    v_lshl_add_u32 v212, v227, 4, v225
    v_xor_b32 v227, 1, v226
    v_lshl_add_u32 v213, v227, 4, v225
    v_xor_b32 v227, 4, v226
    v_mfma_f32_32x32x16_bf16 v[64:79], v[168:171], v[176:179], v[64:79]
    v_fmac_f32 v139, v107, v199
    v_fmac_f32 v140, v108, v199
    v_fmac_f32 v141, v109, v199
    v_fmac_f32 v142, v110, v199
    v_fmac_f32 v143, v111, v199
    s_waitcnt lgkmcnt(6)
    v_mfma_f32_32x32x16_bf16 v[48:63], v[180:183], v[184:187], v[48:63]
    ds_read_b128 v[168:171], v22 offset:0
    ds_read_b128 v[172:175], v38 offset:0
    ds_read_b128 v[176:179], v38 offset:4096
    v_lshl_add_u32 v214, v227, 4, v225
    v_xor_b32 v227, 5, v226
    v_lshl_add_u32 v215, v227, 4, v225
    v_mfma_f32_32x32x16_bf16 v[64:79], v[180:183], v[188:191], v[64:79]
    v_add_u32 v225, 32, v45
    v_lshrrev_b32 v226, 3, v225
    s_waitcnt lgkmcnt(6)
    v_mfma_f32_32x32x16_bf16 v[80:95], v[144:147], v[148:151], 0
    ds_read_b128 v[180:183], v23 offset:0
    ds_read_b128 v[184:187], v39 offset:0
    ds_read_b128 v[188:191], v39 offset:4096
    v_lshrrev_b32 v227, 5, v1
    v_lshlrev_b32 v228, 1, v227
    v_xor_b32 v226, v226, v228
    v_mfma_f32_32x32x16_bf16 v[96:111], v[144:147], v[152:155], 0
    v_and_b32 v225, 7, v225
    v_lshlrev_b32 v225, 1, v225
    s_waitcnt lgkmcnt(6)
    v_mfma_f32_32x32x16_bf16 v[80:95], v[156:159], v[160:163], v[80:95]
    s_barrier
    ds_read_b128 v[144:147], v24 offset:0
    ds_read_b128 v[148:151], v40 offset:0
    ds_read_b128 v[152:155], v40 offset:4096
    v_mul_u32_u24 v227, 1536, v227
    v_add_u32 v225, v225, v227
    s_mul_i32 s99, s56, 12288
    s_add_u32 s99, s99, 129280
    v_add_u32 v225, s99, v225
    v_xor_b32 v227, 0, v226
    v_lshl_add_u32 v216, v227, 4, v225
    v_fmac_f32 v112, v48, v200
    v_mfma_f32_32x32x16_bf16 v[96:111], v[156:159], v[164:167], v[96:111]
    v_fmac_f32 v113, v49, v200
    v_fmac_f32 v114, v50, v200
    v_fmac_f32 v115, v51, v200
    v_fmac_f32 v116, v52, v200
    v_fmac_f32 v117, v53, v200
    s_waitcnt lgkmcnt(6)
    v_mfma_f32_32x32x16_bf16 v[80:95], v[168:171], v[172:175], v[80:95]
    ds_read_b128 v[156:159], v25 offset:0
    ds_read_b128 v[160:163], v41 offset:0
    ds_read_b128 v[164:167], v41 offset:4096
    v_xor_b32 v227, 1, v226
    v_lshl_add_u32 v217, v227, 4, v225
    v_xor_b32 v227, 4, v226
    v_lshl_add_u32 v218, v227, 4, v225
    v_xor_b32 v227, 5, v226
    v_fmac_f32 v118, v54, v200
    v_mfma_f32_32x32x16_bf16 v[96:111], v[168:171], v[176:179], v[96:111]
    v_fmac_f32 v119, v55, v200
    v_fmac_f32 v120, v56, v200
    v_fmac_f32 v121, v57, v200
    v_fmac_f32 v122, v58, v200
    v_fmac_f32 v123, v59, v200
    s_waitcnt lgkmcnt(6)
    v_mfma_f32_32x32x16_bf16 v[80:95], v[180:183], v[184:187], v[80:95]
    ds_read_b128 v[168:171], v26 offset:0
    ds_read_b128 v[172:175], v42 offset:0
    ds_read_b128 v[176:179], v42 offset:4096
    v_lshl_add_u32 v219, v227, 4, v225
    v_and_b32 v225, 15, v1
    v_lshrrev_b32 v226, 4, v1
    v_lshlrev_b32 v227, 3, v226
    v_sub_u32 v227, v227, v225
    v_mfma_f32_32x32x16_bf16 v[96:111], v[180:183], v[188:191], v[96:111]
    v_fmac_f32 v124, v60, v200
    v_fmac_f32 v125, v61, v200
    v_fmac_f32 v126, v62, v200
    v_fmac_f32 v127, v63, v200
    v_fmac_f32 v128, v64, v201
    s_waitcnt lgkmcnt(6)
    v_mfma_f32_32x32x16_bf16 v[80:95], v[144:147], v[148:151], v[80:95]
    ds_read_b128 v[180:183], v27 offset:0
    ds_read_b128 v[184:187], v43 offset:0
    ds_read_b128 v[188:191], v43 offset:4096
    v_add_u32 v227, 15, v227
    v_and_b32 v229, 1, v227
    v_mul_u32_u24 v229, 176, v229
    v_lshrrev_b32 v227, 1, v227
    v_lshl_add_u32 v229, v227, 2, v229
    v_mfma_f32_32x32x16_bf16 v[96:111], v[144:147], v[152:155], v[96:111]
    v_fmac_f32 v129, v65, v201
    v_fmac_f32 v130, v66, v201
    v_fmac_f32 v131, v67, v201
    v_fmac_f32 v132, v68, v201
    v_fmac_f32 v133, v69, v201
    s_waitcnt lgkmcnt(6)
    v_mfma_f32_32x32x16_bf16 v[80:95], v[156:159], v[160:163], v[80:95]
    s_barrier
    ds_read_b128 v[144:147], v12 offset:0
    ds_read_b128 v[148:151], v28 offset:0
    ds_read_b128 v[152:155], v28 offset:4096
    s_mul_i32 s99, s20, 2848
    s_add_u32 s99, s99, 106496
    v_add_u32 v229, s99, v229
    v_lshl_add_u32 v227, v225, 1, v226
    v_lshlrev_b32 v227, 4, v227
    s_mul_i32 s99, s20, 3072
    s_add_u32 s99, s99, 129280
    v_add_u32 v230, s99, v227
    v_add_u32 v231, 64, v230
    v_mfma_f32_32x32x16_bf16 v[96:111], v[156:159], v[164:167], v[96:111]
    v_fmac_f32 v134, v70, v201
    v_fmac_f32 v135, v71, v201
    v_fmac_f32 v136, v72, v201
    v_fmac_f32 v137, v73, v201
    v_fmac_f32 v138, v74, v201
    s_waitcnt lgkmcnt(6)
    v_mfma_f32_32x32x16_bf16 v[80:95], v[168:171], v[172:175], v[80:95]
    ds_read_b128 v[156:159], v13 offset:0
    ds_read_b128 v[160:163], v29 offset:0
    ds_read_b128 v[164:167], v29 offset:4096
    s_and_b32 s99, s20, 1
    s_lshl_b32 s99, s99, 6
    v_xor_b32 v230, s99, v230
    s_and_b32 s99, s20, 1
    s_lshl_b32 s99, s99, 6
    v_xor_b32 v231, s99, v231
    v_lshlrev_b32 v227, 2, v226
    v_lshl_add_u32 v227, v225, 4, v227
    v_fmac_f32 v139, v75, v201
    v_mfma_f32_32x32x16_bf16 v[96:111], v[168:171], v[176:179], v[96:111]
    v_fmac_f32 v140, v76, v201
    v_fmac_f32 v141, v77, v201
    v_fmac_f32 v142, v78, v201
    v_fmac_f32 v143, v79, v201
    s_waitcnt lgkmcnt(6)
    v_mfma_f32_32x32x16_bf16 v[80:95], v[180:183], v[184:187], v[80:95]
    ds_read_b128 v[168:171], v14 offset:0
    ds_read_b128 v[172:175], v30 offset:0
    ds_read_b128 v[176:179], v30 offset:4096
    v_lshlrev_b32 v227, 7, v227
    v_add_u32 v227, 0, v227
    v_mfma_f32_32x32x16_bf16 v[96:111], v[180:183], v[188:191], v[96:111]
    v_and_b32 v225, 7, v225
    s_mul_i32 s99, s20, 1
    s_add_u32 s99, s99, 0
    v_xor_b32 v226, s99, v225
    s_waitcnt lgkmcnt(6)
    v_mfma_f32_32x32x16_bf16 v[48:63], v[144:147], v[148:151], 0
    ds_read_b128 v[180:183], v15 offset:0
    ds_read_b128 v[184:187], v31 offset:0
    ds_read_b128 v[188:191], v31 offset:4096
    v_lshl_add_u32 v234, v226, 4, v227
    v_and_b32 v225, 15, v1
    v_mfma_f32_32x32x16_bf16 v[64:79], v[144:147], v[152:155], 0
    v_lshrrev_b32 v226, 4, v1
    v_lshlrev_b32 v226, 3, v226
    s_waitcnt lgkmcnt(6)
    v_mfma_f32_32x32x16_bf16 v[48:63], v[156:159], v[160:163], v[48:63]
    s_barrier
    ds_read_b128 v[144:147], v16 offset:0
    ds_read_b128 v[148:151], v32 offset:0
    ds_read_b128 v[152:155], v32 offset:4096
    v_sub_u32 v225, v225, v226
    v_add_u32 v225, 16, v225
    v_mov_b32 v240, 0
    v_mov_b32 v226, 0x3f80
    v_fmac_f32 v112, v80, v202
    v_mfma_f32_32x32x16_bf16 v[64:79], v[156:159], v[164:167], v[64:79]
    v_fmac_f32 v113, v81, v202
    v_fmac_f32 v114, v82, v202
    v_fmac_f32 v115, v83, v202
    v_fmac_f32 v116, v84, v202
    v_fmac_f32 v117, v85, v202
    s_waitcnt lgkmcnt(6)
    v_mfma_f32_32x32x16_bf16 v[48:63], v[168:171], v[172:175], v[48:63]
    ds_read_b128 v[156:159], v17 offset:0
    ds_read_b128 v[160:163], v33 offset:0
    ds_read_b128 v[164:167], v33 offset:4096
    v_mov_b32 v227, 0x3f800000
    v_cmp_eq_u32 vcc, 0, v225
    s_nop 1
    v_cndmask_b32 v240, v240, v226, vcc
    v_cmp_eq_u32 vcc, 1, v225
    s_nop 1
    v_cndmask_b32 v240, v240, v227, vcc
    v_mov_b32 v241, 0
    v_fmac_f32 v118, v86, v202
    v_mfma_f32_32x32x16_bf16 v[64:79], v[168:171], v[176:179], v[64:79]
    v_fmac_f32 v119, v87, v202
    v_fmac_f32 v120, v88, v202
    v_fmac_f32 v121, v89, v202
    v_fmac_f32 v122, v90, v202
    v_fmac_f32 v123, v91, v202
    s_waitcnt lgkmcnt(6)
    v_mfma_f32_32x32x16_bf16 v[48:63], v[180:183], v[184:187], v[48:63]
    ds_read_b128 v[168:171], v18 offset:0
    ds_read_b128 v[172:175], v34 offset:0
    ds_read_b128 v[176:179], v34 offset:4096
    v_mov_b32 v226, 0x3f80
    v_mov_b32 v227, 0x3f800000
    v_cmp_eq_u32 vcc, 2, v225
    s_nop 1
    v_cndmask_b32 v241, v241, v226, vcc
    v_cmp_eq_u32 vcc, 3, v225
    s_nop 1
    v_cndmask_b32 v241, v241, v227, vcc
    v_fmac_f32 v124, v92, v202
    v_mfma_f32_32x32x16_bf16 v[64:79], v[180:183], v[188:191], v[64:79]
    v_fmac_f32 v125, v93, v202
    v_fmac_f32 v126, v94, v202
    v_fmac_f32 v127, v95, v202
    v_fmac_f32 v128, v96, v203
    s_waitcnt lgkmcnt(6)
    v_mfma_f32_32x32x16_bf16 v[48:63], v[144:147], v[148:151], v[48:63]
    ds_read_b128 v[180:183], v19 offset:0
    ds_read_b128 v[184:187], v35 offset:0
    ds_read_b128 v[188:191], v35 offset:4096
    v_mov_b32 v242, 0
    v_mov_b32 v226, 0x3f80
    v_mov_b32 v227, 0x3f800000
    v_cmp_eq_u32 vcc, 4, v225
    s_nop 1
    v_cndmask_b32 v242, v242, v226, vcc
    v_fmac_f32 v129, v97, v203
    v_mfma_f32_32x32x16_bf16 v[64:79], v[144:147], v[152:155], v[64:79]
    v_fmac_f32 v130, v98, v203
    v_fmac_f32 v131, v99, v203
    v_fmac_f32 v132, v100, v203
    v_fmac_f32 v133, v101, v203
    s_waitcnt lgkmcnt(6)
    v_mfma_f32_32x32x16_bf16 v[48:63], v[156:159], v[160:163], v[48:63]
    s_barrier
    ds_read_b128 v[144:147], v20 offset:0
    ds_read_b128 v[148:151], v36 offset:0
    ds_read_b128 v[152:155], v36 offset:4096
    v_cmp_eq_u32 vcc, 5, v225
    s_nop 1
    v_cndmask_b32 v242, v242, v227, vcc
    v_mov_b32 v243, 0
    v_mov_b32 v226, 0x3f80
    v_mov_b32 v227, 0x3f800000
    v_fmac_f32 v134, v102, v203
    v_mfma_f32_32x32x16_bf16 v[64:79], v[156:159], v[164:167], v[64:79]
    v_fmac_f32 v135, v103, v203
    v_fmac_f32 v136, v104, v203
    v_fmac_f32 v137, v105, v203
    v_fmac_f32 v138, v106, v203
    s_waitcnt lgkmcnt(6)
    v_mfma_f32_32x32x16_bf16 v[48:63], v[168:171], v[172:175], v[48:63]
    ds_read_b128 v[156:159], v21 offset:0
    ds_read_b128 v[160:163], v37 offset:0
    ds_read_b128 v[164:167], v37 offset:4096
    v_cmp_eq_u32 vcc, 6, v225
    s_nop 1
    v_cndmask_b32 v243, v243, v226, vcc
    v_cmp_eq_u32 vcc, 7, v225
    s_nop 1
    v_cndmask_b32 v243, v243, v227, vcc
    v_lshrrev_b32 v225, 3, v0
    v_and_b32 v226, 7, v0
    v_fmac_f32 v139, v107, v203
    v_mfma_f32_32x32x16_bf16 v[64:79], v[168:171], v[176:179], v[64:79]
    v_fmac_f32 v140, v108, v203
    v_fmac_f32 v141, v109, v203
    v_fmac_f32 v142, v110, v203
    v_fmac_f32 v143, v111, v203
    s_waitcnt lgkmcnt(6)
    v_mfma_f32_32x32x16_bf16 v[48:63], v[180:183], v[184:187], v[48:63]
    ds_read_b128 v[168:171], v22 offset:0
    ds_read_b128 v[172:175], v38 offset:0
    ds_read_b128 v[176:179], v38 offset:4096
    v_lshrrev_b32 v227, 4, v225
    v_add_u32 v228, s26, v225
    v_mfma_f32_32x32x16_bf16 v[64:79], v[180:183], v[188:191], v[64:79]
    v_lshlrev_b32 v228, 11, v228
    v_lshl_add_u32 v228, v226, 4, v228
    s_waitcnt lgkmcnt(6)
    v_mfma_f32_32x32x16_bf16 v[80:95], v[144:147], v[148:151], 0
    ds_read_b128 v[180:183], v23 offset:0
    ds_read_b128 v[184:187], v39 offset:0
    ds_read_b128 v[188:191], v39 offset:4096
    v_add_u32 v222, s27, v228
    v_add_u32 v223, 131072, v222
    v_mfma_f32_32x32x16_bf16 v[96:111], v[144:147], v[152:155], 0
    v_mov_b32 v228, 0x80000000
    v_cmp_gt_u32 vcc, 32, v225
    s_nop 1
    v_cndmask_b32 v223, v228, v223, vcc
    s_waitcnt lgkmcnt(6)
    v_mfma_f32_32x32x16_bf16 v[80:95], v[156:159], v[160:163], v[80:95]
    s_barrier
    ds_read_b128 v[144:147], v24 offset:0
    ds_read_b128 v[148:151], v40 offset:0
    ds_read_b128 v[152:155], v40 offset:4096
    v_add_u32 v228, 0, v227
    v_and_b32 v228, 7, v228
    v_xor_b32 v228, v228, v226
    v_lshlrev_b32 v228, 4, v228
    v_fmac_f32 v112, v48, v204
    v_mfma_f32_32x32x16_bf16 v[96:111], v[156:159], v[164:167], v[96:111]
    v_fmac_f32 v113, v49, v204
    v_fmac_f32 v114, v50, v204
    v_fmac_f32 v115, v51, v204
    v_fmac_f32 v116, v52, v204
    v_fmac_f32 v117, v53, v204
    s_waitcnt lgkmcnt(6)
    v_mfma_f32_32x32x16_bf16 v[80:95], v[168:171], v[172:175], v[80:95]
    ds_read_b128 v[156:159], v25 offset:0
    ds_read_b128 v[160:163], v41 offset:0
    ds_read_b128 v[164:167], v41 offset:4096
    v_lshl_add_u32 v228, v225, 7, v228
    v_add_u32 v220, 0, v228
    v_add_u32 v228, 4, v227
    v_and_b32 v228, 7, v228
    v_fmac_f32 v118, v54, v204
    v_mfma_f32_32x32x16_bf16 v[96:111], v[168:171], v[176:179], v[96:111]
    v_fmac_f32 v119, v55, v204
    v_fmac_f32 v120, v56, v204
    v_fmac_f32 v121, v57, v204
    v_fmac_f32 v122, v58, v204
    v_fmac_f32 v123, v59, v204
    s_waitcnt lgkmcnt(6)
    v_mfma_f32_32x32x16_bf16 v[80:95], v[180:183], v[184:187], v[80:95]
    ds_read_b128 v[168:171], v26 offset:0
    ds_read_b128 v[172:175], v42 offset:0
    ds_read_b128 v[176:179], v42 offset:4096
    v_xor_b32 v228, v228, v226
    v_lshlrev_b32 v228, 4, v228
    v_lshl_add_u32 v228, v225, 7, v228
    v_add_u32 v221, 8192, v228
    v_fmac_f32 v124, v60, v204
    v_mfma_f32_32x32x16_bf16 v[96:111], v[180:183], v[188:191], v[96:111]
    v_fmac_f32 v125, v61, v204
    v_fmac_f32 v126, v62, v204
    v_fmac_f32 v127, v63, v204
    v_fmac_f32 v128, v64, v205
    s_waitcnt lgkmcnt(6)
    v_mfma_f32_32x32x16_bf16 v[80:95], v[144:147], v[148:151], v[80:95]
    ds_read_b128 v[180:183], v27 offset:0
    ds_read_b128 v[184:187], v43 offset:0
    ds_read_b128 v[188:191], v43 offset:4096
    v_fmac_f32 v129, v65, v205
    v_fmac_f32 v130, v66, v205
    v_fmac_f32 v131, v67, v205
    v_mfma_f32_32x32x16_bf16 v[96:111], v[144:147], v[152:155], v[96:111]
    v_fmac_f32 v132, v68, v205
    v_fmac_f32 v133, v69, v205
    s_waitcnt lgkmcnt(6)
    v_mfma_f32_32x32x16_bf16 v[80:95], v[156:159], v[160:163], v[80:95]
    v_fmac_f32 v134, v70, v205
    v_fmac_f32 v135, v71, v205
    v_fmac_f32 v136, v72, v205
    v_mfma_f32_32x32x16_bf16 v[96:111], v[156:159], v[164:167], v[96:111]
    v_fmac_f32 v137, v73, v205
    v_fmac_f32 v138, v74, v205
    s_waitcnt lgkmcnt(3)
    v_mfma_f32_32x32x16_bf16 v[80:95], v[168:171], v[172:175], v[80:95]
    v_fmac_f32 v139, v75, v205
    v_fmac_f32 v140, v76, v205
    v_fmac_f32 v141, v77, v205
    v_mfma_f32_32x32x16_bf16 v[96:111], v[168:171], v[176:179], v[96:111]
    v_fmac_f32 v142, v78, v205
    v_fmac_f32 v143, v79, v205
    s_waitcnt lgkmcnt(0)
    v_mfma_f32_32x32x16_bf16 v[80:95], v[180:183], v[184:187], v[80:95]
    v_mfma_f32_32x32x16_bf16 v[96:111], v[180:183], v[188:191], v[96:111]
    s_nop 7
    s_nop 7
    v_fmac_f32 v112, v80, v206
    v_fmac_f32 v113, v81, v206
    v_fmac_f32 v114, v82, v206
    v_fmac_f32 v115, v83, v206
    v_fmac_f32 v116, v84, v206
    v_fmac_f32 v117, v85, v206
    v_fmac_f32 v118, v86, v206
    v_fmac_f32 v119, v87, v206
    v_fmac_f32 v120, v88, v206
    v_fmac_f32 v121, v89, v206
    v_fmac_f32 v122, v90, v206
    v_fmac_f32 v123, v91, v206
    v_fmac_f32 v124, v92, v206
    v_fmac_f32 v125, v93, v206
    v_fmac_f32 v126, v94, v206
    v_fmac_f32 v127, v95, v206
    v_fmac_f32 v128, v96, v207
    v_fmac_f32 v129, v97, v207
    v_fmac_f32 v130, v98, v207
    v_fmac_f32 v131, v99, v207
    v_fmac_f32 v132, v100, v207
    v_fmac_f32 v133, v101, v207
    v_fmac_f32 v134, v102, v207
    v_fmac_f32 v135, v103, v207
    v_fmac_f32 v136, v104, v207
    v_fmac_f32 v137, v105, v207
    v_fmac_f32 v138, v106, v207
    v_fmac_f32 v139, v107, v207
    v_fmac_f32 v140, v108, v207
    v_fmac_f32 v141, v109, v207
    v_fmac_f32 v142, v110, v207
    v_fmac_f32 v143, v111, v207
    v_cvt_pk_bf16_f32 v144, v112, v113
    v_cvt_pk_bf16_f32 v145, v114, v115
    v_cvt_pk_bf16_f32 v146, v116, v117
    v_cvt_pk_bf16_f32 v147, v118, v119
    v_cvt_pk_bf16_f32 v148, v120, v121
    v_cvt_pk_bf16_f32 v149, v122, v123
    v_cvt_pk_bf16_f32 v150, v124, v125
    v_cvt_pk_bf16_f32 v151, v126, v127
    ds_write_b16 v212, v144 offset:0
    ds_write_b16_d16_hi v212, v144 offset:384
    ds_write_b16 v213, v145 offset:768
    ds_write_b16_d16_hi v213, v145 offset:1152
    ds_write_b16 v214, v146 offset:3072
    ds_write_b16_d16_hi v214, v146 offset:3456
    ds_write_b16 v215, v147 offset:3840
    ds_write_b16_d16_hi v215, v147 offset:4224
    ds_write_b16 v212, v148 offset:6144
    ds_write_b16_d16_hi v212, v148 offset:6528
    ds_write_b16 v213, v149 offset:6912
    ds_write_b16_d16_hi v213, v149 offset:7296
    ds_write_b16 v214, v150 offset:9216
    ds_write_b16_d16_hi v214, v150 offset:9600
    ds_write_b16 v215, v151 offset:9984
    ds_write_b16_d16_hi v215, v151 offset:10368
    v_cvt_pk_bf16_f32 v152, v128, v129
    v_cvt_pk_bf16_f32 v153, v130, v131
    v_cvt_pk_bf16_f32 v154, v132, v133
    v_cvt_pk_bf16_f32 v155, v134, v135
    v_cvt_pk_bf16_f32 v156, v136, v137
    v_cvt_pk_bf16_f32 v157, v138, v139
    v_cvt_pk_bf16_f32 v158, v140, v141
    v_cvt_pk_bf16_f32 v159, v142, v143
    ds_write_b16 v216, v152 offset:0
    ds_write_b16_d16_hi v216, v152 offset:384
    ds_write_b16 v217, v153 offset:768
    ds_write_b16_d16_hi v217, v153 offset:1152
    ds_write_b16 v218, v154 offset:3072
    ds_write_b16_d16_hi v218, v154 offset:3456
    ds_write_b16 v219, v155 offset:3840
    ds_write_b16_d16_hi v219, v155 offset:4224
    ds_write_b16 v216, v156 offset:6144
    ds_write_b16_d16_hi v216, v156 offset:6528
    ds_write_b16 v217, v157 offset:6912
    ds_write_b16_d16_hi v217, v157 offset:7296
    ds_write_b16 v218, v158 offset:9216
    ds_write_b16_d16_hi v218, v158 offset:9600
    ds_write_b16 v219, v159 offset:9984
    ds_write_b16_d16_hi v219, v159 offset:10368
    s_waitcnt lgkmcnt(0)
    s_barrier
    v_add_u32 v236, 0, v229
    ds_read2_b32 v[48:49], v236 offset0:0 offset1:1
    ds_read2_b32 v[50:51], v236 offset0:2 offset1:3
    ds_read2_b32 v[52:53], v236 offset0:16 offset1:17
    ds_read2_b32 v[54:55], v236 offset0:18 offset1:19
    v_xor_b32 v232, 0, v230
    v_xor_b32 v233, 0, v231
    ds_read_b128 v[80:83], v232 offset:0
    ds_read_b128 v[84:87], v233 offset:0
    v_add_u32 v236, 356, v229
    ds_read2_b32 v[56:57], v236 offset0:0 offset1:1
    ds_read2_b32 v[58:59], v236 offset0:2 offset1:3
    ds_read2_b32 v[60:61], v236 offset0:16 offset1:17
    ds_read2_b32 v[62:63], v236 offset0:18 offset1:19
    ds_read_b128 v[88:91], v232 offset:384
    ds_read_b128 v[92:95], v233 offset:384
    v_add_u32 v236, 712, v229
    ds_read2_b32 v[64:65], v236 offset0:0 offset1:1
    ds_read2_b32 v[66:67], v236 offset0:2 offset1:3
    ds_read2_b32 v[68:69], v236 offset0:16 offset1:17
    ds_read2_b32 v[70:71], v236 offset0:18 offset1:19
    v_xor_b32 v232, 16, v230
    v_xor_b32 v233, 16, v231
    ds_read_b128 v[96:99], v232 offset:768
    ds_read_b128 v[100:103], v233 offset:768
    v_add_u32 v236, 1068, v229
    ds_read2_b32 v[72:73], v236 offset0:0 offset1:1
    ds_read2_b32 v[74:75], v236 offset0:2 offset1:3
    ds_read2_b32 v[76:77], v236 offset0:16 offset1:17
    ds_read2_b32 v[78:79], v236 offset0:18 offset1:19
    ds_read_b128 v[104:107], v232 offset:1152
    ds_read_b128 v[108:111], v233 offset:1152
    s_waitcnt lgkmcnt(15)
    v_mfma_f32_16x16x32_bf16 v[112:115], v[48:51], v[80:83], 0
    v_mfma_f32_16x16x32_bf16 v[112:115], v[52:55], v[84:87], v[112:115]
    v_mfma_f32_16x16x32_bf16 v[112:115], v[240:243], v[80:83], v[112:115]
    v_add_u32 v236, 1424, v229
    ds_read2_b32 v[48:49], v236 offset0:0 offset1:1
    ds_read2_b32 v[50:51], v236 offset0:2 offset1:3
    ds_read2_b32 v[52:53], v236 offset0:16 offset1:17
    ds_read2_b32 v[54:55], v236 offset0:18 offset1:19
    v_xor_b32 v232, 32, v230
    v_xor_b32 v233, 32, v231
    ds_read_b128 v[80:83], v232 offset:1536
    ds_read_b128 v[84:87], v233 offset:1536
    s_waitcnt lgkmcnt(15)
    v_mfma_f32_16x16x32_bf16 v[116:119], v[56:59], v[88:91], 0
    v_mfma_f32_16x16x32_bf16 v[116:119], v[60:63], v[92:95], v[116:119]
    v_mfma_f32_16x16x32_bf16 v[116:119], v[240:243], v[88:91], v[116:119]
    v_add_u32 v236, 1780, v229
    ds_read2_b32 v[56:57], v236 offset0:0 offset1:1
    ds_read2_b32 v[58:59], v236 offset0:2 offset1:3
    ds_read2_b32 v[60:61], v236 offset0:16 offset1:17
    ds_read2_b32 v[62:63], v236 offset0:18 offset1:19
    ds_read_b128 v[88:91], v232 offset:1920
    ds_read_b128 v[92:95], v233 offset:1920
    s_waitcnt lgkmcnt(15)
    v_mfma_f32_16x16x32_bf16 v[120:123], v[64:67], v[96:99], 0
    v_mfma_f32_16x16x32_bf16 v[120:123], v[68:71], v[100:103], v[120:123]
    v_mfma_f32_16x16x32_bf16 v[120:123], v[240:243], v[96:99], v[120:123]
    v_add_u32 v236, 2136, v229
    ds_read2_b32 v[64:65], v236 offset0:0 offset1:1
    ds_read2_b32 v[66:67], v236 offset0:2 offset1:3
    ds_read2_b32 v[68:69], v236 offset0:16 offset1:17
    ds_read2_b32 v[70:71], v236 offset0:18 offset1:19
    v_xor_b32 v232, 48, v230
    v_xor_b32 v233, 48, v231
    ds_read_b128 v[96:99], v232 offset:2304
    ds_read_b128 v[100:103], v233 offset:2304
    s_waitcnt lgkmcnt(15)
    v_mfma_f32_16x16x32_bf16 v[124:127], v[72:75], v[104:107], 0
    v_mfma_f32_16x16x32_bf16 v[124:127], v[76:79], v[108:111], v[124:127]
    v_mfma_f32_16x16x32_bf16 v[124:127], v[240:243], v[104:107], v[124:127]
    v_add_u32 v236, 2492, v229
    ds_read2_b32 v[72:73], v236 offset0:0 offset1:1
    ds_read2_b32 v[74:75], v236 offset0:2 offset1:3
    ds_read2_b32 v[76:77], v236 offset0:16 offset1:17
    ds_read2_b32 v[78:79], v236 offset0:18 offset1:19
    ds_read_b128 v[104:107], v232 offset:2688
    ds_read_b128 v[108:111], v233 offset:2688
    s_waitcnt lgkmcnt(15)
    v_mfma_f32_16x16x32_bf16 v[128:131], v[48:51], v[80:83], 0
    v_mfma_f32_16x16x32_bf16 v[128:131], v[52:55], v[84:87], v[128:131]
    v_mfma_f32_16x16x32_bf16 v[128:131], v[240:243], v[80:83], v[128:131]
    s_waitcnt lgkmcnt(12)
    v_mfma_f32_16x16x32_bf16 v[132:135], v[56:59], v[88:91], 0
    v_mfma_f32_16x16x32_bf16 v[132:135], v[60:63], v[92:95], v[132:135]
    v_mfma_f32_16x16x32_bf16 v[132:135], v[240:243], v[88:91], v[132:135]
    v_cvt_pk_bf16_f32 v144, v112, v116
    v_cvt_pk_bf16_f32 v145, v120, v124
    v_cvt_pk_bf16_f32 v146, v113, v117
    v_cvt_pk_bf16_f32 v147, v121, v125
    v_cvt_pk_bf16_f32 v148, v114, v118
    v_cvt_pk_bf16_f32 v149, v122, v126
    v_cvt_pk_bf16_f32 v150, v115, v119
    v_cvt_pk_bf16_f32 v151, v123, v127
    s_mov_b32 exec_lo, 4128831
    s_mov_b32 exec_hi, 4128831
    ds_write_b64 v234, v[144:145] offset:0
    ds_write_b64 v234, v[146:147] offset:128
    ds_write_b64 v234, v[148:149] offset:256
    ds_write_b64 v234, v[150:151] offset:384
    s_mov_b64 exec, -1
    s_waitcnt lgkmcnt(6)
    v_mfma_f32_16x16x32_bf16 v[136:139], v[64:67], v[96:99], 0
    v_mfma_f32_16x16x32_bf16 v[136:139], v[68:71], v[100:103], v[136:139]
    v_mfma_f32_16x16x32_bf16 v[136:139], v[240:243], v[96:99], v[136:139]
    s_waitcnt lgkmcnt(0)
    v_mfma_f32_16x16x32_bf16 v[140:143], v[72:75], v[104:107], 0
    v_mfma_f32_16x16x32_bf16 v[140:143], v[76:79], v[108:111], v[140:143]
    v_mfma_f32_16x16x32_bf16 v[140:143], v[240:243], v[104:107], v[140:143]
    s_nop 7
    s_nop 1
    v_cvt_pk_bf16_f32 v144, v128, v132
    v_cvt_pk_bf16_f32 v145, v136, v140
    v_cvt_pk_bf16_f32 v146, v129, v133
    v_cvt_pk_bf16_f32 v147, v137, v141
    v_cvt_pk_bf16_f32 v148, v130, v134
    v_cvt_pk_bf16_f32 v149, v138, v142
    v_cvt_pk_bf16_f32 v150, v131, v135
    v_cvt_pk_bf16_f32 v151, v139, v143
    s_mov_b32 exec_lo, 4128831
    s_mov_b32 exec_hi, 4128831
    ds_write_b64 v234, v[144:145] offset:8
    ds_write_b64 v234, v[146:147] offset:136
    ds_write_b64 v234, v[148:149] offset:264
    ds_write_b64 v234, v[150:151] offset:392
    s_mov_b64 exec, -1
    s_waitcnt lgkmcnt(0)
    s_barrier
    ds_read_b128 v[48:51], v220
    ds_read_b128 v[52:55], v221
    s_waitcnt lgkmcnt(1)
    buffer_store_dwordx4 v[48:51], v222, s[48:51], 0 offen sc1
    s_waitcnt lgkmcnt(0)
    buffer_store_dwordx4 v[52:55], v223, s[48:51], 0 offen sc1
    s_endpgm
k3P_loader:
    v_and_b32 v1, 63, v0
    v_and_b32 v12, 255, v0
    s_sub_u32 s57, s26, 16
    s_mul_i32 s99, s25, 32
    s_mul_i32 s54, s25, 4096
    s_add_u32 s99, s99, s57
    v_lshrrev_b32 v4, 3, v1
    v_lshrrev_b32 v5, 4, v1
    v_and_b32 v6, 7, v1
    v_xor_b32 v5, v5, v6
    v_add_u32 v4, s99, v4
    v_lshlrev_b32 v4, 11, v4
    v_lshl_add_u32 v15, v5, 4, v4
    v_xor_b32 v5, 4, v5
    v_lshl_add_u32 v6, v5, 4, v4
    v_add_u32 v16, 15360, v6
    v_add_u32 v17, 30720, v15
    v_add_u32 v18, 46080, v6
    s_lshl_b32 s57, s23, 6
    s_lshl_b32 s98, s21, 9
    s_add_u32 s57, s57, s98
    s_mul_i32 s99, s25, 16
    s_mul_i32 s52, s25, 2048
    s_add_u32 s99, s99, s57
    v_lshrrev_b32 v4, 3, v1
    v_lshrrev_b32 v5, 4, v1
    v_and_b32 v6, 7, v1
    v_xor_b32 v5, v5, v6
    v_add_u32 v4, s99, v4
    v_lshlrev_b32 v4, 11, v4
    v_lshl_add_u32 v13, v5, 4, v4
    v_xor_b32 v5, 4, v5
    v_lshl_add_u32 v6, v5, 4, v4
    v_add_u32 v14, 15360, v6
    s_mov_b32 s56, 0
    s_lshl_b32 s53, s56, 7
    s_mov_b32 s55, s53
    s_waitcnt lgkmcnt(0)
    s_mul_i32 s38, s21, 2097152
    s_add_u32 s8, s30, s38
    s_addc_u32 s9, s31, 0
    s_add_u32 s8, s8, 11534336
    s_addc_u32 s9, s9, 0
    s_mov_b32 s10, 2048000
    s_mov_b32 s11, 0x20000
    s_add_u32 s12, s30, 16777216
    s_addc_u32 s13, s31, 0
    s_mov_b32 s14, 2097152
    s_mov_b32 s15, 0x20000
    s_add_u32 m0, s54, 8192
    s_nop 0
    buffer_load_dwordx4 v15, s[8:11], s55 offen offset:0  lds
    buffer_load_dwordx4 v16, s[8:11], s55 offen offset:1024  lds
    buffer_load_dwordx4 v17, s[8:11], s55 offen offset:2048  lds
    buffer_load_dwordx4 v18, s[8:11], s55 offen offset:3072  lds
    s_add_u32 m0, s52, 0
    s_nop 0
    buffer_load_dwordx4 v13, s[12:15], s53 offen offset:0  lds
    buffer_load_dwordx4 v14, s[12:15], s53 offen offset:1024  lds
    s_add_u32 s56, s56, 1
    s_and_b32 s56, s56, 15
    s_lshl_b32 s53, s56, 7
    s_mov_b32 s55, s53
    s_add_u32 m0, s54, 32768
    s_nop 0
    buffer_load_dwordx4 v15, s[8:11], s55 offen offset:0  lds
    buffer_load_dwordx4 v16, s[8:11], s55 offen offset:1024  lds
    buffer_load_dwordx4 v17, s[8:11], s55 offen offset:2048  lds
    buffer_load_dwordx4 v18, s[8:11], s55 offen offset:3072  lds
    s_add_u32 m0, s52, 24576
    s_nop 0
    buffer_load_dwordx4 v13, s[12:15], s53 offen offset:0  lds
    buffer_load_dwordx4 v14, s[12:15], s53 offen offset:1024  lds
    s_add_u32 s56, s56, 1
    s_and_b32 s56, s56, 15
    s_lshl_b32 s53, s56, 7
    s_mov_b32 s55, s53
    s_waitcnt vmcnt(6)
    s_barrier
    s_add_u32 m0, s54, 57344
    s_nop 0
    buffer_load_dwordx4 v15, s[8:11], s55 offen offset:0  lds
    buffer_load_dwordx4 v16, s[8:11], s55 offen offset:1024  lds
    buffer_load_dwordx4 v17, s[8:11], s55 offen offset:2048  lds
    buffer_load_dwordx4 v18, s[8:11], s55 offen offset:3072  lds
    s_add_u32 m0, s52, 49152
    s_nop 0
    buffer_load_dwordx4 v13, s[12:15], s53 offen offset:0  lds
    buffer_load_dwordx4 v14, s[12:15], s53 offen offset:1024  lds
    s_add_u32 s56, s56, 1
    s_and_b32 s56, s56, 15
    s_lshl_b32 s53, s56, 7
    s_mov_b32 s55, s53
    s_mul_i32 s38, s21, 2048000
    s_add_u32 s48, s30, s38
    s_addc_u32 s49, s31, 0
    s_add_u32 s48, s48, 22020096
    s_addc_u32 s49, s49, 0
    s_mov_b32 s50, 2048000
    s_mov_b32 s51, 0x20000
    s_lshl_b32 s58, s26, 11
    s_waitcnt vmcnt(6)
    s_barrier
    s_add_u32 m0, s54, 81920
    s_nop 0
    buffer_load_dwordx4 v15, s[8:11], s55 offen offset:0  lds
    buffer_load_dwordx4 v16, s[8:11], s55 offen offset:1024  lds
    buffer_load_dwordx4 v17, s[8:11], s55 offen offset:2048  lds
    buffer_load_dwordx4 v18, s[8:11], s55 offen offset:3072  lds
    s_add_u32 m0, s52, 73728
    s_nop 0
    buffer_load_dwordx4 v13, s[12:15], s53 offen offset:0  lds
    buffer_load_dwordx4 v14, s[12:15], s53 offen offset:1024  lds
    s_add_u32 s56, s56, 1
    s_and_b32 s56, s56, 15
    s_lshl_b32 s53, s56, 7
    s_mov_b32 s55, s53
    s_waitcnt vmcnt(6)
    s_barrier
    s_add_u32 m0, s54, 8192
    s_nop 0
    buffer_load_dwordx4 v15, s[8:11], s55 offen offset:0  lds
    buffer_load_dwordx4 v16, s[8:11], s55 offen offset:1024  lds
    buffer_load_dwordx4 v17, s[8:11], s55 offen offset:2048  lds
    buffer_load_dwordx4 v18, s[8:11], s55 offen offset:3072  lds
    s_add_u32 m0, s52, 0
    s_nop 0
    buffer_load_dwordx4 v13, s[12:15], s53 offen offset:0  lds
    buffer_load_dwordx4 v14, s[12:15], s53 offen offset:1024  lds
    s_add_u32 s56, s56, 1
    s_and_b32 s56, s56, 15
    s_lshl_b32 s53, s56, 7
    s_mov_b32 s55, s53
    s_waitcnt vmcnt(6)
    s_barrier
    s_add_u32 m0, s54, 32768
    s_nop 0
    buffer_load_dwordx4 v15, s[8:11], s55 offen offset:0  lds
    buffer_load_dwordx4 v16, s[8:11], s55 offen offset:1024  lds
    buffer_load_dwordx4 v17, s[8:11], s55 offen offset:2048  lds
    buffer_load_dwordx4 v18, s[8:11], s55 offen offset:3072  lds
    s_add_u32 m0, s52, 24576
    s_nop 0
    buffer_load_dwordx4 v13, s[12:15], s53 offen offset:0  lds
    buffer_load_dwordx4 v14, s[12:15], s53 offen offset:1024  lds
    s_add_u32 s56, s56, 1
    s_and_b32 s56, s56, 15
    s_lshl_b32 s53, s56, 7
    s_mov_b32 s55, s53
    s_waitcnt vmcnt(6)
    s_barrier
    s_add_u32 m0, s54, 57344
    s_nop 0
    buffer_load_dwordx4 v15, s[8:11], s55 offen offset:0  lds
    buffer_load_dwordx4 v16, s[8:11], s55 offen offset:1024  lds
    buffer_load_dwordx4 v17, s[8:11], s55 offen offset:2048  lds
    buffer_load_dwordx4 v18, s[8:11], s55 offen offset:3072  lds
    s_add_u32 m0, s52, 49152
    s_nop 0
    buffer_load_dwordx4 v13, s[12:15], s53 offen offset:0  lds
    buffer_load_dwordx4 v14, s[12:15], s53 offen offset:1024  lds
    s_add_u32 s56, s56, 1
    s_and_b32 s56, s56, 15
    s_lshl_b32 s53, s56, 7
    s_mov_b32 s55, s53
    s_waitcnt vmcnt(6)
    s_barrier
    s_add_u32 m0, s54, 81920
    s_nop 0
    buffer_load_dwordx4 v15, s[8:11], s55 offen offset:0  lds
    buffer_load_dwordx4 v16, s[8:11], s55 offen offset:1024  lds
    buffer_load_dwordx4 v17, s[8:11], s55 offen offset:2048  lds
    buffer_load_dwordx4 v18, s[8:11], s55 offen offset:3072  lds
    s_add_u32 m0, s52, 73728
    s_nop 0
    buffer_load_dwordx4 v13, s[12:15], s53 offen offset:0  lds
    buffer_load_dwordx4 v14, s[12:15], s53 offen offset:1024  lds
    s_add_u32 s56, s56, 1
    s_and_b32 s56, s56, 15
    s_lshl_b32 s53, s56, 7
    s_mov_b32 s55, s53
    s_cmp_lt_u32 s33, 16
    s_cbranch_scc0 .Lpf5_skip
    s_cmp_eq_u32 s25, 0
    s_cbranch_scc0 .Lpf5_skip
    s_getpc_b64 s[96:97]
.Lpf5_pc:
    s_add_u32 s96, s96, (k3_kernel - .Lpf5_pc) & 0xffffffff
    s_addc_u32 s97, s97, ((k3_kernel - .Lpf5_pc) >> 32) & 0xffffffff
    v_and_b32 v254, 63, v0
    s_lshl_b32 s98, s33, 6
    v_add_u32 v254, s98, v254
    v_lshlrev_b32 v254, 7, v254
    v_min_u32 v254, (k4_exit - k3_kernel - 4), v254
    global_load_dword v255, v254, s[96:97]
.Lpf5_skip:
    s_waitcnt vmcnt(6)
    s_barrier
    s_add_u32 m0, s54, 8192
    s_nop 0
    buffer_load_dwordx4 v15, s[8:11], s55 offen offset:0  lds
    buffer_load_dwordx4 v16, s[8:11], s55 offen offset:1024  lds
    buffer_load_dwordx4 v17, s[8:11], s55 offen offset:2048  lds
    buffer_load_dwordx4 v18, s[8:11], s55 offen offset:3072  lds
    s_add_u32 m0, s52, 0
    s_nop 0
    buffer_load_dwordx4 v13, s[12:15], s53 offen offset:0  lds
    buffer_load_dwordx4 v14, s[12:15], s53 offen offset:1024  lds
    s_add_u32 s56, s56, 1
    s_and_b32 s56, s56, 15
    s_lshl_b32 s53, s56, 7
    s_mov_b32 s55, s53
    s_waitcnt vmcnt(6)
    s_barrier
    s_add_u32 m0, s54, 32768
    s_nop 0
    buffer_load_dwordx4 v15, s[8:11], s55 offen offset:0  lds
    buffer_load_dwordx4 v16, s[8:11], s55 offen offset:1024  lds
    buffer_load_dwordx4 v17, s[8:11], s55 offen offset:2048  lds
    buffer_load_dwordx4 v18, s[8:11], s55 offen offset:3072  lds
    s_add_u32 m0, s52, 24576
    s_nop 0
    buffer_load_dwordx4 v13, s[12:15], s53 offen offset:0  lds
    buffer_load_dwordx4 v14, s[12:15], s53 offen offset:1024  lds
    s_add_u32 s56, s56, 1
    s_and_b32 s56, s56, 15
    s_lshl_b32 s53, s56, 7
    s_mov_b32 s55, s53
    s_waitcnt vmcnt(6)
    s_barrier
    s_add_u32 m0, s54, 57344
    s_nop 0
    buffer_load_dwordx4 v15, s[8:11], s55 offen offset:0  lds
    buffer_load_dwordx4 v16, s[8:11], s55 offen offset:1024  lds
    buffer_load_dwordx4 v17, s[8:11], s55 offen offset:2048  lds
    buffer_load_dwordx4 v18, s[8:11], s55 offen offset:3072  lds
    s_add_u32 m0, s52, 49152
    s_nop 0
    buffer_load_dwordx4 v13, s[12:15], s53 offen offset:0  lds
    buffer_load_dwordx4 v14, s[12:15], s53 offen offset:1024  lds
    s_add_u32 s56, s56, 1
    s_and_b32 s56, s56, 15
    s_lshl_b32 s53, s56, 7
    s_mov_b32 s55, s53
    s_waitcnt vmcnt(6)
    s_barrier
    s_add_u32 m0, s54, 81920
    s_nop 0
    buffer_load_dwordx4 v15, s[8:11], s55 offen offset:0  lds
    buffer_load_dwordx4 v16, s[8:11], s55 offen offset:1024  lds
    buffer_load_dwordx4 v17, s[8:11], s55 offen offset:2048  lds
    buffer_load_dwordx4 v18, s[8:11], s55 offen offset:3072  lds
    s_add_u32 m0, s52, 73728
    s_nop 0
    buffer_load_dwordx4 v13, s[12:15], s53 offen offset:0  lds
    buffer_load_dwordx4 v14, s[12:15], s53 offen offset:1024  lds
    s_add_u32 s56, s56, 1
    s_and_b32 s56, s56, 15
    s_lshl_b32 s53, s56, 7
    s_mov_b32 s55, s53
    s_waitcnt vmcnt(6)
    s_barrier
    s_add_u32 m0, s54, 8192
    s_nop 0
    buffer_load_dwordx4 v15, s[8:11], s55 offen offset:0  lds
    buffer_load_dwordx4 v16, s[8:11], s55 offen offset:1024  lds
    buffer_load_dwordx4 v17, s[8:11], s55 offen offset:2048  lds
    buffer_load_dwordx4 v18, s[8:11], s55 offen offset:3072  lds
    s_add_u32 m0, s52, 0
    s_nop 0
    buffer_load_dwordx4 v13, s[12:15], s53 offen offset:0  lds
    buffer_load_dwordx4 v14, s[12:15], s53 offen offset:1024  lds
    s_add_u32 s56, s56, 1
    s_and_b32 s56, s56, 15
    s_lshl_b32 s53, s56, 7
    s_mov_b32 s55, s53
    s_waitcnt vmcnt(6)
    s_barrier
    s_add_u32 m0, s54, 32768
    s_nop 0
    buffer_load_dwordx4 v15, s[8:11], s55 offen offset:0  lds
    buffer_load_dwordx4 v16, s[8:11], s55 offen offset:1024  lds
    buffer_load_dwordx4 v17, s[8:11], s55 offen offset:2048  lds
    buffer_load_dwordx4 v18, s[8:11], s55 offen offset:3072  lds
    s_add_u32 m0, s52, 24576
    s_nop 0
    buffer_load_dwordx4 v13, s[12:15], s53 offen offset:0  lds
    buffer_load_dwordx4 v14, s[12:15], s53 offen offset:1024  lds
    s_add_u32 s56, s56, 1
    s_and_b32 s56, s56, 15
    s_lshl_b32 s53, s56, 7
    s_mov_b32 s55, s53
    s_waitcnt vmcnt(6)
    s_barrier
    s_add_u32 m0, s54, 57344
    s_nop 0
    buffer_load_dwordx4 v15, s[8:11], s55 offen offset:0  lds
    buffer_load_dwordx4 v16, s[8:11], s55 offen offset:1024  lds
    buffer_load_dwordx4 v17, s[8:11], s55 offen offset:2048  lds
    buffer_load_dwordx4 v18, s[8:11], s55 offen offset:3072  lds
    s_add_u32 m0, s52, 49152
    s_nop 0
    buffer_load_dwordx4 v13, s[12:15], s53 offen offset:0  lds
    buffer_load_dwordx4 v14, s[12:15], s53 offen offset:1024  lds
    s_add_u32 s56, s56, 1
    s_and_b32 s56, s56, 15
    s_lshl_b32 s53, s56, 7
    s_mov_b32 s55, s53
    s_waitcnt vmcnt(6)
    s_barrier
    s_add_u32 m0, s54, 81920
    s_nop 0
    buffer_load_dwordx4 v15, s[8:11], s55 offen offset:0  lds
    buffer_load_dwordx4 v16, s[8:11], s55 offen offset:1024  lds
    buffer_load_dwordx4 v17, s[8:11], s55 offen offset:2048  lds
    buffer_load_dwordx4 v18, s[8:11], s55 offen offset:3072  lds
    s_add_u32 m0, s52, 73728
    s_nop 0
    buffer_load_dwordx4 v13, s[12:15], s53 offen offset:0  lds
    buffer_load_dwordx4 v14, s[12:15], s53 offen offset:1024  lds
    s_add_u32 s56, s56, 1
    s_and_b32 s56, s56, 15
    s_lshl_b32 s53, s56, 7
    s_mov_b32 s55, s53
    s_waitcnt vmcnt(6)
    s_barrier
    v_and_b32 v4, 15, v1
    v_lshrrev_b32 v5, 4, v1
    v_lshlrev_b32 v6, 3, v5
    v_sub_u32 v6, v6, v4
    v_add_u32 v6, 15, v6
    v_and_b32 v124, 1, v6
    v_mul_u32_u24 v124, 176, v124
    v_lshrrev_b32 v6, 1, v6
    v_lshl_add_u32 v124, v6, 2, v124
    s_mul_i32 s99, s20, 2848
    s_add_u32 s99, s99, 106496
    v_add_u32 v124, s99, v124
    v_lshl_add_u32 v6, v4, 1, v5
    v_lshlrev_b32 v6, 4, v6
    s_mul_i32 s99, s20, 3072
    s_add_u32 s99, s99, 129280
    v_add_u32 v125, s99, v6
    v_add_u32 v126, 64, v125
    s_and_b32 s99, s20, 1
    s_lshl_b32 s99, s99, 6
    v_xor_b32 v125, s99, v125
    s_and_b32 s99, s20, 1
    s_lshl_b32 s99, s99, 6
    v_xor_b32 v126, s99, v126
    v_lshlrev_b32 v6, 2, v5
    v_lshl_add_u32 v6, v4, 4, v6
    v_lshlrev_b32 v6, 7, v6
    v_add_u32 v6, 0, v6
    v_and_b32 v4, 7, v4
    s_mul_i32 s99, s20, 1
    s_add_u32 s99, s99, 0
    v_xor_b32 v5, s99, v4
    v_lshl_add_u32 v129, v5, 4, v6
    v_and_b32 v4, 15, v1
    v_lshrrev_b32 v5, 4, v1
    v_lshlrev_b32 v5, 3, v5
    v_sub_u32 v4, v4, v5
    v_add_u32 v4, 16, v4
    v_mov_b32 v132, 0
    v_mov_b32 v5, 0x3f80
    v_mov_b32 v6, 0x3f800000
    v_cmp_eq_u32 vcc, 0, v4
    s_nop 1
    v_cndmask_b32 v132, v132, v5, vcc
    v_cmp_eq_u32 vcc, 1, v4
    s_nop 1
    v_cndmask_b32 v132, v132, v6, vcc
    v_mov_b32 v133, 0
    v_mov_b32 v5, 0x3f80
    v_mov_b32 v6, 0x3f800000
    v_cmp_eq_u32 vcc, 2, v4
    s_nop 1
    v_cndmask_b32 v133, v133, v5, vcc
    v_cmp_eq_u32 vcc, 3, v4
    s_nop 1
    v_cndmask_b32 v133, v133, v6, vcc
    v_mov_b32 v134, 0
    v_mov_b32 v5, 0x3f80
    v_mov_b32 v6, 0x3f800000
    v_cmp_eq_u32 vcc, 4, v4
    s_nop 1
    v_cndmask_b32 v134, v134, v5, vcc
    v_cmp_eq_u32 vcc, 5, v4
    s_nop 1
    v_cndmask_b32 v134, v134, v6, vcc
    v_mov_b32 v135, 0
    v_mov_b32 v5, 0x3f80
    v_mov_b32 v6, 0x3f800000
    v_cmp_eq_u32 vcc, 6, v4
    s_nop 1
    v_cndmask_b32 v135, v135, v5, vcc
    v_cmp_eq_u32 vcc, 7, v4
    s_nop 1
    v_cndmask_b32 v135, v135, v6, vcc
    v_lshrrev_b32 v4, 3, v0
    v_and_b32 v5, 7, v0
    v_lshrrev_b32 v6, 4, v4
    v_add_u32 v7, s26, v4
    v_lshlrev_b32 v7, 11, v7
    v_lshl_add_u32 v7, v5, 4, v7
    v_add_u32 v138, s27, v7
    v_add_u32 v139, 131072, v138
    v_mov_b32 v7, 0x80000000
    v_cmp_gt_u32 vcc, 32, v4
    s_nop 1
    v_cndmask_b32 v139, v7, v139, vcc
    v_add_u32 v7, 0, v6
    v_and_b32 v7, 7, v7
    v_xor_b32 v7, v7, v5
    v_lshlrev_b32 v7, 4, v7
    v_lshl_add_u32 v7, v4, 7, v7
    v_add_u32 v136, 0, v7
    v_add_u32 v7, 4, v6
    v_and_b32 v7, 7, v7
    v_xor_b32 v7, v7, v5
    v_lshlrev_b32 v7, 4, v7
    v_lshl_add_u32 v7, v4, 7, v7
    v_add_u32 v137, 8192, v7
    s_waitcnt vmcnt(0)
    s_barrier
    s_lshl_b32 s98, s33, 2
    s_add_u32 s98, s98, s25
    s_lshl_b32 s98, s98, 13
    v_and_b32 v4, 63, v0
    v_lshlrev_b32 v4, 7, v4
    v_add_u32 v4, s98, v4
    s_load_dwordx2 s[76:77], s[0:1], 56
    s_mov_b32 s78, 1048576
    s_mov_b32 s79, 0x20000
    s_waitcnt lgkmcnt(0)
    buffer_load_dword v252, v4, s[76:79], 0 offen
    s_barrier
    v_add_u32 v131, 0, v124
    ds_read2_b32 v[20:21], v131 offset0:0 offset1:1
    ds_read2_b32 v[22:23], v131 offset0:2 offset1:3
    ds_read2_b32 v[24:25], v131 offset0:16 offset1:17
    ds_read2_b32 v[26:27], v131 offset0:18 offset1:19
    v_xor_b32 v127, 0, v125
    v_xor_b32 v128, 0, v126
    ds_read_b128 v[52:55], v127 offset:0
    ds_read_b128 v[56:59], v128 offset:0
    v_add_u32 v131, 356, v124
    ds_read2_b32 v[28:29], v131 offset0:0 offset1:1
    ds_read2_b32 v[30:31], v131 offset0:2 offset1:3
    ds_read2_b32 v[32:33], v131 offset0:16 offset1:17
    ds_read2_b32 v[34:35], v131 offset0:18 offset1:19
    ds_read_b128 v[60:63], v127 offset:384
    ds_read_b128 v[64:67], v128 offset:384
    v_add_u32 v131, 712, v124
    ds_read2_b32 v[36:37], v131 offset0:0 offset1:1
    ds_read2_b32 v[38:39], v131 offset0:2 offset1:3
    ds_read2_b32 v[40:41], v131 offset0:16 offset1:17
    ds_read2_b32 v[42:43], v131 offset0:18 offset1:19
    v_xor_b32 v127, 16, v125
    v_xor_b32 v128, 16, v126
    ds_read_b128 v[68:71], v127 offset:768
    ds_read_b128 v[72:75], v128 offset:768
    v_add_u32 v131, 1068, v124
    ds_read2_b32 v[44:45], v131 offset0:0 offset1:1
    ds_read2_b32 v[46:47], v131 offset0:2 offset1:3
    ds_read2_b32 v[48:49], v131 offset0:16 offset1:17
    ds_read2_b32 v[50:51], v131 offset0:18 offset1:19
    ds_read_b128 v[76:79], v127 offset:1152
    ds_read_b128 v[80:83], v128 offset:1152
    s_waitcnt lgkmcnt(15)
    v_mfma_f32_16x16x32_bf16 v[84:87], v[20:23], v[52:55], 0
    v_mfma_f32_16x16x32_bf16 v[84:87], v[24:27], v[56:59], v[84:87]
    v_mfma_f32_16x16x32_bf16 v[84:87], v[132:135], v[52:55], v[84:87]
    v_add_u32 v131, 1424, v124
    ds_read2_b32 v[20:21], v131 offset0:0 offset1:1
    ds_read2_b32 v[22:23], v131 offset0:2 offset1:3
    ds_read2_b32 v[24:25], v131 offset0:16 offset1:17
    ds_read2_b32 v[26:27], v131 offset0:18 offset1:19
    v_xor_b32 v127, 32, v125
    v_xor_b32 v128, 32, v126
    ds_read_b128 v[52:55], v127 offset:1536
    ds_read_b128 v[56:59], v128 offset:1536
    s_waitcnt lgkmcnt(15)
    v_mfma_f32_16x16x32_bf16 v[88:91], v[28:31], v[60:63], 0
    v_mfma_f32_16x16x32_bf16 v[88:91], v[32:35], v[64:67], v[88:91]
    v_mfma_f32_16x16x32_bf16 v[88:91], v[132:135], v[60:63], v[88:91]
    v_add_u32 v131, 1780, v124
    ds_read2_b32 v[28:29], v131 offset0:0 offset1:1
    ds_read2_b32 v[30:31], v131 offset0:2 offset1:3
    ds_read2_b32 v[32:33], v131 offset0:16 offset1:17
    ds_read2_b32 v[34:35], v131 offset0:18 offset1:19
    ds_read_b128 v[60:63], v127 offset:1920
    ds_read_b128 v[64:67], v128 offset:1920
    s_waitcnt lgkmcnt(15)
    v_mfma_f32_16x16x32_bf16 v[92:95], v[36:39], v[68:71], 0
    v_mfma_f32_16x16x32_bf16 v[92:95], v[40:43], v[72:75], v[92:95]
    v_mfma_f32_16x16x32_bf16 v[92:95], v[132:135], v[68:71], v[92:95]
    v_add_u32 v131, 2136, v124
    ds_read2_b32 v[36:37], v131 offset0:0 offset1:1
    ds_read2_b32 v[38:39], v131 offset0:2 offset1:3
    ds_read2_b32 v[40:41], v131 offset0:16 offset1:17
    ds_read2_b32 v[42:43], v131 offset0:18 offset1:19
    v_xor_b32 v127, 48, v125
    v_xor_b32 v128, 48, v126
    ds_read_b128 v[68:71], v127 offset:2304
    ds_read_b128 v[72:75], v128 offset:2304
    s_waitcnt lgkmcnt(15)
    v_mfma_f32_16x16x32_bf16 v[96:99], v[44:47], v[76:79], 0
    v_mfma_f32_16x16x32_bf16 v[96:99], v[48:51], v[80:83], v[96:99]
    v_mfma_f32_16x16x32_bf16 v[96:99], v[132:135], v[76:79], v[96:99]
    v_add_u32 v131, 2492, v124
    ds_read2_b32 v[44:45], v131 offset0:0 offset1:1
    ds_read2_b32 v[46:47], v131 offset0:2 offset1:3
    ds_read2_b32 v[48:49], v131 offset0:16 offset1:17
    ds_read2_b32 v[50:51], v131 offset0:18 offset1:19
    ds_read_b128 v[76:79], v127 offset:2688
    ds_read_b128 v[80:83], v128 offset:2688
    s_waitcnt lgkmcnt(15)
    v_mfma_f32_16x16x32_bf16 v[100:103], v[20:23], v[52:55], 0
    v_mfma_f32_16x16x32_bf16 v[100:103], v[24:27], v[56:59], v[100:103]
    v_mfma_f32_16x16x32_bf16 v[100:103], v[132:135], v[52:55], v[100:103]
    s_waitcnt lgkmcnt(12)
    v_mfma_f32_16x16x32_bf16 v[104:107], v[28:31], v[60:63], 0
    v_mfma_f32_16x16x32_bf16 v[104:107], v[32:35], v[64:67], v[104:107]
    v_mfma_f32_16x16x32_bf16 v[104:107], v[132:135], v[60:63], v[104:107]
    v_cvt_pk_bf16_f32 v116, v84, v88
    v_cvt_pk_bf16_f32 v117, v92, v96
    v_cvt_pk_bf16_f32 v118, v85, v89
    v_cvt_pk_bf16_f32 v119, v93, v97
    v_cvt_pk_bf16_f32 v120, v86, v90
    v_cvt_pk_bf16_f32 v121, v94, v98
    v_cvt_pk_bf16_f32 v122, v87, v91
    v_cvt_pk_bf16_f32 v123, v95, v99
    s_mov_b32 exec_lo, 4128831
    s_mov_b32 exec_hi, 4128831
    ds_write_b64 v129, v[116:117] offset:0
    ds_write_b64 v129, v[118:119] offset:128
    ds_write_b64 v129, v[120:121] offset:256
    ds_write_b64 v129, v[122:123] offset:384
    s_mov_b64 exec, -1
    s_waitcnt lgkmcnt(6)
    v_mfma_f32_16x16x32_bf16 v[108:111], v[36:39], v[68:71], 0
    v_mfma_f32_16x16x32_bf16 v[108:111], v[40:43], v[72:75], v[108:111]
    v_mfma_f32_16x16x32_bf16 v[108:111], v[132:135], v[68:71], v[108:111]
    s_waitcnt lgkmcnt(0)
    v_mfma_f32_16x16x32_bf16 v[112:115], v[44:47], v[76:79], 0
    v_mfma_f32_16x16x32_bf16 v[112:115], v[48:51], v[80:83], v[112:115]
    v_mfma_f32_16x16x32_bf16 v[112:115], v[132:135], v[76:79], v[112:115]
    s_nop 7
    s_nop 1
    v_cvt_pk_bf16_f32 v116, v100, v104
    v_cvt_pk_bf16_f32 v117, v108, v112
    v_cvt_pk_bf16_f32 v118, v101, v105
    v_cvt_pk_bf16_f32 v119, v109, v113
    v_cvt_pk_bf16_f32 v120, v102, v106
    v_cvt_pk_bf16_f32 v121, v110, v114
    v_cvt_pk_bf16_f32 v122, v103, v107
    v_cvt_pk_bf16_f32 v123, v111, v115
    s_mov_b32 exec_lo, 4128831
    s_mov_b32 exec_hi, 4128831
    ds_write_b64 v129, v[116:117] offset:8
    ds_write_b64 v129, v[118:119] offset:136
    ds_write_b64 v129, v[120:121] offset:264
    ds_write_b64 v129, v[122:123] offset:392
    s_mov_b64 exec, -1
    s_waitcnt lgkmcnt(0)
    s_barrier
    ds_read_b128 v[140:143], v136
    ds_read_b128 v[144:147], v137
    s_waitcnt lgkmcnt(1)
    buffer_store_dwordx4 v[140:143], v138, s[48:51], 0 offen sc1
    s_waitcnt lgkmcnt(0)
    buffer_store_dwordx4 v[144:147], v139, s[48:51], 0 offen sc1
    s_endpgm
k3_typeL:
    s_mul_i32 s34, s32, 10
    s_add_u32 s34, s34, s33
    s_sub_u32 s34, s34, 22
    s_lshr_b32 s35, s34, 3
    s_and_b32 s23, s34, 7
    s_cmp_ge_u32 s35, 5
    s_cselect_b32 s21, 1, 0
    s_mul_i32 s36, s21, 5
    s_sub_u32 s22, s35, s36
    s_add_u32 s24, s23, s22
    s_and_b32 s24, s24, 7
    s_mul_i32 s26, s22, 224
    s_lshl_b32 s27, s23, 7
    s_add_u32 s28, s27, 1024
    s_and_b32 s25, s20, 3
    s_cmp_ge_u32 s20, 4
    s_cbranch_scc1 k3L_loader
    v_and_b32 v1, 63, v0
    v_and_b32 v4, 31, v1
    s_lshl_b32 s99, s20, 6
    v_add_u32 v128, s99, v4
    v_bfe_u32 v4, v128, 1, 3
    v_lshrrev_b32 v5, 5, v1
    v_xor_b32 v4, v4, v5
    v_lshlrev_b32 v4, 4, v4
    v_lshl_add_u32 v4, v128, 7, v4
    v_add_u32 v12, 0, v4
    v_add_u32 v16, 40960, v4
    v_add_u32 v20, 81920, v4
    v_xor_b32 v5, 32, v4
    v_add_u32 v13, 0, v5
    v_add_u32 v17, 40960, v5
    v_add_u32 v21, 81920, v5
    v_xor_b32 v5, 64, v4
    v_add_u32 v14, 0, v5
    v_add_u32 v18, 40960, v5
    v_add_u32 v22, 81920, v5
    v_xor_b32 v5, 96, v4
    v_add_u32 v15, 0, v5
    v_add_u32 v19, 40960, v5
    v_add_u32 v23, 81920, v5
    s_mov_b32 s56, 0
    v_bfe_u32 v4, v1, 2, 2
    v_lshrrev_b32 v5, 5, v1
    v_lshl_add_u32 v4, v5, 3, v4
    v_bfe_u32 v5, v4, 1, 1
    v_mul_u32_u24 v4, 128, v4
    v_bfe_u32 v6, v1, 4, 1
    v_lshl_add_u32 v4, v6, 5, v4
    v_and_b32 v6, 3, v1
    v_lshl_add_u32 v4, v6, 3, v4
    s_add_u32 s99, s56, 0
    v_xor_b32 v7, s99, v5
    v_lshl_add_u32 v7, v7, 6, v4
    v_add_u32 v24, 32768, v7
    v_add_u32 v26, 73728, v7
    v_add_u32 v28, 114688, v7
    s_add_u32 s99, s56, 1
    v_xor_b32 v7, s99, v5
    v_lshl_add_u32 v7, v7, 6, v4
    v_add_u32 v25, 32768, v7
    v_add_u32 v27, 73728, v7
    v_add_u32 v29, 114688, v7
    s_waitcnt lgkmcnt(0)
    s_mov_b32 s44, s6
    s_mov_b32 s45, s7
    s_mov_b32 s46, 63488
    s_mov_b32 s47, 0x20000
    v_and_b32 v4, 63, v0
    v_lshrrev_b32 v5, 6, v0
    v_mul_u32_u24 v5, 2048, v5
    v_lshl_add_u32 v4, v4, 1, v5
    v_add_u32 v4, s28, v4
    s_mov_b32 s99, 0
    buffer_load_ushort v144, v4, s[44:47], s99 offen
    s_mov_b32 s99, 8192
    buffer_load_ushort v145, v4, s[44:47], s99 offen
    s_mov_b32 s99, 16384
    buffer_load_ushort v146, v4, s[44:47], s99 offen
    s_mov_b32 s99, 24576
    buffer_load_ushort v147, v4, s[44:47], s99 offen
    s_mov_b32 s99, 32768
    buffer_load_ushort v148, v4, s[44:47], s99 offen
    s_mov_b32 s99, 40960
    buffer_load_ushort v149, v4, s[44:47], s99 offen
    s_mov_b32 s99, 49152
    buffer_load_ushort v150, v4, s[44:47], s99 offen
    s_mov_b32 s99, 57344
    buffer_load_ushort v151, v4, s[44:47], s99 offen
    s_mul_i32 s38, s21, 2048000
    s_add_u32 s48, s30, s38
    s_addc_u32 s49, s31, 0
    s_add_u32 s48, s48, 22020096
    s_addc_u32 s49, s49, 0
    s_mov_b32 s50, 2048000
    s_mov_b32 s51, 0x20000
    s_barrier
    ds_read_b128 v[96:99], v12 offset:0
    ds_read_b128 v[100:103], v12 offset:4096
    ds_read_b64_tr_b16 v[104:105], v24 offset:0
    ds_read_b64_tr_b16 v[106:107], v24 offset:512
    ds_read_b64_tr_b16 v[108:109], v25 offset:0
    ds_read_b64_tr_b16 v[110:111], v25 offset:512
    s_waitcnt lgkmcnt(0)
    v_mfma_f32_32x32x16_bf16 v[32:47], v[96:99], v[104:107], 0
    ds_read_b128 v[112:115], v13 offset:0
    ds_read_b128 v[116:119], v13 offset:4096
    ds_read_b64_tr_b16 v[120:121], v24 offset:2048
    v_mov_b32 v140, 0
    v_mfma_f32_32x32x16_bf16 v[48:63], v[96:99], v[108:111], 0
    ds_read_b64_tr_b16 v[122:123], v24 offset:2560
    ds_read_b64_tr_b16 v[124:125], v25 offset:2048
    ds_read_b64_tr_b16 v[126:127], v25 offset:2560
    v_mov_b32 v141, 0
    v_mfma_f32_32x32x16_bf16 v[64:79], v[100:103], v[104:107], 0
    v_mov_b32 v142, 0
    v_mfma_f32_32x32x16_bf16 v[80:95], v[100:103], v[108:111], 0
    s_waitcnt lgkmcnt(0)
    v_mfma_f32_32x32x16_bf16 v[32:47], v[112:115], v[120:123], v[32:47]
    ds_read_b128 v[96:99], v14 offset:0
    ds_read_b128 v[100:103], v14 offset:4096
    ds_read_b64_tr_b16 v[104:105], v24 offset:4096
    v_mov_b32 v143, 0
    v_mfma_f32_32x32x16_bf16 v[48:63], v[112:115], v[124:127], v[48:63]
    ds_read_b64_tr_b16 v[106:107], v24 offset:4608
    ds_read_b64_tr_b16 v[108:109], v25 offset:4096
    ds_read_b64_tr_b16 v[110:111], v25 offset:4608
    v_lshlrev_b32 v152, 4, v0
    v_mfma_f32_32x32x16_bf16 v[64:79], v[116:119], v[120:123], v[64:79]
    v_add_u32 v152, 122880, v152
    v_mfma_f32_32x32x16_bf16 v[80:95], v[116:119], v[124:127], v[80:95]
    s_waitcnt lgkmcnt(0)
    v_mfma_f32_32x32x16_bf16 v[32:47], v[96:99], v[104:107], v[32:47]
    ds_read_b128 v[112:115], v15 offset:0
    ds_read_b128 v[116:119], v15 offset:4096
    ds_read_b64_tr_b16 v[120:121], v24 offset:6144
    ds_write_b128 v152, v[140:143] offset:0
    v_mfma_f32_32x32x16_bf16 v[48:63], v[96:99], v[108:111], v[48:63]
    ds_read_b64_tr_b16 v[122:123], v24 offset:6656
    ds_read_b64_tr_b16 v[124:125], v25 offset:6144
    ds_read_b64_tr_b16 v[126:127], v25 offset:6656
    ds_write_b128 v152, v[140:143] offset:4096
    v_mfma_f32_32x32x16_bf16 v[64:79], v[100:103], v[104:107], v[64:79]
    ds_write_b128 v152, v[140:143] offset:8192
    v_mfma_f32_32x32x16_bf16 v[80:95], v[100:103], v[108:111], v[80:95]
    s_waitcnt lgkmcnt(0)
    v_mfma_f32_32x32x16_bf16 v[32:47], v[112:115], v[120:123], v[32:47]
    s_barrier
    ds_read_b128 v[96:99], v16 offset:0
    ds_read_b128 v[100:103], v16 offset:4096
    ds_read_b64_tr_b16 v[104:105], v26 offset:0
    ds_write_b128 v152, v[140:143] offset:12288
    v_mfma_f32_32x32x16_bf16 v[48:63], v[112:115], v[124:127], v[48:63]
    ds_read_b64_tr_b16 v[106:107], v26 offset:512
    ds_read_b64_tr_b16 v[108:109], v27 offset:0
    ds_read_b64_tr_b16 v[110:111], v27 offset:512
    ds_write_b128 v152, v[140:143] offset:16384
    v_mfma_f32_32x32x16_bf16 v[64:79], v[116:119], v[120:123], v[64:79]
    v_cmp_gt_u32 vcc, 144, v0
    s_and_saveexec_b64 s[96:97], vcc
    ds_write_b128 v152, v[140:143] offset:20480
    s_mov_b64 exec, s[96:97]
    v_mfma_f32_32x32x16_bf16 v[80:95], v[116:119], v[124:127], v[80:95]
    s_waitcnt lgkmcnt(0)
    v_mfma_f32_32x32x16_bf16 v[32:47], v[96:99], v[104:107], v[32:47]
    ds_read_b128 v[112:115], v17 offset:0
    ds_read_b128 v[116:119], v17 offset:4096
    ds_read_b64_tr_b16 v[120:121], v26 offset:2048
    v_mfma_f32_32x32x16_bf16 v[48:63], v[96:99], v[108:111], v[48:63]
    ds_read_b64_tr_b16 v[122:123], v26 offset:2560
    ds_read_b64_tr_b16 v[124:125], v27 offset:2048
    ds_read_b64_tr_b16 v[126:127], v27 offset:2560
    v_mfma_f32_32x32x16_bf16 v[64:79], v[100:103], v[104:107], v[64:79]
    v_mfma_f32_32x32x16_bf16 v[80:95], v[100:103], v[108:111], v[80:95]
    s_waitcnt lgkmcnt(0)
    v_mfma_f32_32x32x16_bf16 v[32:47], v[112:115], v[120:123], v[32:47]
    ds_read_b128 v[96:99], v18 offset:0
    ds_read_b128 v[100:103], v18 offset:4096
    ds_read_b64_tr_b16 v[104:105], v26 offset:4096
    v_mfma_f32_32x32x16_bf16 v[48:63], v[112:115], v[124:127], v[48:63]
    ds_read_b64_tr_b16 v[106:107], v26 offset:4608
    ds_read_b64_tr_b16 v[108:109], v27 offset:4096
    ds_read_b64_tr_b16 v[110:111], v27 offset:4608
    v_mfma_f32_32x32x16_bf16 v[64:79], v[116:119], v[120:123], v[64:79]
    v_mfma_f32_32x32x16_bf16 v[80:95], v[116:119], v[124:127], v[80:95]
    s_waitcnt lgkmcnt(0)
    v_mfma_f32_32x32x16_bf16 v[32:47], v[96:99], v[104:107], v[32:47]
    ds_read_b128 v[112:115], v19 offset:0
    ds_read_b128 v[116:119], v19 offset:4096
    ds_read_b64_tr_b16 v[120:121], v26 offset:6144
    v_mfma_f32_32x32x16_bf16 v[48:63], v[96:99], v[108:111], v[48:63]
    ds_read_b64_tr_b16 v[122:123], v26 offset:6656
    ds_read_b64_tr_b16 v[124:125], v27 offset:6144
    ds_read_b64_tr_b16 v[126:127], v27 offset:6656
    v_mfma_f32_32x32x16_bf16 v[64:79], v[100:103], v[104:107], v[64:79]
    v_mfma_f32_32x32x16_bf16 v[80:95], v[100:103], v[108:111], v[80:95]
    s_waitcnt lgkmcnt(0)
    v_mfma_f32_32x32x16_bf16 v[32:47], v[112:115], v[120:123], v[32:47]
    s_barrier
    ds_read_b128 v[96:99], v20 offset:0
    ds_read_b128 v[100:103], v20 offset:4096
    ds_read_b64_tr_b16 v[104:105], v28 offset:0
    v_mfma_f32_32x32x16_bf16 v[48:63], v[112:115], v[124:127], v[48:63]
    ds_read_b64_tr_b16 v[106:107], v28 offset:512
    ds_read_b64_tr_b16 v[108:109], v29 offset:0
    ds_read_b64_tr_b16 v[110:111], v29 offset:512
    v_mfma_f32_32x32x16_bf16 v[64:79], v[116:119], v[120:123], v[64:79]
    v_mfma_f32_32x32x16_bf16 v[80:95], v[116:119], v[124:127], v[80:95]
    s_waitcnt lgkmcnt(0)
    v_mfma_f32_32x32x16_bf16 v[32:47], v[96:99], v[104:107], v[32:47]
    ds_read_b128 v[112:115], v21 offset:0
    ds_read_b128 v[116:119], v21 offset:4096
    ds_read_b64_tr_b16 v[120:121], v28 offset:2048
    s_waitcnt vmcnt(0)
    v_mfma_f32_32x32x16_bf16 v[48:63], v[96:99], v[108:111], v[48:63]
    ds_read_b64_tr_b16 v[122:123], v28 offset:2560
    ds_read_b64_tr_b16 v[124:125], v29 offset:2048
    ds_read_b64_tr_b16 v[126:127], v29 offset:2560
    v_and_b32 v152, 63, v0
    v_mfma_f32_32x32x16_bf16 v[64:79], v[100:103], v[104:107], v[64:79]
    v_lshrrev_b32 v153, 6, v0
    v_mfma_f32_32x32x16_bf16 v[80:95], v[100:103], v[108:111], v[80:95]
    s_waitcnt lgkmcnt(0)
    v_mfma_f32_32x32x16_bf16 v[32:47], v[112:115], v[120:123], v[32:47]
    ds_read_b128 v[96:99], v22 offset:0
    ds_read_b128 v[100:103], v22 offset:4096
    ds_read_b64_tr_b16 v[104:105], v28 offset:4096
    v_mul_u32_u24 v152, 356, v152
    v_mfma_f32_32x32x16_bf16 v[48:63], v[112:115], v[124:127], v[48:63]
    ds_read_b64_tr_b16 v[106:107], v28 offset:4608
    ds_read_b64_tr_b16 v[108:109], v29 offset:4096
    ds_read_b64_tr_b16 v[110:111], v29 offset:4608
    v_lshl_add_u32 v152, v153, 1, v152
    v_mfma_f32_32x32x16_bf16 v[64:79], v[116:119], v[120:123], v[64:79]
    v_add_u32 v152, 122880, v152
    v_mfma_f32_32x32x16_bf16 v[80:95], v[116:119], v[124:127], v[80:95]
    s_waitcnt lgkmcnt(0)
    v_mfma_f32_32x32x16_bf16 v[32:47], v[96:99], v[104:107], v[32:47]
    ds_read_b128 v[112:115], v23 offset:0
    ds_read_b128 v[116:119], v23 offset:4096
    ds_read_b64_tr_b16 v[120:121], v28 offset:6144
    ds_write_b16 v152, v144 offset:32
    v_mfma_f32_32x32x16_bf16 v[48:63], v[96:99], v[108:111], v[48:63]
    ds_read_b64_tr_b16 v[122:123], v28 offset:6656
    ds_read_b64_tr_b16 v[124:125], v29 offset:6144
    ds_read_b64_tr_b16 v[126:127], v29 offset:6656
    ds_write_b16 v152, v144 offset:206
    v_mfma_f32_32x32x16_bf16 v[64:79], v[100:103], v[104:107], v[64:79]
    ds_write_b16 v152, v145 offset:40
    v_mfma_f32_32x32x16_bf16 v[80:95], v[100:103], v[108:111], v[80:95]
    s_waitcnt lgkmcnt(0)
    v_mfma_f32_32x32x16_bf16 v[32:47], v[112:115], v[120:123], v[32:47]
    s_barrier
    ds_read_b128 v[96:99], v12 offset:0
    ds_read_b128 v[100:103], v12 offset:4096
    ds_read_b64_tr_b16 v[104:105], v24 offset:0
    ds_write_b16 v152, v145 offset:214
    v_mfma_f32_32x32x16_bf16 v[48:63], v[112:115], v[124:127], v[48:63]
    ds_read_b64_tr_b16 v[106:107], v24 offset:512
    ds_read_b64_tr_b16 v[108:109], v25 offset:0
    ds_read_b64_tr_b16 v[110:111], v25 offset:512
    ds_write_b16 v152, v146 offset:48
    v_mfma_f32_32x32x16_bf16 v[64:79], v[116:119], v[120:123], v[64:79]
    ds_write_b16 v152, v146 offset:222
    v_mfma_f32_32x32x16_bf16 v[80:95], v[116:119], v[124:127], v[80:95]
    s_waitcnt lgkmcnt(0)
    v_mfma_f32_32x32x16_bf16 v[32:47], v[96:99], v[104:107], v[32:47]
    ds_read_b128 v[112:115], v13 offset:0
    ds_read_b128 v[116:119], v13 offset:4096
    ds_read_b64_tr_b16 v[120:121], v24 offset:2048
    ds_write_b16 v152, v147 offset:56
    v_mfma_f32_32x32x16_bf16 v[48:63], v[96:99], v[108:111], v[48:63]
    ds_read_b64_tr_b16 v[122:123], v24 offset:2560
    ds_read_b64_tr_b16 v[124:125], v25 offset:2048
    ds_read_b64_tr_b16 v[126:127], v25 offset:2560
    ds_write_b16 v152, v147 offset:230
    v_mfma_f32_32x32x16_bf16 v[64:79], v[100:103], v[104:107], v[64:79]
    ds_write_b16 v152, v148 offset:64
    v_mfma_f32_32x32x16_bf16 v[80:95], v[100:103], v[108:111], v[80:95]
    s_waitcnt lgkmcnt(0)
    v_mfma_f32_32x32x16_bf16 v[32:47], v[112:115], v[120:123], v[32:47]
    ds_read_b128 v[96:99], v14 offset:0
    ds_read_b128 v[100:103], v14 offset:4096
    ds_read_b64_tr_b16 v[104:105], v24 offset:4096
    ds_write_b16 v152, v148 offset:238
    v_mfma_f32_32x32x16_bf16 v[48:63], v[112:115], v[124:127], v[48:63]
    ds_read_b64_tr_b16 v[106:107], v24 offset:4608
    ds_read_b64_tr_b16 v[108:109], v25 offset:4096
    ds_read_b64_tr_b16 v[110:111], v25 offset:4608
    ds_write_b16 v152, v149 offset:72
    v_mfma_f32_32x32x16_bf16 v[64:79], v[116:119], v[120:123], v[64:79]
    v_mfma_f32_32x32x16_bf16 v[80:95], v[116:119], v[124:127], v[80:95]
    s_waitcnt lgkmcnt(0)
    v_mfma_f32_32x32x16_bf16 v[32:47], v[96:99], v[104:107], v[32:47]
    ds_read_b128 v[112:115], v15 offset:0
    ds_read_b128 v[116:119], v15 offset:4096
    ds_read_b64_tr_b16 v[120:121], v24 offset:6144
    ds_write_b16 v152, v149 offset:246
    v_mfma_f32_32x32x16_bf16 v[48:63], v[96:99], v[108:111], v[48:63]
    ds_read_b64_tr_b16 v[122:123], v24 offset:6656
    ds_read_b64_tr_b16 v[124:125], v25 offset:6144
    ds_read_b64_tr_b16 v[126:127], v25 offset:6656
    ds_write_b16 v152, v150 offset:80
    v_mfma_f32_32x32x16_bf16 v[64:79], v[100:103], v[104:107], v[64:79]
    v_mfma_f32_32x32x16_bf16 v[80:95], v[100:103], v[108:111], v[80:95]
    s_waitcnt lgkmcnt(0)
    v_mfma_f32_32x32x16_bf16 v[32:47], v[112:115], v[120:123], v[32:47]
    s_barrier
    ds_read_b128 v[96:99], v16 offset:0
    ds_read_b128 v[100:103], v16 offset:4096
    ds_read_b64_tr_b16 v[104:105], v26 offset:0
    ds_write_b16 v152, v150 offset:254
    v_mfma_f32_32x32x16_bf16 v[48:63], v[112:115], v[124:127], v[48:63]
    ds_read_b64_tr_b16 v[106:107], v26 offset:512
    ds_read_b64_tr_b16 v[108:109], v27 offset:0
    ds_read_b64_tr_b16 v[110:111], v27 offset:512
    v_cmp_gt_u32 vcc, 3, v153
    s_and_saveexec_b64 s[96:97], vcc
    ds_write_b16 v152, v151 offset:88
    ds_write_b16 v152, v151 offset:262
    s_mov_b64 exec, s[96:97]
    v_mfma_f32_32x32x16_bf16 v[64:79], v[116:119], v[120:123], v[64:79]
    v_mfma_f32_32x32x16_bf16 v[80:95], v[116:119], v[124:127], v[80:95]
    s_waitcnt lgkmcnt(0)
    v_mfma_f32_32x32x16_bf16 v[32:47], v[96:99], v[104:107], v[32:47]
    ds_read_b128 v[112:115], v17 offset:0
    ds_read_b128 v[116:119], v17 offset:4096
    ds_read_b64_tr_b16 v[120:121], v26 offset:2048
    v_and_b32 v152, 31, v1
    v_bfe_u32 v153, v1, 1, 3
    v_mul_u32_u24 v152, 640, v152
    v_mfma_f32_32x32x16_bf16 v[48:63], v[96:99], v[108:111], v[48:63]
    ds_read_b64_tr_b16 v[122:123], v26 offset:2560
    ds_read_b64_tr_b16 v[124:125], v27 offset:2048
    ds_read_b64_tr_b16 v[126:127], v27 offset:2560
    v_lshrrev_b32 v154, 5, v1
    v_lshl_add_u32 v152, v154, 3, v152
    s_lshl_b32 s99, s20, 7
    s_add_u32 s99, s99, 0
    v_add_u32 v152, s99, v152
    v_mfma_f32_32x32x16_bf16 v[64:79], v[100:103], v[104:107], v[64:79]
    v_xor_b32 v154, 0, v153
    v_lshl_add_u32 v129, v154, 4, v152
    v_mfma_f32_32x32x16_bf16 v[80:95], v[100:103], v[108:111], v[80:95]
    v_xor_b32 v154, 1, v153
    v_lshl_add_u32 v130, v154, 4, v152
    s_waitcnt lgkmcnt(0)
    v_mfma_f32_32x32x16_bf16 v[32:47], v[112:115], v[120:123], v[32:47]
    ds_read_b128 v[96:99], v18 offset:0
    ds_read_b128 v[100:103], v18 offset:4096
    ds_read_b64_tr_b16 v[104:105], v26 offset:4096
    v_xor_b32 v154, 2, v153
    v_lshl_add_u32 v131, v154, 4, v152
    v_xor_b32 v154, 3, v153
    v_mfma_f32_32x32x16_bf16 v[48:63], v[112:115], v[124:127], v[48:63]
    ds_read_b64_tr_b16 v[106:107], v26 offset:4608
    ds_read_b64_tr_b16 v[108:109], v27 offset:4096
    ds_read_b64_tr_b16 v[110:111], v27 offset:4608
    v_lshl_add_u32 v132, v154, 4, v152
    v_xor_b32 v154, 4, v153
    v_lshl_add_u32 v133, v154, 4, v152
    v_mfma_f32_32x32x16_bf16 v[64:79], v[116:119], v[120:123], v[64:79]
    v_xor_b32 v154, 5, v153
    v_lshl_add_u32 v134, v154, 4, v152
    v_mfma_f32_32x32x16_bf16 v[80:95], v[116:119], v[124:127], v[80:95]
    v_xor_b32 v154, 6, v153
    v_lshl_add_u32 v135, v154, 4, v152
    s_waitcnt lgkmcnt(0)
    v_mfma_f32_32x32x16_bf16 v[32:47], v[96:99], v[104:107], v[32:47]
    ds_read_b128 v[112:115], v19 offset:0
    ds_read_b128 v[116:119], v19 offset:4096
    ds_read_b64_tr_b16 v[120:121], v26 offset:6144
    v_xor_b32 v154, 7, v153
    v_lshl_add_u32 v136, v154, 4, v152
    v_lshrrev_b32 v155, 2, v0
    v_mfma_f32_32x32x16_bf16 v[48:63], v[96:99], v[108:111], v[48:63]
    ds_read_b64_tr_b16 v[122:123], v26 offset:6656
    ds_read_b64_tr_b16 v[124:125], v27 offset:6144
    ds_read_b64_tr_b16 v[126:127], v27 offset:6656
    v_mul_u32_u24 v155, 640, v155
    v_and_b32 v156, 3, v0
    v_mfma_f32_32x32x16_bf16 v[64:79], v[100:103], v[104:107], v[64:79]
    v_lshl_add_u32 v137, v156, 5, v155
    v_and_b32 v152, 15, v1
    v_mfma_f32_32x32x16_bf16 v[80:95], v[100:103], v[108:111], v[80:95]
    v_lshrrev_b32 v153, 4, v1
    v_lshlrev_b32 v154, 3, v153
    s_waitcnt lgkmcnt(0)
    v_mfma_f32_32x32x16_bf16 v[32:47], v[112:115], v[120:123], v[32:47]
    s_barrier
    ds_read_b128 v[96:99], v20 offset:0
    ds_read_b128 v[100:103], v20 offset:4096
    ds_read_b64_tr_b16 v[104:105], v28 offset:0
    v_mfma_f32_32x32x16_bf16 v[48:63], v[112:115], v[124:127], v[48:63]
    ds_read_b64_tr_b16 v[106:107], v28 offset:512
    ds_read_b64_tr_b16 v[108:109], v29 offset:0
    ds_read_b64_tr_b16 v[110:111], v29 offset:512
    v_mfma_f32_32x32x16_bf16 v[64:79], v[116:119], v[120:123], v[64:79]
    v_mfma_f32_32x32x16_bf16 v[80:95], v[116:119], v[124:127], v[80:95]
    s_waitcnt lgkmcnt(0)
    v_mfma_f32_32x32x16_bf16 v[32:47], v[96:99], v[104:107], v[32:47]
    ds_read_b128 v[112:115], v21 offset:0
    ds_read_b128 v[116:119], v21 offset:4096
    ds_read_b64_tr_b16 v[120:121], v28 offset:2048
    v_sub_u32 v154, v154, v152
    v_add_u32 v154, 15, v154
    v_and_b32 v157, 1, v154
    v_mfma_f32_32x32x16_bf16 v[48:63], v[96:99], v[108:111], v[48:63]
    ds_read_b64_tr_b16 v[122:123], v28 offset:2560
    ds_read_b64_tr_b16 v[124:125], v29 offset:2048
    ds_read_b64_tr_b16 v[126:127], v29 offset:2560
    v_mul_u32_u24 v157, 176, v157
    v_lshrrev_b32 v154, 1, v154
    v_mfma_f32_32x32x16_bf16 v[64:79], v[100:103], v[104:107], v[64:79]
    v_lshl_add_u32 v157, v154, 2, v157
    s_mul_i32 s99, s20, 2848
    s_add_u32 s99, s99, 122880
    v_add_u32 v157, s99, v157
    v_mfma_f32_32x32x16_bf16 v[80:95], v[100:103], v[108:111], v[80:95]
    v_lshl_add_u32 v154, v152, 1, v153
    v_lshlrev_b32 v154, 4, v154
    s_waitcnt lgkmcnt(0)
    v_mfma_f32_32x32x16_bf16 v[32:47], v[112:115], v[120:123], v[32:47]
    ds_read_b128 v[96:99], v22 offset:0
    ds_read_b128 v[100:103], v22 offset:4096
    ds_read_b64_tr_b16 v[104:105], v28 offset:4096
    s_mul_i32 s99, s20, 5120
    s_add_u32 s99, s99, 0
    v_add_u32 v158, s99, v154
    v_add_u32 v159, 64, v158
    s_and_b32 s99, s20, 1
    s_lshl_b32 s99, s99, 6
    v_xor_b32 v158, s99, v158
    v_mfma_f32_32x32x16_bf16 v[48:63], v[112:115], v[124:127], v[48:63]
    ds_read_b64_tr_b16 v[106:107], v28 offset:4608
    ds_read_b64_tr_b16 v[108:109], v29 offset:4096
    ds_read_b64_tr_b16 v[110:111], v29 offset:4608
    s_and_b32 s99, s20, 1
    s_lshl_b32 s99, s99, 6
    v_xor_b32 v159, s99, v159
    v_lshlrev_b32 v154, 2, v153
    v_mfma_f32_32x32x16_bf16 v[64:79], v[116:119], v[120:123], v[64:79]
    v_lshl_add_u32 v154, v152, 4, v154
    v_lshlrev_b32 v154, 7, v154
    v_mfma_f32_32x32x16_bf16 v[80:95], v[116:119], v[124:127], v[80:95]
    v_add_u32 v154, 40960, v154
    v_and_b32 v152, 7, v152
    s_waitcnt lgkmcnt(0)
    v_mfma_f32_32x32x16_bf16 v[32:47], v[96:99], v[104:107], v[32:47]
    ds_read_b128 v[112:115], v23 offset:0
    ds_read_b128 v[116:119], v23 offset:4096
    ds_read_b64_tr_b16 v[120:121], v28 offset:6144
    s_mul_i32 s99, s20, 1
    s_add_u32 s99, s99, 0
    v_xor_b32 v153, s99, v152
    v_lshl_add_u32 v162, v153, 4, v154
    v_and_b32 v152, 15, v1
    v_mfma_f32_32x32x16_bf16 v[48:63], v[96:99], v[108:111], v[48:63]
    ds_read_b64_tr_b16 v[122:123], v28 offset:6656
    ds_read_b64_tr_b16 v[124:125], v29 offset:6144
    ds_read_b64_tr_b16 v[126:127], v29 offset:6656
    v_lshrrev_b32 v153, 4, v1
    v_lshlrev_b32 v153, 3, v153
    v_mfma_f32_32x32x16_bf16 v[64:79], v[100:103], v[104:107], v[64:79]
    v_sub_u32 v152, v152, v153
    v_add_u32 v152, 16, v152
    v_mfma_f32_32x32x16_bf16 v[80:95], v[100:103], v[108:111], v[80:95]
    v_mov_b32 v168, 0
    v_mov_b32 v153, 0x3f80
    s_waitcnt lgkmcnt(0)
    v_mfma_f32_32x32x16_bf16 v[32:47], v[112:115], v[120:123], v[32:47]
    s_barrier
    ds_read_b128 v[96:99], v12 offset:0
    ds_read_b128 v[100:103], v12 offset:4096
    ds_read_b64_tr_b16 v[104:105], v24 offset:0
    v_mfma_f32_32x32x16_bf16 v[48:63], v[112:115], v[124:127], v[48:63]
    ds_read_b64_tr_b16 v[106:107], v24 offset:512
    ds_read_b64_tr_b16 v[108:109], v25 offset:0
    ds_read_b64_tr_b16 v[110:111], v25 offset:512
    v_mfma_f32_32x32x16_bf16 v[64:79], v[116:119], v[120:123], v[64:79]
    v_mfma_f32_32x32x16_bf16 v[80:95], v[116:119], v[124:127], v[80:95]
    s_waitcnt lgkmcnt(0)
    v_mfma_f32_32x32x16_bf16 v[32:47], v[96:99], v[104:107], v[32:47]
    ds_read_b128 v[112:115], v13 offset:0
    ds_read_b128 v[116:119], v13 offset:4096
    ds_read_b64_tr_b16 v[120:121], v24 offset:2048
    v_mov_b32 v154, 0x3f800000
    v_cmp_eq_u32 vcc, 0, v152
    s_nop 1
    v_cndmask_b32 v168, v168, v153, vcc
    v_cmp_eq_u32 vcc, 1, v152
    s_nop 1
    v_cndmask_b32 v168, v168, v154, vcc
    v_mfma_f32_32x32x16_bf16 v[48:63], v[96:99], v[108:111], v[48:63]
    ds_read_b64_tr_b16 v[122:123], v24 offset:2560
    ds_read_b64_tr_b16 v[124:125], v25 offset:2048
    ds_read_b64_tr_b16 v[126:127], v25 offset:2560
    v_mov_b32 v169, 0
    v_mov_b32 v153, 0x3f80
    v_mfma_f32_32x32x16_bf16 v[64:79], v[100:103], v[104:107], v[64:79]
    v_mov_b32 v154, 0x3f800000
    v_cmp_eq_u32 vcc, 2, v152
    s_nop 1
    v_cndmask_b32 v169, v169, v153, vcc
    v_mfma_f32_32x32x16_bf16 v[80:95], v[100:103], v[108:111], v[80:95]
    v_cmp_eq_u32 vcc, 3, v152
    s_nop 1
    v_cndmask_b32 v169, v169, v154, vcc
    v_mov_b32 v170, 0
    s_waitcnt lgkmcnt(0)
    v_mfma_f32_32x32x16_bf16 v[32:47], v[112:115], v[120:123], v[32:47]
    ds_read_b128 v[96:99], v14 offset:0
    ds_read_b128 v[100:103], v14 offset:4096
    ds_read_b64_tr_b16 v[104:105], v24 offset:4096
    v_mov_b32 v153, 0x3f80
    v_mov_b32 v154, 0x3f800000
    v_cmp_eq_u32 vcc, 4, v152
    s_nop 1
    v_cndmask_b32 v170, v170, v153, vcc
    v_mfma_f32_32x32x16_bf16 v[48:63], v[112:115], v[124:127], v[48:63]
    ds_read_b64_tr_b16 v[106:107], v24 offset:4608
    ds_read_b64_tr_b16 v[108:109], v25 offset:4096
    ds_read_b64_tr_b16 v[110:111], v25 offset:4608
    v_cmp_eq_u32 vcc, 5, v152
    s_nop 1
    v_cndmask_b32 v170, v170, v154, vcc
    v_mov_b32 v171, 0
    v_mfma_f32_32x32x16_bf16 v[64:79], v[116:119], v[120:123], v[64:79]
    v_mov_b32 v153, 0x3f80
    v_mov_b32 v154, 0x3f800000
    v_mfma_f32_32x32x16_bf16 v[80:95], v[116:119], v[124:127], v[80:95]
    v_cmp_eq_u32 vcc, 6, v152
    s_nop 1
    v_cndmask_b32 v171, v171, v153, vcc
    v_cmp_eq_u32 vcc, 7, v152
    s_nop 1
    v_cndmask_b32 v171, v171, v154, vcc
    s_waitcnt lgkmcnt(0)
    v_mfma_f32_32x32x16_bf16 v[32:47], v[96:99], v[104:107], v[32:47]
    ds_read_b128 v[112:115], v15 offset:0
    ds_read_b128 v[116:119], v15 offset:4096
    ds_read_b64_tr_b16 v[120:121], v24 offset:6144
    v_lshrrev_b32 v152, 3, v0
    v_and_b32 v153, 7, v0
    v_lshrrev_b32 v154, 4, v152
    v_mfma_f32_32x32x16_bf16 v[48:63], v[96:99], v[108:111], v[48:63]
    ds_read_b64_tr_b16 v[122:123], v24 offset:6656
    ds_read_b64_tr_b16 v[124:125], v25 offset:6144
    ds_read_b64_tr_b16 v[126:127], v25 offset:6656
    v_add_u32 v155, s26, v152
    v_lshlrev_b32 v155, 11, v155
    v_mfma_f32_32x32x16_bf16 v[64:79], v[100:103], v[104:107], v[64:79]
    v_lshl_add_u32 v155, v153, 4, v155
    v_add_u32 v176, s28, v155
    v_mfma_f32_32x32x16_bf16 v[80:95], v[100:103], v[108:111], v[80:95]
    v_add_u32 v177, 131072, v176
    v_add_u32 v178, 262144, v176
    s_waitcnt lgkmcnt(0)
    v_mfma_f32_32x32x16_bf16 v[32:47], v[112:115], v[120:123], v[32:47]
    s_barrier
    ds_read_b128 v[96:99], v16 offset:0
    ds_read_b128 v[100:103], v16 offset:4096
    ds_read_b64_tr_b16 v[104:105], v26 offset:0
    v_mfma_f32_32x32x16_bf16 v[48:63], v[112:115], v[124:127], v[48:63]
    ds_read_b64_tr_b16 v[106:107], v26 offset:512
    ds_read_b64_tr_b16 v[108:109], v27 offset:0
    ds_read_b64_tr_b16 v[110:111], v27 offset:512
    v_mfma_f32_32x32x16_bf16 v[64:79], v[116:119], v[120:123], v[64:79]
    v_mfma_f32_32x32x16_bf16 v[80:95], v[116:119], v[124:127], v[80:95]
    s_waitcnt lgkmcnt(0)
    v_mfma_f32_32x32x16_bf16 v[32:47], v[96:99], v[104:107], v[32:47]
    ds_read_b128 v[112:115], v17 offset:0
    ds_read_b128 v[116:119], v17 offset:4096
    ds_read_b64_tr_b16 v[120:121], v26 offset:2048
    v_add_u32 v179, 393216, v176
    v_mov_b32 v155, 0x80000000
    v_cmp_gt_u32 vcc, 32, v152
    s_nop 1
    v_cndmask_b32 v179, v155, v179, vcc
    v_mfma_f32_32x32x16_bf16 v[48:63], v[96:99], v[108:111], v[48:63]
    ds_read_b64_tr_b16 v[122:123], v26 offset:2560
    ds_read_b64_tr_b16 v[124:125], v27 offset:2048
    ds_read_b64_tr_b16 v[126:127], v27 offset:2560
    v_add_u32 v155, 0, v154
    v_and_b32 v155, 7, v155
    v_mfma_f32_32x32x16_bf16 v[64:79], v[100:103], v[104:107], v[64:79]
    v_xor_b32 v155, v155, v153
    v_lshlrev_b32 v155, 4, v155
    v_mfma_f32_32x32x16_bf16 v[80:95], v[100:103], v[108:111], v[80:95]
    v_lshl_add_u32 v155, v152, 7, v155
    v_add_u32 v172, 40960, v155
    s_waitcnt lgkmcnt(0)
    v_mfma_f32_32x32x16_bf16 v[32:47], v[112:115], v[120:123], v[32:47]
    ds_read_b128 v[96:99], v18 offset:0
    ds_read_b128 v[100:103], v18 offset:4096
    ds_read_b64_tr_b16 v[104:105], v26 offset:4096
    v_add_u32 v155, 4, v154
    v_and_b32 v155, 7, v155
    v_xor_b32 v155, v155, v153
    v_mfma_f32_32x32x16_bf16 v[48:63], v[112:115], v[124:127], v[48:63]
    ds_read_b64_tr_b16 v[106:107], v26 offset:4608
    ds_read_b64_tr_b16 v[108:109], v27 offset:4096
    ds_read_b64_tr_b16 v[110:111], v27 offset:4608
    v_lshlrev_b32 v155, 4, v155
    v_lshl_add_u32 v155, v152, 7, v155
    v_mfma_f32_32x32x16_bf16 v[64:79], v[116:119], v[120:123], v[64:79]
    v_add_u32 v173, 49152, v155
    v_add_u32 v155, 8, v154
    v_mfma_f32_32x32x16_bf16 v[80:95], v[116:119], v[124:127], v[80:95]
    v_and_b32 v155, 7, v155
    v_xor_b32 v155, v155, v153
    s_waitcnt lgkmcnt(0)
    v_mfma_f32_32x32x16_bf16 v[32:47], v[96:99], v[104:107], v[32:47]
    ds_read_b128 v[112:115], v19 offset:0
    ds_read_b128 v[116:119], v19 offset:4096
    ds_read_b64_tr_b16 v[120:121], v26 offset:6144
    v_lshlrev_b32 v155, 4, v155
    v_lshl_add_u32 v155, v152, 7, v155
    v_add_u32 v174, 57344, v155
    v_mfma_f32_32x32x16_bf16 v[48:63], v[96:99], v[108:111], v[48:63]
    ds_read_b64_tr_b16 v[122:123], v26 offset:6656
    ds_read_b64_tr_b16 v[124:125], v27 offset:6144
    ds_read_b64_tr_b16 v[126:127], v27 offset:6656
    v_add_u32 v155, 12, v154
    v_and_b32 v155, 7, v155
    v_mfma_f32_32x32x16_bf16 v[64:79], v[100:103], v[104:107], v[64:79]
    v_xor_b32 v155, v155, v153
    v_lshlrev_b32 v155, 4, v155
    v_mfma_f32_32x32x16_bf16 v[80:95], v[100:103], v[108:111], v[80:95]
    v_lshl_add_u32 v155, v152, 7, v155
    v_add_u32 v175, 65536, v155
    s_waitcnt lgkmcnt(0)
    v_mfma_f32_32x32x16_bf16 v[32:47], v[112:115], v[120:123], v[32:47]
    v_mfma_f32_32x32x16_bf16 v[48:63], v[112:115], v[124:127], v[48:63]
    v_mfma_f32_32x32x16_bf16 v[64:79], v[116:119], v[120:123], v[64:79]
    v_mfma_f32_32x32x16_bf16 v[80:95], v[116:119], v[124:127], v[80:95]
    s_nop 7
    s_barrier
    ds_write_b128 v137, v[140:143] offset:512
    ds_write_b128 v137, v[140:143] offset:528
    v_cvt_pk_bf16_f32 v180, v32, v33
    v_cvt_pk_bf16_f32 v181, v34, v35
    v_cvt_pk_bf16_f32 v182, v36, v37
    v_cvt_pk_bf16_f32 v183, v38, v39
    v_cvt_pk_bf16_f32 v184, v40, v41
    v_cvt_pk_bf16_f32 v185, v42, v43
    v_cvt_pk_bf16_f32 v186, v44, v45
    v_cvt_pk_bf16_f32 v187, v46, v47
    ds_write_b64 v129, v[180:181] offset:0
    ds_write_b64 v130, v[182:183] offset:0
    ds_write_b64 v131, v[184:185] offset:0
    ds_write_b64 v132, v[186:187] offset:0
    v_cvt_pk_bf16_f32 v180, v64, v65
    v_cvt_pk_bf16_f32 v181, v66, v67
    v_cvt_pk_bf16_f32 v182, v68, v69
    v_cvt_pk_bf16_f32 v183, v70, v71
    v_cvt_pk_bf16_f32 v184, v72, v73
    v_cvt_pk_bf16_f32 v185, v74, v75
    v_cvt_pk_bf16_f32 v186, v76, v77
    v_cvt_pk_bf16_f32 v187, v78, v79
    ds_write_b64 v133, v[180:181] offset:0
    ds_write_b64 v134, v[182:183] offset:0
    ds_write_b64 v135, v[184:185] offset:0
    ds_write_b64 v136, v[186:187] offset:0
    v_cvt_pk_bf16_f32 v180, v48, v49
    v_cvt_pk_bf16_f32 v181, v50, v51
    v_cvt_pk_bf16_f32 v182, v52, v53
    v_cvt_pk_bf16_f32 v183, v54, v55
    v_cvt_pk_bf16_f32 v184, v56, v57
    v_cvt_pk_bf16_f32 v185, v58, v59
    v_cvt_pk_bf16_f32 v186, v60, v61
    v_cvt_pk_bf16_f32 v187, v62, v63
    ds_write_b64 v129, v[180:181] offset:20480
    ds_write_b64 v130, v[182:183] offset:20480
    ds_write_b64 v131, v[184:185] offset:20480
    ds_write_b64 v132, v[186:187] offset:20480
    v_cvt_pk_bf16_f32 v180, v80, v81
    v_cvt_pk_bf16_f32 v181, v82, v83
    v_cvt_pk_bf16_f32 v182, v84, v85
    v_cvt_pk_bf16_f32 v183, v86, v87
    v_cvt_pk_bf16_f32 v184, v88, v89
    v_cvt_pk_bf16_f32 v185, v90, v91
    v_cvt_pk_bf16_f32 v186, v92, v93
    v_cvt_pk_bf16_f32 v187, v94, v95
    ds_write_b64 v133, v[180:181] offset:20480
    ds_write_b64 v134, v[182:183] offset:20480
    ds_write_b64 v135, v[184:185] offset:20480
    ds_write_b64 v136, v[186:187] offset:20480
    s_waitcnt lgkmcnt(0)
    s_barrier
    v_add_u32 v164, 0, v157
    ds_read2_b32 v[32:33], v164 offset0:0 offset1:1
    ds_read2_b32 v[34:35], v164 offset0:2 offset1:3
    ds_read2_b32 v[36:37], v164 offset0:16 offset1:17
    ds_read2_b32 v[38:39], v164 offset0:18 offset1:19
    v_xor_b32 v160, 0, v158
    v_xor_b32 v161, 0, v159
    ds_read_b128 v[56:59], v160 offset:0
    ds_read_b128 v[60:63], v161 offset:0
    v_add_u32 v164, 356, v157
    ds_read2_b32 v[40:41], v164 offset0:0 offset1:1
    ds_read2_b32 v[42:43], v164 offset0:2 offset1:3
    ds_read2_b32 v[44:45], v164 offset0:16 offset1:17
    ds_read2_b32 v[46:47], v164 offset0:18 offset1:19
    ds_read_b128 v[64:67], v160 offset:640
    ds_read_b128 v[68:71], v161 offset:640
    v_add_u32 v164, 712, v157
    ds_read2_b32 v[48:49], v164 offset0:0 offset1:1
    ds_read2_b32 v[50:51], v164 offset0:2 offset1:3
    ds_read2_b32 v[52:53], v164 offset0:16 offset1:17
    ds_read2_b32 v[54:55], v164 offset0:18 offset1:19
    v_xor_b32 v160, 16, v158
    v_xor_b32 v161, 16, v159
    ds_read_b128 v[72:75], v160 offset:1280
    ds_read_b128 v[76:79], v161 offset:1280
    s_waitcnt lgkmcnt(12)
    v_mfma_f32_16x16x32_bf16 v[80:83], v[32:35], v[56:59], 0
    v_mfma_f32_16x16x32_bf16 v[80:83], v[36:39], v[60:63], v[80:83]
    v_mfma_f32_16x16x32_bf16 v[80:83], v[168:171], v[56:59], v[80:83]
    v_add_u32 v164, 1068, v157
    ds_read2_b32 v[32:33], v164 offset0:0 offset1:1
    ds_read2_b32 v[34:35], v164 offset0:2 offset1:3
    ds_read2_b32 v[36:37], v164 offset0:16 offset1:17
    ds_read2_b32 v[38:39], v164 offset0:18 offset1:19
    ds_read_b128 v[56:59], v160 offset:1920
    ds_read_b128 v[60:63], v161 offset:1920
    s_waitcnt lgkmcnt(12)
    v_mfma_f32_16x16x32_bf16 v[84:87], v[40:43], v[64:67], 0
    v_mfma_f32_16x16x32_bf16 v[84:87], v[44:47], v[68:71], v[84:87]
    v_mfma_f32_16x16x32_bf16 v[84:87], v[168:171], v[64:67], v[84:87]
    v_add_u32 v164, 1424, v157
    ds_read2_b32 v[40:41], v164 offset0:0 offset1:1
    ds_read2_b32 v[42:43], v164 offset0:2 offset1:3
    ds_read2_b32 v[44:45], v164 offset0:16 offset1:17
    ds_read2_b32 v[46:47], v164 offset0:18 offset1:19
    v_xor_b32 v160, 32, v158
    v_xor_b32 v161, 32, v159
    ds_read_b128 v[64:67], v160 offset:2560
    ds_read_b128 v[68:71], v161 offset:2560
    s_waitcnt lgkmcnt(12)
    v_mfma_f32_16x16x32_bf16 v[88:91], v[48:51], v[72:75], 0
    v_mfma_f32_16x16x32_bf16 v[88:91], v[52:55], v[76:79], v[88:91]
    v_mfma_f32_16x16x32_bf16 v[88:91], v[168:171], v[72:75], v[88:91]
    v_add_u32 v164, 1780, v157
    ds_read2_b32 v[48:49], v164 offset0:0 offset1:1
    ds_read2_b32 v[50:51], v164 offset0:2 offset1:3
    ds_read2_b32 v[52:53], v164 offset0:16 offset1:17
    ds_read2_b32 v[54:55], v164 offset0:18 offset1:19
    ds_read_b128 v[72:75], v160 offset:3200
    ds_read_b128 v[76:79], v161 offset:3200
    s_waitcnt lgkmcnt(12)
    v_mfma_f32_16x16x32_bf16 v[92:95], v[32:35], v[56:59], 0
    v_mfma_f32_16x16x32_bf16 v[92:95], v[36:39], v[60:63], v[92:95]
    v_mfma_f32_16x16x32_bf16 v[92:95], v[168:171], v[56:59], v[92:95]
    v_add_u32 v164, 2136, v157
    ds_read2_b32 v[32:33], v164 offset0:0 offset1:1
    ds_read2_b32 v[34:35], v164 offset0:2 offset1:3
    ds_read2_b32 v[36:37], v164 offset0:16 offset1:17
    ds_read2_b32 v[38:39], v164 offset0:18 offset1:19
    v_xor_b32 v160, 48, v158
    v_xor_b32 v161, 48, v159
    ds_read_b128 v[56:59], v160 offset:3840
    ds_read_b128 v[60:63], v161 offset:3840
    s_waitcnt lgkmcnt(12)
    v_mfma_f32_16x16x32_bf16 v[96:99], v[40:43], v[64:67], 0
    v_mfma_f32_16x16x32_bf16 v[96:99], v[44:47], v[68:71], v[96:99]
    v_mfma_f32_16x16x32_bf16 v[96:99], v[168:171], v[64:67], v[96:99]
    v_add_u32 v164, 2492, v157
    ds_read2_b32 v[40:41], v164 offset0:0 offset1:1
    ds_read2_b32 v[42:43], v164 offset0:2 offset1:3
    ds_read2_b32 v[44:45], v164 offset0:16 offset1:17
    ds_read2_b32 v[46:47], v164 offset0:18 offset1:19
    ds_read_b128 v[64:67], v160 offset:4480
    ds_read_b128 v[68:71], v161 offset:4480
    s_waitcnt lgkmcnt(12)
    v_mfma_f32_16x16x32_bf16 v[100:103], v[48:51], v[72:75], 0
    v_mfma_f32_16x16x32_bf16 v[100:103], v[52:55], v[76:79], v[100:103]
    v_mfma_f32_16x16x32_bf16 v[100:103], v[168:171], v[72:75], v[100:103]
    v_cvt_pk_bf16_f32 v112, v80, v84
    v_cvt_pk_bf16_f32 v113, v88, v92
    v_cvt_pk_bf16_f32 v114, v81, v85
    v_cvt_pk_bf16_f32 v115, v89, v93
    v_cvt_pk_bf16_f32 v116, v82, v86
    v_cvt_pk_bf16_f32 v117, v90, v94
    v_cvt_pk_bf16_f32 v118, v83, v87
    v_cvt_pk_bf16_f32 v119, v91, v95
    s_mov_b32 exec_lo, 1073692671
    s_mov_b32 exec_hi, 1073692671
    ds_write_b64 v162, v[112:113] offset:0
    ds_write_b64 v162, v[114:115] offset:128
    ds_write_b64 v162, v[116:117] offset:256
    ds_write_b64 v162, v[118:119] offset:384
    s_mov_b64 exec, -1
    s_waitcnt lgkmcnt(6)
    v_mfma_f32_16x16x32_bf16 v[104:107], v[32:35], v[56:59], 0
    v_mfma_f32_16x16x32_bf16 v[104:107], v[36:39], v[60:63], v[104:107]
    v_mfma_f32_16x16x32_bf16 v[104:107], v[168:171], v[56:59], v[104:107]
    s_waitcnt lgkmcnt(0)
    v_mfma_f32_16x16x32_bf16 v[108:111], v[40:43], v[64:67], 0
    v_mfma_f32_16x16x32_bf16 v[108:111], v[44:47], v[68:71], v[108:111]
    v_mfma_f32_16x16x32_bf16 v[108:111], v[168:171], v[64:67], v[108:111]
    s_nop 7
    s_nop 1
    v_cvt_pk_bf16_f32 v112, v96, v100
    v_cvt_pk_bf16_f32 v113, v104, v108
    v_cvt_pk_bf16_f32 v114, v97, v101
    v_cvt_pk_bf16_f32 v115, v105, v109
    v_cvt_pk_bf16_f32 v116, v98, v102
    v_cvt_pk_bf16_f32 v117, v106, v110
    v_cvt_pk_bf16_f32 v118, v99, v103
    v_cvt_pk_bf16_f32 v119, v107, v111
    s_mov_b32 exec_lo, 1073692671
    s_mov_b32 exec_hi, 1073692671
    ds_write_b64 v162, v[112:113] offset:8
    ds_write_b64 v162, v[114:115] offset:136
    ds_write_b64 v162, v[116:117] offset:264
    ds_write_b64 v162, v[118:119] offset:392
    s_mov_b64 exec, -1
    s_waitcnt lgkmcnt(0)
    s_barrier
    ds_read_b128 v[188:191], v172
    ds_read_b128 v[192:195], v173
    ds_read_b128 v[196:199], v174
    ds_read_b128 v[200:203], v175
    s_waitcnt lgkmcnt(3)
    buffer_store_dwordx4 v[188:191], v176, s[48:51], 0 offen sc1
    s_waitcnt lgkmcnt(2)
    buffer_store_dwordx4 v[192:195], v177, s[48:51], 0 offen sc1
    s_waitcnt lgkmcnt(1)
    buffer_store_dwordx4 v[196:199], v178, s[48:51], 0 offen sc1
    s_waitcnt lgkmcnt(0)
    buffer_store_dwordx4 v[200:203], v179, s[48:51], 0 offen sc1
    s_endpgm
k3L_loader:
    v_and_b32 v1, 63, v0
    v_and_b32 v12, 255, v0
    s_sub_u32 s57, s26, 16
    s_mul_i32 s99, s25, 64
    s_mul_i32 s52, s25, 8192
    s_add_u32 s99, s99, s57
    v_lshrrev_b32 v4, 3, v1
    v_lshrrev_b32 v5, 4, v1
    v_and_b32 v6, 7, v1
    v_xor_b32 v5, v5, v6
    v_add_u32 v4, s99, v4
    v_lshlrev_b32 v4, 10, v4
    v_lshl_add_u32 v13, v5, 4, v4
    v_xor_b32 v5, 4, v5
    v_lshl_add_u32 v6, v5, 4, v4
    v_add_u32 v14, 7168, v6
    v_add_u32 v15, 14336, v13
    v_add_u32 v16, 21504, v6
    v_add_u32 v17, 32768, v13
    v_add_u32 v18, 39936, v6
    v_add_u32 v19, 47104, v13
    v_add_u32 v20, 54272, v6
    s_mul_i32 s54, s25, 2048
    s_mul_i32 s99, s25, 16384
    s_add_u32 s99, s99, s27
    v_lshrrev_b32 v5, 3, v1
    v_and_b32 v4, 7, v1
    v_bfe_u32 v6, v5, 1, 1
    v_lshlrev_b32 v6, 2, v6
    v_xor_b32 v4, v4, v6
    v_mul_u32_u24 v5, 1024, v5
    v_lshl_add_u32 v21, v4, 4, v5
    v_add_u32 v21, s99, v21
    v_add_u32 v22, 7168, v21
    s_mov_b32 s56, s24
    s_lshl_b32 s53, s56, 7
    s_lshl_b32 s55, s56, 16
    s_waitcnt lgkmcnt(0)
    s_mul_i32 s38, s21, 1024000
    s_add_u32 s8, s30, s38
    s_addc_u32 s9, s31, 0
    s_add_u32 s8, s8, 19922944
    s_addc_u32 s9, s9, 0
    s_mov_b32 s10, 1024000
    s_mov_b32 s11, 0x20000
    s_mov_b32 s12, s4
    s_mov_b32 s13, s5
    s_mov_b32 s14, 524288
    s_mov_b32 s15, 0x20000
    s_add_u32 m0, s52, 0
    s_nop 0
    buffer_load_dwordx4 v13, s[8:11], s53 offen offset:0  lds
    buffer_load_dwordx4 v14, s[8:11], s53 offen offset:1024  lds
    buffer_load_dwordx4 v15, s[8:11], s53 offen offset:2048  lds
    buffer_load_dwordx4 v16, s[8:11], s53 offen offset:3072  lds
    s_add_u32 m0, s52, 4096
    s_nop 0
    buffer_load_dwordx4 v17, s[8:11], s53 offen offset:0  lds
    buffer_load_dwordx4 v18, s[8:11], s53 offen offset:1024  lds
    buffer_load_dwordx4 v19, s[8:11], s53 offen offset:2048  lds
    buffer_load_dwordx4 v20, s[8:11], s53 offen offset:3072  lds
    s_add_u32 m0, s54, 32768
    s_nop 0
    buffer_load_dwordx4 v21, s[12:15], s55 offen offset:0  lds
    buffer_load_dwordx4 v22, s[12:15], s55 offen offset:1024  lds
    s_add_u32 s56, s56, 1
    s_and_b32 s56, s56, 7
    s_lshl_b32 s53, s56, 7
    s_lshl_b32 s55, s56, 16
    s_add_u32 m0, s52, 40960
    s_nop 0
    buffer_load_dwordx4 v13, s[8:11], s53 offen offset:0  lds
    buffer_load_dwordx4 v14, s[8:11], s53 offen offset:1024  lds
    buffer_load_dwordx4 v15, s[8:11], s53 offen offset:2048  lds
    buffer_load_dwordx4 v16, s[8:11], s53 offen offset:3072  lds
    s_add_u32 m0, s52, 45056
    s_nop 0
    buffer_load_dwordx4 v17, s[8:11], s53 offen offset:0  lds
    buffer_load_dwordx4 v18, s[8:11], s53 offen offset:1024  lds
    buffer_load_dwordx4 v19, s[8:11], s53 offen offset:2048  lds
    buffer_load_dwordx4 v20, s[8:11], s53 offen offset:3072  lds
    s_add_u32 m0, s54, 73728
    s_nop 0
    buffer_load_dwordx4 v21, s[12:15], s55 offen offset:0  lds
    buffer_load_dwordx4 v22, s[12:15], s55 offen offset:1024  lds
    s_add_u32 s56, s56, 1
    s_and_b32 s56, s56, 7
    s_lshl_b32 s53, s56, 7
    s_lshl_b32 s55, s56, 16
    s_waitcnt vmcnt(10)
    s_barrier
    s_add_u32 m0, s52, 81920
    s_nop 0
    buffer_load_dwordx4 v13, s[8:11], s53 offen offset:0  lds
    buffer_load_dwordx4 v14, s[8:11], s53 offen offset:1024  lds
    buffer_load_dwordx4 v15, s[8:11], s53 offen offset:2048  lds
    buffer_load_dwordx4 v16, s[8:11], s53 offen offset:3072  lds
    s_add_u32 m0, s52, 86016
    s_nop 0
    buffer_load_dwordx4 v17, s[8:11], s53 offen offset:0  lds
    buffer_load_dwordx4 v18, s[8:11], s53 offen offset:1024  lds
    buffer_load_dwordx4 v19, s[8:11], s53 offen offset:2048  lds
    buffer_load_dwordx4 v20, s[8:11], s53 offen offset:3072  lds
    s_add_u32 m0, s54, 114688
    s_nop 0
    buffer_load_dwordx4 v21, s[12:15], s55 offen offset:0  lds
    buffer_load_dwordx4 v22, s[12:15], s55 offen offset:1024  lds
    s_add_u32 s56, s56, 1
    s_and_b32 s56, s56, 7
    s_lshl_b32 s53, s56, 7
    s_lshl_b32 s55, s56, 16
    s_mul_i32 s38, s21, 2048000
    s_add_u32 s48, s30, s38
    s_addc_u32 s49, s31, 0
    s_add_u32 s48, s48, 22020096
    s_addc_u32 s49, s49, 0
    s_mov_b32 s50, 2048000
    s_mov_b32 s51, 0x20000
    s_lshl_b32 s58, s26, 11
    s_waitcnt vmcnt(10)
    s_barrier
    s_add_u32 m0, s52, 0
    s_nop 0
    buffer_load_dwordx4 v13, s[8:11], s53 offen offset:0  lds
    buffer_load_dwordx4 v14, s[8:11], s53 offen offset:1024  lds
    buffer_load_dwordx4 v15, s[8:11], s53 offen offset:2048  lds
    buffer_load_dwordx4 v16, s[8:11], s53 offen offset:3072  lds
    s_add_u32 m0, s52, 4096
    s_nop 0
    buffer_load_dwordx4 v17, s[8:11], s53 offen offset:0  lds
    buffer_load_dwordx4 v18, s[8:11], s53 offen offset:1024  lds
    buffer_load_dwordx4 v19, s[8:11], s53 offen offset:2048  lds
    buffer_load_dwordx4 v20, s[8:11], s53 offen offset:3072  lds
    s_add_u32 m0, s54, 32768
    s_nop 0
    buffer_load_dwordx4 v21, s[12:15], s55 offen offset:0  lds
    buffer_load_dwordx4 v22, s[12:15], s55 offen offset:1024  lds
    s_add_u32 s56, s56, 1
    s_and_b32 s56, s56, 7
    s_lshl_b32 s53, s56, 7
    s_lshl_b32 s55, s56, 16
    s_waitcnt vmcnt(10)
    s_barrier
    s_add_u32 m0, s52, 40960
    s_nop 0
    buffer_load_dwordx4 v13, s[8:11], s53 offen offset:0  lds
    buffer_load_dwordx4 v14, s[8:11], s53 offen offset:1024  lds
    buffer_load_dwordx4 v15, s[8:11], s53 offen offset:2048  lds
    buffer_load_dwordx4 v16, s[8:11], s53 offen offset:3072  lds
    s_add_u32 m0, s52, 45056
    s_nop 0
    buffer_load_dwordx4 v17, s[8:11], s53 offen offset:0  lds
    buffer_load_dwordx4 v18, s[8:11], s53 offen offset:1024  lds
    buffer_load_dwordx4 v19, s[8:11], s53 offen offset:2048  lds
    buffer_load_dwordx4 v20, s[8:11], s53 offen offset:3072  lds
    s_add_u32 m0, s54, 73728
    s_nop 0
    buffer_load_dwordx4 v21, s[12:15], s55 offen offset:0  lds
    buffer_load_dwordx4 v22, s[12:15], s55 offen offset:1024  lds
    s_add_u32 s56, s56, 1
    s_and_b32 s56, s56, 7
    s_lshl_b32 s53, s56, 7
    s_lshl_b32 s55, s56, 16
    s_waitcnt vmcnt(10)
    s_barrier
    s_add_u32 m0, s52, 81920
    s_nop 0
    buffer_load_dwordx4 v13, s[8:11], s53 offen offset:0  lds
    buffer_load_dwordx4 v14, s[8:11], s53 offen offset:1024  lds
    buffer_load_dwordx4 v15, s[8:11], s53 offen offset:2048  lds
    buffer_load_dwordx4 v16, s[8:11], s53 offen offset:3072  lds
    s_add_u32 m0, s52, 86016
    s_nop 0
    buffer_load_dwordx4 v17, s[8:11], s53 offen offset:0  lds
    buffer_load_dwordx4 v18, s[8:11], s53 offen offset:1024  lds
    buffer_load_dwordx4 v19, s[8:11], s53 offen offset:2048  lds
    buffer_load_dwordx4 v20, s[8:11], s53 offen offset:3072  lds
    s_add_u32 m0, s54, 114688
    s_nop 0
    buffer_load_dwordx4 v21, s[12:15], s55 offen offset:0  lds
    buffer_load_dwordx4 v22, s[12:15], s55 offen offset:1024  lds
    s_add_u32 s56, s56, 1
    s_and_b32 s56, s56, 7
    s_lshl_b32 s53, s56, 7
    s_lshl_b32 s55, s56, 16
    s_waitcnt vmcnt(10)
    s_barrier
    s_add_u32 m0, s52, 0
    s_nop 0
    buffer_load_dwordx4 v13, s[8:11], s53 offen offset:0  lds
    buffer_load_dwordx4 v14, s[8:11], s53 offen offset:1024  lds
    buffer_load_dwordx4 v15, s[8:11], s53 offen offset:2048  lds
    buffer_load_dwordx4 v16, s[8:11], s53 offen offset:3072  lds
    s_add_u32 m0, s52, 4096
    s_nop 0
    buffer_load_dwordx4 v17, s[8:11], s53 offen offset:0  lds
    buffer_load_dwordx4 v18, s[8:11], s53 offen offset:1024  lds
    buffer_load_dwordx4 v19, s[8:11], s53 offen offset:2048  lds
    buffer_load_dwordx4 v20, s[8:11], s53 offen offset:3072  lds
    s_add_u32 m0, s54, 32768
    s_nop 0
    buffer_load_dwordx4 v21, s[12:15], s55 offen offset:0  lds
    buffer_load_dwordx4 v22, s[12:15], s55 offen offset:1024  lds
    s_add_u32 s56, s56, 1
    s_and_b32 s56, s56, 7
    s_lshl_b32 s53, s56, 7
    s_lshl_b32 s55, s56, 16
    s_cmp_lt_u32 s33, 16
    s_cbranch_scc0 .Lpf6_skip
    s_cmp_eq_u32 s25, 0
    s_cbranch_scc0 .Lpf6_skip
    s_getpc_b64 s[96:97]
.Lpf6_pc:
    s_add_u32 s96, s96, (k3_kernel - .Lpf6_pc) & 0xffffffff
    s_addc_u32 s97, s97, ((k3_kernel - .Lpf6_pc) >> 32) & 0xffffffff
    v_and_b32 v254, 63, v0
    s_lshl_b32 s98, s33, 6
    v_add_u32 v254, s98, v254
    v_lshlrev_b32 v254, 7, v254
    v_min_u32 v254, (k4_exit - k3_kernel - 4), v254
    global_load_dword v255, v254, s[96:97]
.Lpf6_skip:
    s_waitcnt vmcnt(10)
    s_barrier
    s_add_u32 m0, s52, 40960
    s_nop 0
    buffer_load_dwordx4 v13, s[8:11], s53 offen offset:0  lds
    buffer_load_dwordx4 v14, s[8:11], s53 offen offset:1024  lds
    buffer_load_dwordx4 v15, s[8:11], s53 offen offset:2048  lds
    buffer_load_dwordx4 v16, s[8:11], s53 offen offset:3072  lds
    s_add_u32 m0, s52, 45056
    s_nop 0
    buffer_load_dwordx4 v17, s[8:11], s53 offen offset:0  lds
    buffer_load_dwordx4 v18, s[8:11], s53 offen offset:1024  lds
    buffer_load_dwordx4 v19, s[8:11], s53 offen offset:2048  lds
    buffer_load_dwordx4 v20, s[8:11], s53 offen offset:3072  lds
    s_add_u32 m0, s54, 73728
    s_nop 0
    buffer_load_dwordx4 v21, s[12:15], s55 offen offset:0  lds
    buffer_load_dwordx4 v22, s[12:15], s55 offen offset:1024  lds
    s_add_u32 s56, s56, 1
    s_and_b32 s56, s56, 7
    s_lshl_b32 s53, s56, 7
    s_lshl_b32 s55, s56, 16
    s_waitcnt vmcnt(10)
    s_barrier
    v_and_b32 v4, 15, v1
    v_lshrrev_b32 v5, 4, v1
    v_lshlrev_b32 v6, 3, v5
    v_sub_u32 v6, v6, v4
    v_add_u32 v6, 15, v6
    v_and_b32 v128, 1, v6
    v_mul_u32_u24 v128, 176, v128
    v_lshrrev_b32 v6, 1, v6
    v_lshl_add_u32 v128, v6, 2, v128
    s_mul_i32 s99, s20, 2848
    s_add_u32 s99, s99, 122880
    v_add_u32 v128, s99, v128
    v_lshl_add_u32 v6, v4, 1, v5
    v_lshlrev_b32 v6, 4, v6
    s_mul_i32 s99, s20, 5120
    s_add_u32 s99, s99, 0
    v_add_u32 v129, s99, v6
    v_add_u32 v130, 64, v129
    s_and_b32 s99, s20, 1
    s_lshl_b32 s99, s99, 6
    v_xor_b32 v129, s99, v129
    s_and_b32 s99, s20, 1
    s_lshl_b32 s99, s99, 6
    v_xor_b32 v130, s99, v130
    v_lshlrev_b32 v6, 2, v5
    v_lshl_add_u32 v6, v4, 4, v6
    v_lshlrev_b32 v6, 7, v6
    v_add_u32 v6, 40960, v6
    v_and_b32 v4, 7, v4
    s_mul_i32 s99, s20, 1
    s_add_u32 s99, s99, 0
    v_xor_b32 v5, s99, v4
    v_lshl_add_u32 v133, v5, 4, v6
    v_and_b32 v4, 15, v1
    v_lshrrev_b32 v5, 4, v1
    v_lshlrev_b32 v5, 3, v5
    v_sub_u32 v4, v4, v5
    v_add_u32 v4, 16, v4
    v_mov_b32 v136, 0
    v_mov_b32 v5, 0x3f80
    v_mov_b32 v6, 0x3f800000
    v_cmp_eq_u32 vcc, 0, v4
    s_nop 1
    v_cndmask_b32 v136, v136, v5, vcc
    v_cmp_eq_u32 vcc, 1, v4
    s_nop 1
    v_cndmask_b32 v136, v136, v6, vcc
    v_mov_b32 v137, 0
    v_mov_b32 v5, 0x3f80
    v_mov_b32 v6, 0x3f800000
    v_cmp_eq_u32 vcc, 2, v4
    s_nop 1
    v_cndmask_b32 v137, v137, v5, vcc
    v_cmp_eq_u32 vcc, 3, v4
    s_nop 1
    v_cndmask_b32 v137, v137, v6, vcc
    v_mov_b32 v138, 0
    v_mov_b32 v5, 0x3f80
    v_mov_b32 v6, 0x3f800000
    v_cmp_eq_u32 vcc, 4, v4
    s_nop 1
    v_cndmask_b32 v138, v138, v5, vcc
    v_cmp_eq_u32 vcc, 5, v4
    s_nop 1
    v_cndmask_b32 v138, v138, v6, vcc
    v_mov_b32 v139, 0
    v_mov_b32 v5, 0x3f80
    v_mov_b32 v6, 0x3f800000
    v_cmp_eq_u32 vcc, 6, v4
    s_nop 1
    v_cndmask_b32 v139, v139, v5, vcc
    v_cmp_eq_u32 vcc, 7, v4
    s_nop 1
    v_cndmask_b32 v139, v139, v6, vcc
    v_lshrrev_b32 v4, 3, v0
    v_and_b32 v5, 7, v0
    v_lshrrev_b32 v6, 4, v4
    v_add_u32 v7, s26, v4
    v_lshlrev_b32 v7, 11, v7
    v_lshl_add_u32 v7, v5, 4, v7
    v_add_u32 v144, s28, v7
    v_add_u32 v145, 131072, v144
    v_add_u32 v146, 262144, v144
    v_add_u32 v147, 393216, v144
    v_mov_b32 v7, 0x80000000
    v_cmp_gt_u32 vcc, 32, v4
    s_nop 1
    v_cndmask_b32 v147, v7, v147, vcc
    v_add_u32 v7, 0, v6
    v_and_b32 v7, 7, v7
    v_xor_b32 v7, v7, v5
    v_lshlrev_b32 v7, 4, v7
    v_lshl_add_u32 v7, v4, 7, v7
    v_add_u32 v140, 40960, v7
    v_add_u32 v7, 4, v6
    v_and_b32 v7, 7, v7
    v_xor_b32 v7, v7, v5
    v_lshlrev_b32 v7, 4, v7
    v_lshl_add_u32 v7, v4, 7, v7
    v_add_u32 v141, 49152, v7
    v_add_u32 v7, 8, v6
    v_and_b32 v7, 7, v7
    v_xor_b32 v7, v7, v5
    v_lshlrev_b32 v7, 4, v7
    v_lshl_add_u32 v7, v4, 7, v7
    v_add_u32 v142, 57344, v7
    v_add_u32 v7, 12, v6
    v_and_b32 v7, 7, v7
    v_xor_b32 v7, v7, v5
    v_lshlrev_b32 v7, 4, v7
    v_lshl_add_u32 v7, v4, 7, v7
    v_add_u32 v143, 65536, v7
    s_waitcnt vmcnt(0)
    s_barrier
    s_lshl_b32 s98, s33, 2
    s_add_u32 s98, s98, s25
    s_lshl_b32 s98, s98, 13
    v_and_b32 v4, 63, v0
    v_lshlrev_b32 v4, 7, v4
    v_add_u32 v4, s98, v4
    s_load_dwordx2 s[76:77], s[0:1], 56
    s_mov_b32 s78, 1048576
    s_mov_b32 s79, 0x20000
    s_waitcnt lgkmcnt(0)
    buffer_load_dword v252, v4, s[76:79], 0 offen
    s_barrier
    s_barrier
    v_add_u32 v135, 0, v128
    ds_read2_b32 v[24:25], v135 offset0:0 offset1:1
    ds_read2_b32 v[26:27], v135 offset0:2 offset1:3
    ds_read2_b32 v[28:29], v135 offset0:16 offset1:17
    ds_read2_b32 v[30:31], v135 offset0:18 offset1:19
    v_xor_b32 v131, 0, v129
    v_xor_b32 v132, 0, v130
    ds_read_b128 v[56:59], v131 offset:0
    ds_read_b128 v[60:63], v132 offset:0
    v_add_u32 v135, 356, v128
    ds_read2_b32 v[32:33], v135 offset0:0 offset1:1
    ds_read2_b32 v[34:35], v135 offset0:2 offset1:3
    ds_read2_b32 v[36:37], v135 offset0:16 offset1:17
    ds_read2_b32 v[38:39], v135 offset0:18 offset1:19
    ds_read_b128 v[64:67], v131 offset:640
    ds_read_b128 v[68:71], v132 offset:640
    v_add_u32 v135, 712, v128
    ds_read2_b32 v[40:41], v135 offset0:0 offset1:1
    ds_read2_b32 v[42:43], v135 offset0:2 offset1:3
    ds_read2_b32 v[44:45], v135 offset0:16 offset1:17
    ds_read2_b32 v[46:47], v135 offset0:18 offset1:19
    v_xor_b32 v131, 16, v129
    v_xor_b32 v132, 16, v130
    ds_read_b128 v[72:75], v131 offset:1280
    ds_read_b128 v[76:79], v132 offset:1280
    v_add_u32 v135, 1068, v128
    ds_read2_b32 v[48:49], v135 offset0:0 offset1:1
    ds_read2_b32 v[50:51], v135 offset0:2 offset1:3
    ds_read2_b32 v[52:53], v135 offset0:16 offset1:17
    ds_read2_b32 v[54:55], v135 offset0:18 offset1:19
    ds_read_b128 v[80:83], v131 offset:1920
    ds_read_b128 v[84:87], v132 offset:1920
    s_waitcnt lgkmcnt(15)
    v_mfma_f32_16x16x32_bf16 v[88:91], v[24:27], v[56:59], 0
    v_mfma_f32_16x16x32_bf16 v[88:91], v[28:31], v[60:63], v[88:91]
    v_mfma_f32_16x16x32_bf16 v[88:91], v[136:139], v[56:59], v[88:91]
    v_add_u32 v135, 1424, v128
    ds_read2_b32 v[24:25], v135 offset0:0 offset1:1
    ds_read2_b32 v[26:27], v135 offset0:2 offset1:3
    ds_read2_b32 v[28:29], v135 offset0:16 offset1:17
    ds_read2_b32 v[30:31], v135 offset0:18 offset1:19
    v_xor_b32 v131, 32, v129
    v_xor_b32 v132, 32, v130
    ds_read_b128 v[56:59], v131 offset:2560
    ds_read_b128 v[60:63], v132 offset:2560
    s_waitcnt lgkmcnt(15)
    v_mfma_f32_16x16x32_bf16 v[92:95], v[32:35], v[64:67], 0
    v_mfma_f32_16x16x32_bf16 v[92:95], v[36:39], v[68:71], v[92:95]
    v_mfma_f32_16x16x32_bf16 v[92:95], v[136:139], v[64:67], v[92:95]
    v_add_u32 v135, 1780, v128
    ds_read2_b32 v[32:33], v135 offset0:0 offset1:1
    ds_read2_b32 v[34:35], v135 offset0:2 offset1:3
    ds_read2_b32 v[36:37], v135 offset0:16 offset1:17
    ds_read2_b32 v[38:39], v135 offset0:18 offset1:19
    ds_read_b128 v[64:67], v131 offset:3200
    ds_read_b128 v[68:71], v132 offset:3200
    s_waitcnt lgkmcnt(15)
    v_mfma_f32_16x16x32_bf16 v[96:99], v[40:43], v[72:75], 0
    v_mfma_f32_16x16x32_bf16 v[96:99], v[44:47], v[76:79], v[96:99]
    v_mfma_f32_16x16x32_bf16 v[96:99], v[136:139], v[72:75], v[96:99]
    v_add_u32 v135, 2136, v128
    ds_read2_b32 v[40:41], v135 offset0:0 offset1:1
    ds_read2_b32 v[42:43], v135 offset0:2 offset1:3
    ds_read2_b32 v[44:45], v135 offset0:16 offset1:17
    ds_read2_b32 v[46:47], v135 offset0:18 offset1:19
    v_xor_b32 v131, 48, v129
    v_xor_b32 v132, 48, v130
    ds_read_b128 v[72:75], v131 offset:3840
    ds_read_b128 v[76:79], v132 offset:3840
    s_waitcnt lgkmcnt(15)
    v_mfma_f32_16x16x32_bf16 v[100:103], v[48:51], v[80:83], 0
    v_mfma_f32_16x16x32_bf16 v[100:103], v[52:55], v[84:87], v[100:103]
    v_mfma_f32_16x16x32_bf16 v[100:103], v[136:139], v[80:83], v[100:103]
    v_add_u32 v135, 2492, v128
    ds_read2_b32 v[48:49], v135 offset0:0 offset1:1
    ds_read2_b32 v[50:51], v135 offset0:2 offset1:3
    ds_read2_b32 v[52:53], v135 offset0:16 offset1:17
    ds_read2_b32 v[54:55], v135 offset0:18 offset1:19
    ds_read_b128 v[80:83], v131 offset:4480
    ds_read_b128 v[84:87], v132 offset:4480
    s_waitcnt lgkmcnt(15)
    v_mfma_f32_16x16x32_bf16 v[104:107], v[24:27], v[56:59], 0
    v_mfma_f32_16x16x32_bf16 v[104:107], v[28:31], v[60:63], v[104:107]
    v_mfma_f32_16x16x32_bf16 v[104:107], v[136:139], v[56:59], v[104:107]
    s_waitcnt lgkmcnt(12)
    v_mfma_f32_16x16x32_bf16 v[108:111], v[32:35], v[64:67], 0
    v_mfma_f32_16x16x32_bf16 v[108:111], v[36:39], v[68:71], v[108:111]
    v_mfma_f32_16x16x32_bf16 v[108:111], v[136:139], v[64:67], v[108:111]
    v_cvt_pk_bf16_f32 v120, v88, v92
    v_cvt_pk_bf16_f32 v121, v96, v100
    v_cvt_pk_bf16_f32 v122, v89, v93
    v_cvt_pk_bf16_f32 v123, v97, v101
    v_cvt_pk_bf16_f32 v124, v90, v94
    v_cvt_pk_bf16_f32 v125, v98, v102
    v_cvt_pk_bf16_f32 v126, v91, v95
    v_cvt_pk_bf16_f32 v127, v99, v103
    s_mov_b32 exec_lo, 1073692671
    s_mov_b32 exec_hi, 1073692671
    ds_write_b64 v133, v[120:121] offset:0
    ds_write_b64 v133, v[122:123] offset:128
    ds_write_b64 v133, v[124:125] offset:256
    ds_write_b64 v133, v[126:127] offset:384
    s_mov_b64 exec, -1
    s_waitcnt lgkmcnt(6)
    v_mfma_f32_16x16x32_bf16 v[112:115], v[40:43], v[72:75], 0
    v_mfma_f32_16x16x32_bf16 v[112:115], v[44:47], v[76:79], v[112:115]
    v_mfma_f32_16x16x32_bf16 v[112:115], v[136:139], v[72:75], v[112:115]
    s_waitcnt lgkmcnt(0)
    v_mfma_f32_16x16x32_bf16 v[116:119], v[48:51], v[80:83], 0
    v_mfma_f32_16x16x32_bf16 v[116:119], v[52:55], v[84:87], v[116:119]
    v_mfma_f32_16x16x32_bf16 v[116:119], v[136:139], v[80:83], v[116:119]
    s_nop 7
    s_nop 1
    v_cvt_pk_bf16_f32 v120, v104, v108
    v_cvt_pk_bf16_f32 v121, v112, v116
    v_cvt_pk_bf16_f32 v122, v105, v109
    v_cvt_pk_bf16_f32 v123, v113, v117
    v_cvt_pk_bf16_f32 v124, v106, v110
    v_cvt_pk_bf16_f32 v125, v114, v118
    v_cvt_pk_bf16_f32 v126, v107, v111
    v_cvt_pk_bf16_f32 v127, v115, v119
    s_mov_b32 exec_lo, 1073692671
    s_mov_b32 exec_hi, 1073692671
    ds_write_b64 v133, v[120:121] offset:8
    ds_write_b64 v133, v[122:123] offset:136
    ds_write_b64 v133, v[124:125] offset:264
    ds_write_b64 v133, v[126:127] offset:392
    s_mov_b64 exec, -1
    s_waitcnt lgkmcnt(0)
    s_barrier
    ds_read_b128 v[148:151], v140
    ds_read_b128 v[152:155], v141
    ds_read_b128 v[156:159], v142
    ds_read_b128 v[160:163], v143
    s_waitcnt lgkmcnt(3)
    buffer_store_dwordx4 v[148:151], v144, s[48:51], 0 offen sc1
    s_waitcnt lgkmcnt(2)
    buffer_store_dwordx4 v[152:155], v145, s[48:51], 0 offen sc1
    s_waitcnt lgkmcnt(1)
    buffer_store_dwordx4 v[156:159], v146, s[48:51], 0 offen sc1
    s_waitcnt lgkmcnt(0)
    buffer_store_dwordx4 v[160:163], v147, s[48:51], 0 offen sc1
    s_endpgm
k3_exit:
    s_endpgm
.globl k4_kernel
.p2align 8
.type k4_kernel,@function
k4_kernel:
    s_cmp_ge_u32 s2, 256
    s_cbranch_scc1 k4_exit
k4_begin:
    s_load_dwordx2 s[30:31], s[0:1], 80
    s_load_dwordx4 s[40:43], s[0:1], 56
    s_load_dwordx2 s[4:5], s[0:1], 0
    v_lshrrev_b32 v1, 6, v0
    s_and_b32 s32, s2, 7
    s_lshr_b32 s33, s2, 3
    v_readfirstlane_b32 s20, v1
    s_lshr_b32 s34, s33, 3
    s_lshl_b32 s21, s32, 2
    s_add_u32 s21, s21, s34
    s_and_b32 s22, s33, 7
    s_lshl_b32 s24, s22, 1
    s_add_u32 s24, s24, s34
    s_and_b32 s24, s24, 15
    s_lshl_b32 s26, s21, 6
    s_lshl_b32 s27, s22, 7
    s_and_b32 s25, s20, 3
    s_cmp_ge_u32 s20, 4
    s_cbranch_scc1 k4_loader
    v_and_b32 v1, 63, v0
    s_and_b32 s56, s20, 1
    s_lshr_b32 s57, s20, 1
    v_and_b32 v4, 31, v1
    s_lshl_b32 s99, s57, 5
    v_add_u32 v96, s99, v4
    v_bfe_u32 v4, v96, 1, 3
    v_lshrrev_b32 v5, 5, v1
    v_xor_b32 v4, v4, v5
    v_lshlrev_b32 v4, 4, v4
    v_lshl_add_u32 v4, v96, 7, v4
    v_add_u32 v17, 8192, v4
    v_add_u32 v21, 24576, v4
    v_add_u32 v25, 40960, v4
    v_add_u32 v29, 57344, v4
    v_add_u32 v33, 73728, v4
    v_xor_b32 v5, 32, v4
    v_add_u32 v18, 8192, v5
    v_add_u32 v22, 24576, v5
    v_add_u32 v26, 40960, v5
    v_add_u32 v30, 57344, v5
    v_add_u32 v34, 73728, v5
    v_xor_b32 v5, 64, v4
    v_add_u32 v19, 8192, v5
    v_add_u32 v23, 24576, v5
    v_add_u32 v27, 40960, v5
    v_add_u32 v31, 57344, v5
    v_add_u32 v35, 73728, v5
    v_xor_b32 v5, 96, v4
    v_add_u32 v20, 8192, v5
    v_add_u32 v24, 24576, v5
    v_add_u32 v28, 40960, v5
    v_add_u32 v32, 57344, v5
    v_add_u32 v36, 73728, v5
    v_bfe_u32 v4, v1, 2, 2
    v_lshrrev_b32 v5, 5, v1
    v_lshl_add_u32 v4, v5, 3, v4
    v_bfe_u32 v5, v4, 1, 1
    v_mul_u32_u24 v4, 128, v4
    v_bfe_u32 v6, v1, 4, 1
    v_lshl_add_u32 v4, v6, 5, v4
    v_and_b32 v6, 3, v1
    v_lshl_add_u32 v4, v6, 3, v4
    s_add_u32 s99, s56, 0
    v_xor_b32 v7, s99, v5
    v_lshl_add_u32 v7, v7, 6, v4
    v_add_u32 v12, 0, v7
    v_add_u32 v13, 16384, v7
    v_add_u32 v14, 32768, v7
    v_add_u32 v15, 49152, v7
    v_add_u32 v16, 65536, v7
    v_add_u32 v4, s26, v96
    v_lshlrev_b32 v4, 10, v4
    v_lshrrev_b32 v5, 5, v1
    v_lshl_add_u32 v4, v5, 3, v4
    s_lshl_b32 s99, s56, 6
    s_add_u32 s99, s99, s27
    v_add_u32 v97, s99, v4
    v_mul_u32_u24 v98, 144, v96
    v_lshl_add_u32 v98, v5, 3, v98
    s_lshl_b32 s99, s56, 6
    v_add_u32 v98, s99, v98
    s_waitcnt lgkmcnt(0)
    s_mov_b32 s16, s4
    s_mov_b32 s17, s5
    s_mov_b32 s18, 2048000
    s_mov_b32 s19, 0x20000
    s_mov_b32 s44, s42
    s_mov_b32 s45, s43
    s_mov_b32 s46, 2048000
    s_mov_b32 s47, 0x20000
    buffer_load_dwordx2 v[88:89], v97, s[16:19], 0 offen offset:0
    buffer_load_dwordx2 v[90:91], v97, s[16:19], 0 offen offset:16
    buffer_load_dwordx2 v[92:93], v97, s[16:19], 0 offen offset:32
    buffer_load_dwordx2 v[94:95], v97, s[16:19], 0 offen offset:48
    s_barrier
    ds_read_b64_tr_b16 v[56:57], v12 offset:0
    ds_read_b64_tr_b16 v[58:59], v12 offset:512
    ds_read_b128 v[60:63], v17 offset:0
    ds_read_b64_tr_b16 v[64:65], v12 offset:2048
    ds_read_b64_tr_b16 v[66:67], v12 offset:2560
    ds_read_b128 v[68:71], v18 offset:0
    ds_read_b64_tr_b16 v[72:73], v12 offset:4096
    ds_read_b64_tr_b16 v[74:75], v12 offset:4608
    ds_read_b128 v[76:79], v19 offset:0
    s_waitcnt lgkmcnt(6)
    v_mfma_f32_32x32x16_bf16 v[40:55], v[56:59], v[60:63], 0
    ds_read_b64_tr_b16 v[80:81], v12 offset:6144
    ds_read_b64_tr_b16 v[82:83], v12 offset:6656
    ds_read_b128 v[84:87], v20 offset:0
    s_waitcnt lgkmcnt(6)
    v_mfma_f32_32x32x16_bf16 v[40:55], v[64:67], v[68:71], v[40:55]
    s_barrier
    ds_read_b64_tr_b16 v[56:57], v13 offset:0
    ds_read_b64_tr_b16 v[58:59], v13 offset:512
    ds_read_b128 v[60:63], v21 offset:0
    s_waitcnt lgkmcnt(6)
    v_mfma_f32_32x32x16_bf16 v[40:55], v[72:75], v[76:79], v[40:55]
    ds_read_b64_tr_b16 v[64:65], v13 offset:2048
    ds_read_b64_tr_b16 v[66:67], v13 offset:2560
    ds_read_b128 v[68:71], v22 offset:0
    s_waitcnt lgkmcnt(6)
    v_mfma_f32_32x32x16_bf16 v[40:55], v[80:83], v[84:87], v[40:55]
    ds_read_b64_tr_b16 v[72:73], v13 offset:4096
    ds_read_b64_tr_b16 v[74:75], v13 offset:4608
    ds_read_b128 v[76:79], v23 offset:0
    s_waitcnt lgkmcnt(6)
    v_mfma_f32_32x32x16_bf16 v[40:55], v[56:59], v[60:63], v[40:55]
    ds_read_b64_tr_b16 v[80:81], v13 offset:6144
    ds_read_b64_tr_b16 v[82:83], v13 offset:6656
    ds_read_b128 v[84:87], v24 offset:0
    s_waitcnt lgkmcnt(6)
    v_mfma_f32_32x32x16_bf16 v[40:55], v[64:67], v[68:71], v[40:55]
    s_barrier
    ds_read_b64_tr_b16 v[56:57], v14 offset:0
    ds_read_b64_tr_b16 v[58:59], v14 offset:512
    ds_read_b128 v[60:63], v25 offset:0
    s_waitcnt lgkmcnt(6)
    v_mfma_f32_32x32x16_bf16 v[40:55], v[72:75], v[76:79], v[40:55]
    ds_read_b64_tr_b16 v[64:65], v14 offset:2048
    ds_read_b64_tr_b16 v[66:67], v14 offset:2560
    ds_read_b128 v[68:71], v26 offset:0
    s_waitcnt lgkmcnt(6)
    v_mfma_f32_32x32x16_bf16 v[40:55], v[80:83], v[84:87], v[40:55]
    ds_read_b64_tr_b16 v[72:73], v14 offset:4096
    ds_read_b64_tr_b16 v[74:75], v14 offset:4608
    ds_read_b128 v[76:79], v27 offset:0
    s_waitcnt lgkmcnt(6)
    v_mfma_f32_32x32x16_bf16 v[40:55], v[56:59], v[60:63], v[40:55]
    ds_read_b64_tr_b16 v[80:81], v14 offset:6144
    ds_read_b64_tr_b16 v[82:83], v14 offset:6656
    ds_read_b128 v[84:87], v28 offset:0
    s_waitcnt lgkmcnt(6)
    v_mfma_f32_32x32x16_bf16 v[40:55], v[64:67], v[68:71], v[40:55]
    s_barrier
    ds_read_b64_tr_b16 v[56:57], v15 offset:0
    ds_read_b64_tr_b16 v[58:59], v15 offset:512
    ds_read_b128 v[60:63], v29 offset:0
    s_waitcnt lgkmcnt(6)
    v_mfma_f32_32x32x16_bf16 v[40:55], v[72:75], v[76:79], v[40:55]
    ds_read_b64_tr_b16 v[64:65], v15 offset:2048
    ds_read_b64_tr_b16 v[66:67], v15 offset:2560
    ds_read_b128 v[68:71], v30 offset:0
    s_waitcnt lgkmcnt(6)
    v_mfma_f32_32x32x16_bf16 v[40:55], v[80:83], v[84:87], v[40:55]
    ds_read_b64_tr_b16 v[72:73], v15 offset:4096
    ds_read_b64_tr_b16 v[74:75], v15 offset:4608
    ds_read_b128 v[76:79], v31 offset:0
    s_waitcnt lgkmcnt(6)
    v_mfma_f32_32x32x16_bf16 v[40:55], v[56:59], v[60:63], v[40:55]
    ds_read_b64_tr_b16 v[80:81], v15 offset:6144
    ds_read_b64_tr_b16 v[82:83], v15 offset:6656
    ds_read_b128 v[84:87], v32 offset:0
    s_waitcnt lgkmcnt(6)
    v_mfma_f32_32x32x16_bf16 v[40:55], v[64:67], v[68:71], v[40:55]
    s_barrier
    ds_read_b64_tr_b16 v[56:57], v16 offset:0
    ds_read_b64_tr_b16 v[58:59], v16 offset:512
    ds_read_b128 v[60:63], v33 offset:0
    s_waitcnt lgkmcnt(6)
    v_mfma_f32_32x32x16_bf16 v[40:55], v[72:75], v[76:79], v[40:55]
    ds_read_b64_tr_b16 v[64:65], v16 offset:2048
    ds_read_b64_tr_b16 v[66:67], v16 offset:2560
    ds_read_b128 v[68:71], v34 offset:0
    s_waitcnt lgkmcnt(6)
    v_mfma_f32_32x32x16_bf16 v[40:55], v[80:83], v[84:87], v[40:55]
    ds_read_b64_tr_b16 v[72:73], v16 offset:4096
    ds_read_b64_tr_b16 v[74:75], v16 offset:4608
    ds_read_b128 v[76:79], v35 offset:0
    s_waitcnt lgkmcnt(6)
    v_mfma_f32_32x32x16_bf16 v[40:55], v[56:59], v[60:63], v[40:55]
    ds_read_b64_tr_b16 v[80:81], v16 offset:6144
    ds_read_b64_tr_b16 v[82:83], v16 offset:6656
    ds_read_b128 v[84:87], v36 offset:0
    s_waitcnt lgkmcnt(6)
    v_mfma_f32_32x32x16_bf16 v[40:55], v[64:67], v[68:71], v[40:55]
    s_barrier
    ds_read_b64_tr_b16 v[56:57], v12 offset:0
    ds_read_b64_tr_b16 v[58:59], v12 offset:512
    ds_read_b128 v[60:63], v17 offset:0
    s_waitcnt lgkmcnt(6)
    v_mfma_f32_32x32x16_bf16 v[40:55], v[72:75], v[76:79], v[40:55]
    ds_read_b64_tr_b16 v[64:65], v12 offset:2048
    ds_read_b64_tr_b16 v[66:67], v12 offset:2560
    ds_read_b128 v[68:71], v18 offset:0
    s_waitcnt lgkmcnt(6)
    v_mfma_f32_32x32x16_bf16 v[40:55], v[80:83], v[84:87], v[40:55]
    ds_read_b64_tr_b16 v[72:73], v12 offset:4096
    ds_read_b64_tr_b16 v[74:75], v12 offset:4608
    ds_read_b128 v[76:79], v19 offset:0
    s_waitcnt lgkmcnt(6)
    v_mfma_f32_32x32x16_bf16 v[40:55], v[56:59], v[60:63], v[40:55]
    ds_read_b64_tr_b16 v[80:81], v12 offset:6144
    ds_read_b64_tr_b16 v[82:83], v12 offset:6656
    ds_read_b128 v[84:87], v20 offset:0
    s_waitcnt lgkmcnt(6)
    v_mfma_f32_32x32x16_bf16 v[40:55], v[64:67], v[68:71], v[40:55]
    s_barrier
    ds_read_b64_tr_b16 v[56:57], v13 offset:0
    ds_read_b64_tr_b16 v[58:59], v13 offset:512
    ds_read_b128 v[60:63], v21 offset:0
    s_waitcnt lgkmcnt(6)
    v_mfma_f32_32x32x16_bf16 v[40:55], v[72:75], v[76:79], v[40:55]
    ds_read_b64_tr_b16 v[64:65], v13 offset:2048
    ds_read_b64_tr_b16 v[66:67], v13 offset:2560
    ds_read_b128 v[68:71], v22 offset:0
    s_waitcnt lgkmcnt(6)
    v_mfma_f32_32x32x16_bf16 v[40:55], v[80:83], v[84:87], v[40:55]
    ds_read_b64_tr_b16 v[72:73], v13 offset:4096
    ds_read_b64_tr_b16 v[74:75], v13 offset:4608
    ds_read_b128 v[76:79], v23 offset:0
    s_waitcnt lgkmcnt(6)
    v_mfma_f32_32x32x16_bf16 v[40:55], v[56:59], v[60:63], v[40:55]
    ds_read_b64_tr_b16 v[80:81], v13 offset:6144
    ds_read_b64_tr_b16 v[82:83], v13 offset:6656
    ds_read_b128 v[84:87], v24 offset:0
    s_waitcnt lgkmcnt(6)
    v_mfma_f32_32x32x16_bf16 v[40:55], v[64:67], v[68:71], v[40:55]
    s_barrier
    ds_read_b64_tr_b16 v[56:57], v14 offset:0
    ds_read_b64_tr_b16 v[58:59], v14 offset:512
    ds_read_b128 v[60:63], v25 offset:0
    s_waitcnt lgkmcnt(6)
    v_mfma_f32_32x32x16_bf16 v[40:55], v[72:75], v[76:79], v[40:55]
    ds_read_b64_tr_b16 v[64:65], v14 offset:2048
    ds_read_b64_tr_b16 v[66:67], v14 offset:2560
    ds_read_b128 v[68:71], v26 offset:0
    s_waitcnt lgkmcnt(6)
    v_mfma_f32_32x32x16_bf16 v[40:55], v[80:83], v[84:87], v[40:55]
    ds_read_b64_tr_b16 v[72:73], v14 offset:4096
    ds_read_b64_tr_b16 v[74:75], v14 offset:4608
    ds_read_b128 v[76:79], v27 offset:0
    s_waitcnt lgkmcnt(6)
    v_mfma_f32_32x32x16_bf16 v[40:55], v[56:59], v[60:63], v[40:55]
    ds_read_b64_tr_b16 v[80:81], v14 offset:6144
    ds_read_b64_tr_b16 v[82:83], v14 offset:6656
    ds_read_b128 v[84:87], v28 offset:0
    s_waitcnt lgkmcnt(6)
    v_mfma_f32_32x32x16_bf16 v[40:55], v[64:67], v[68:71], v[40:55]
    s_barrier
    ds_read_b64_tr_b16 v[56:57], v15 offset:0
    ds_read_b64_tr_b16 v[58:59], v15 offset:512
    ds_read_b128 v[60:63], v29 offset:0
    s_waitcnt lgkmcnt(6)
    v_mfma_f32_32x32x16_bf16 v[40:55], v[72:75], v[76:79], v[40:55]
    ds_read_b64_tr_b16 v[64:65], v15 offset:2048
    ds_read_b64_tr_b16 v[66:67], v15 offset:2560
    ds_read_b128 v[68:71], v30 offset:0
    s_waitcnt lgkmcnt(6)
    v_mfma_f32_32x32x16_bf16 v[40:55], v[80:83], v[84:87], v[40:55]
    ds_read_b64_tr_b16 v[72:73], v15 offset:4096
    ds_read_b64_tr_b16 v[74:75], v15 offset:4608
    ds_read_b128 v[76:79], v31 offset:0
    s_waitcnt lgkmcnt(6)
    v_mfma_f32_32x32x16_bf16 v[40:55], v[56:59], v[60:63], v[40:55]
    ds_read_b64_tr_b16 v[80:81], v15 offset:6144
    ds_read_b64_tr_b16 v[82:83], v15 offset:6656
    ds_read_b128 v[84:87], v32 offset:0
    s_waitcnt lgkmcnt(6)
    v_mfma_f32_32x32x16_bf16 v[40:55], v[64:67], v[68:71], v[40:55]
    s_barrier
    ds_read_b64_tr_b16 v[56:57], v16 offset:0
    ds_read_b64_tr_b16 v[58:59], v16 offset:512
    ds_read_b128 v[60:63], v33 offset:0
    s_waitcnt lgkmcnt(6)
    v_mfma_f32_32x32x16_bf16 v[40:55], v[72:75], v[76:79], v[40:55]
    ds_read_b64_tr_b16 v[64:65], v16 offset:2048
    ds_read_b64_tr_b16 v[66:67], v16 offset:2560
    ds_read_b128 v[68:71], v34 offset:0
    s_waitcnt lgkmcnt(6)
    v_mfma_f32_32x32x16_bf16 v[40:55], v[80:83], v[84:87], v[40:55]
    ds_read_b64_tr_b16 v[72:73], v16 offset:4096
    ds_read_b64_tr_b16 v[74:75], v16 offset:4608
    ds_read_b128 v[76:79], v35 offset:0
    s_waitcnt lgkmcnt(6)
    v_mfma_f32_32x32x16_bf16 v[40:55], v[56:59], v[60:63], v[40:55]
    ds_read_b64_tr_b16 v[80:81], v16 offset:6144
    ds_read_b64_tr_b16 v[82:83], v16 offset:6656
    ds_read_b128 v[84:87], v36 offset:0
    s_waitcnt lgkmcnt(6)
    v_mfma_f32_32x32x16_bf16 v[40:55], v[64:67], v[68:71], v[40:55]
    s_barrier
    ds_read_b64_tr_b16 v[56:57], v12 offset:0
    ds_read_b64_tr_b16 v[58:59], v12 offset:512
    ds_read_b128 v[60:63], v17 offset:0
    s_waitcnt lgkmcnt(6)
    v_mfma_f32_32x32x16_bf16 v[40:55], v[72:75], v[76:79], v[40:55]
    ds_read_b64_tr_b16 v[64:65], v12 offset:2048
    ds_read_b64_tr_b16 v[66:67], v12 offset:2560
    ds_read_b128 v[68:71], v18 offset:0
    s_waitcnt lgkmcnt(6)
    v_mfma_f32_32x32x16_bf16 v[40:55], v[80:83], v[84:87], v[40:55]
    ds_read_b64_tr_b16 v[72:73], v12 offset:4096
    ds_read_b64_tr_b16 v[74:75], v12 offset:4608
    ds_read_b128 v[76:79], v19 offset:0
    s_waitcnt lgkmcnt(6)
    v_mfma_f32_32x32x16_bf16 v[40:55], v[56:59], v[60:63], v[40:55]
    ds_read_b64_tr_b16 v[80:81], v12 offset:6144
    ds_read_b64_tr_b16 v[82:83], v12 offset:6656
    ds_read_b128 v[84:87], v20 offset:0
    s_waitcnt lgkmcnt(6)
    v_mfma_f32_32x32x16_bf16 v[40:55], v[64:67], v[68:71], v[40:55]
    s_barrier
    ds_read_b64_tr_b16 v[56:57], v13 offset:0
    ds_read_b64_tr_b16 v[58:59], v13 offset:512
    ds_read_b128 v[60:63], v21 offset:0
    s_waitcnt lgkmcnt(6)
    v_mfma_f32_32x32x16_bf16 v[40:55], v[72:75], v[76:79], v[40:55]
    ds_read_b64_tr_b16 v[64:65], v13 offset:2048
    ds_read_b64_tr_b16 v[66:67], v13 offset:2560
    ds_read_b128 v[68:71], v22 offset:0
    s_waitcnt lgkmcnt(6)
    v_mfma_f32_32x32x16_bf16 v[40:55], v[80:83], v[84:87], v[40:55]
    ds_read_b64_tr_b16 v[72:73], v13 offset:4096
    ds_read_b64_tr_b16 v[74:75], v13 offset:4608
    ds_read_b128 v[76:79], v23 offset:0
    s_waitcnt lgkmcnt(6)
    v_mfma_f32_32x32x16_bf16 v[40:55], v[56:59], v[60:63], v[40:55]
    ds_read_b64_tr_b16 v[80:81], v13 offset:6144
    ds_read_b64_tr_b16 v[82:83], v13 offset:6656
    ds_read_b128 v[84:87], v24 offset:0
    s_waitcnt lgkmcnt(6)
    v_mfma_f32_32x32x16_bf16 v[40:55], v[64:67], v[68:71], v[40:55]
    s_barrier
    ds_read_b64_tr_b16 v[56:57], v14 offset:0
    ds_read_b64_tr_b16 v[58:59], v14 offset:512
    ds_read_b128 v[60:63], v25 offset:0
    s_waitcnt lgkmcnt(6)
    v_mfma_f32_32x32x16_bf16 v[40:55], v[72:75], v[76:79], v[40:55]
    ds_read_b64_tr_b16 v[64:65], v14 offset:2048
    ds_read_b64_tr_b16 v[66:67], v14 offset:2560
    ds_read_b128 v[68:71], v26 offset:0
    s_waitcnt lgkmcnt(6)
    v_mfma_f32_32x32x16_bf16 v[40:55], v[80:83], v[84:87], v[40:55]
    ds_read_b64_tr_b16 v[72:73], v14 offset:4096
    ds_read_b64_tr_b16 v[74:75], v14 offset:4608
    ds_read_b128 v[76:79], v27 offset:0
    s_waitcnt lgkmcnt(6)
    v_mfma_f32_32x32x16_bf16 v[40:55], v[56:59], v[60:63], v[40:55]
    ds_read_b64_tr_b16 v[80:81], v14 offset:6144
    ds_read_b64_tr_b16 v[82:83], v14 offset:6656
    ds_read_b128 v[84:87], v28 offset:0
    s_waitcnt lgkmcnt(6)
    v_mfma_f32_32x32x16_bf16 v[40:55], v[64:67], v[68:71], v[40:55]
    s_barrier
    ds_read_b64_tr_b16 v[56:57], v15 offset:0
    ds_read_b64_tr_b16 v[58:59], v15 offset:512
    ds_read_b128 v[60:63], v29 offset:0
    s_waitcnt lgkmcnt(6)
    v_mfma_f32_32x32x16_bf16 v[40:55], v[72:75], v[76:79], v[40:55]
    ds_read_b64_tr_b16 v[64:65], v15 offset:2048
    ds_read_b64_tr_b16 v[66:67], v15 offset:2560
    ds_read_b128 v[68:71], v30 offset:0
    s_waitcnt lgkmcnt(6)
    v_mfma_f32_32x32x16_bf16 v[40:55], v[80:83], v[84:87], v[40:55]
    ds_read_b64_tr_b16 v[72:73], v15 offset:4096
    ds_read_b64_tr_b16 v[74:75], v15 offset:4608
    ds_read_b128 v[76:79], v31 offset:0
    s_waitcnt lgkmcnt(6)
    v_mfma_f32_32x32x16_bf16 v[40:55], v[56:59], v[60:63], v[40:55]
    ds_read_b64_tr_b16 v[80:81], v15 offset:6144
    ds_read_b64_tr_b16 v[82:83], v15 offset:6656
    ds_read_b128 v[84:87], v32 offset:0
    s_waitcnt lgkmcnt(6)
    v_mfma_f32_32x32x16_bf16 v[40:55], v[64:67], v[68:71], v[40:55]
    s_barrier
    ds_read_b64_tr_b16 v[56:57], v16 offset:0
    ds_read_b64_tr_b16 v[58:59], v16 offset:512
    ds_read_b128 v[60:63], v33 offset:0
    s_waitcnt lgkmcnt(6)
    v_mfma_f32_32x32x16_bf16 v[40:55], v[72:75], v[76:79], v[40:55]
    ds_read_b64_tr_b16 v[64:65], v16 offset:2048
    ds_read_b64_tr_b16 v[66:67], v16 offset:2560
    ds_read_b128 v[68:71], v34 offset:0
    s_waitcnt lgkmcnt(6)
    v_mfma_f32_32x32x16_bf16 v[40:55], v[80:83], v[84:87], v[40:55]
    ds_read_b64_tr_b16 v[72:73], v16 offset:4096
    ds_read_b64_tr_b16 v[74:75], v16 offset:4608
    ds_read_b128 v[76:79], v35 offset:0
    s_waitcnt lgkmcnt(6)
    v_mfma_f32_32x32x16_bf16 v[40:55], v[56:59], v[60:63], v[40:55]
    ds_read_b64_tr_b16 v[80:81], v16 offset:6144
    ds_read_b64_tr_b16 v[82:83], v16 offset:6656
    ds_read_b128 v[84:87], v36 offset:0
    s_waitcnt lgkmcnt(6)
    v_mfma_f32_32x32x16_bf16 v[40:55], v[64:67], v[68:71], v[40:55]
    s_barrier
    ds_read_b64_tr_b16 v[56:57], v12 offset:0
    ds_read_b64_tr_b16 v[58:59], v12 offset:512
    ds_read_b128 v[60:63], v17 offset:0
    s_waitcnt lgkmcnt(6)
    v_mfma_f32_32x32x16_bf16 v[40:55], v[72:75], v[76:79], v[40:55]
    ds_read_b64_tr_b16 v[64:65], v12 offset:2048
    ds_read_b64_tr_b16 v[66:67], v12 offset:2560
    ds_read_b128 v[68:71], v18 offset:0
    s_waitcnt lgkmcnt(6)
    v_mfma_f32_32x32x16_bf16 v[40:55], v[80:83], v[84:87], v[40:55]
    ds_read_b64_tr_b16 v[72:73], v12 offset:4096
    ds_read_b64_tr_b16 v[74:75], v12 offset:4608
    ds_read_b128 v[76:79], v19 offset:0
    s_waitcnt lgkmcnt(6)
    v_mfma_f32_32x32x16_bf16 v[40:55], v[56:59], v[60:63], v[40:55]
    ds_read_b64_tr_b16 v[80:81], v12 offset:6144
    ds_read_b64_tr_b16 v[82:83], v12 offset:6656
    ds_read_b128 v[84:87], v20 offset:0
    s_waitcnt lgkmcnt(6)
    v_mfma_f32_32x32x16_bf16 v[40:55], v[64:67], v[68:71], v[40:55]
    s_waitcnt lgkmcnt(3)
    v_mfma_f32_32x32x16_bf16 v[40:55], v[72:75], v[76:79], v[40:55]
    s_waitcnt lgkmcnt(0)
    v_mfma_f32_32x32x16_bf16 v[40:55], v[80:83], v[84:87], v[40:55]
    s_waitcnt vmcnt(0)
    s_nop 7
    s_barrier
    v_lshlrev_b32 v108, 16, v88
    v_and_b32 v109, 0xffff0000, v88
    v_pk_add_f32 v[40:41], v[40:41], v[108:109]
    v_cvt_pk_bf16_f32 v100, v40, v41
    v_lshlrev_b32 v108, 16, v89
    v_and_b32 v109, 0xffff0000, v89
    v_pk_add_f32 v[42:43], v[42:43], v[108:109]
    v_cvt_pk_bf16_f32 v101, v42, v43
    ds_write_b64 v98, v[100:101] offset:0
    v_lshlrev_b32 v108, 16, v90
    v_and_b32 v109, 0xffff0000, v90
    v_pk_add_f32 v[44:45], v[44:45], v[108:109]
    v_cvt_pk_bf16_f32 v102, v44, v45
    v_lshlrev_b32 v108, 16, v91
    v_and_b32 v109, 0xffff0000, v91
    v_pk_add_f32 v[46:47], v[46:47], v[108:109]
    v_cvt_pk_bf16_f32 v103, v46, v47
    ds_write_b64 v98, v[102:103] offset:16
    v_lshlrev_b32 v108, 16, v92
    v_and_b32 v109, 0xffff0000, v92
    v_pk_add_f32 v[48:49], v[48:49], v[108:109]
    v_cvt_pk_bf16_f32 v104, v48, v49
    v_lshlrev_b32 v108, 16, v93
    v_and_b32 v109, 0xffff0000, v93
    v_pk_add_f32 v[50:51], v[50:51], v[108:109]
    v_cvt_pk_bf16_f32 v105, v50, v51
    ds_write_b64 v98, v[104:105] offset:32
    v_lshlrev_b32 v108, 16, v94
    v_and_b32 v109, 0xffff0000, v94
    v_pk_add_f32 v[52:53], v[52:53], v[108:109]
    v_cvt_pk_bf16_f32 v106, v52, v53
    v_lshlrev_b32 v108, 16, v95
    v_and_b32 v109, 0xffff0000, v95
    v_pk_add_f32 v[54:55], v[54:55], v[108:109]
    v_cvt_pk_bf16_f32 v107, v54, v55
    ds_write_b64 v98, v[106:107] offset:48
    s_waitcnt lgkmcnt(0)
    s_barrier
    s_lshl_b32 s59, s26, 10
    s_add_u32 s59, s59, s27
    v_lshrrev_b32 v5, 3, v1
    v_and_b32 v4, 7, v1
    s_mul_i32 s99, s20, 8
    v_add_u32 v114, s99, v5
    v_mul_u32_u24 v6, 144, v114
    v_lshl_add_u32 v112, v4, 4, v6
    v_mul_u32_u24 v6, 1024, v114
    v_lshl_add_u32 v6, v4, 4, v6
    v_add_u32 v113, s59, v6
    ds_read_b128 v[56:59], v112 offset:0
    s_mov_b32 s58, 0
    s_waitcnt lgkmcnt(0)
    buffer_store_dwordx4 v[56:59], v113, s[44:47], s58 offen
    s_endpgm
k4_loader:
    v_and_b32 v1, 63, v0
    s_mul_i32 s99, s25, 16
    s_mul_i32 s54, s25, 2048
    s_add_u32 s99, s99, s26
    v_lshrrev_b32 v4, 3, v1
    v_lshrrev_b32 v5, 4, v1
    v_and_b32 v6, 7, v1
    v_xor_b32 v5, v5, v6
    v_add_u32 v4, s99, v4
    v_lshlrev_b32 v4, 11, v4
    v_lshl_add_u32 v14, v5, 4, v4
    v_xor_b32 v5, 4, v5
    v_lshl_add_u32 v6, v5, 4, v4
    v_add_u32 v15, 15360, v6
    s_mul_i32 s52, s25, 2048
    s_mul_i32 s99, s25, 16384
    s_add_u32 s99, s99, s27
    v_lshrrev_b32 v5, 3, v1
    v_and_b32 v4, 7, v1
    v_bfe_u32 v6, v5, 1, 1
    v_lshlrev_b32 v6, 2, v6
    v_xor_b32 v4, v4, v6
    v_mul_u32_u24 v5, 1024, v5
    v_lshl_add_u32 v12, v4, 4, v5
    v_add_u32 v12, s99, v12
    v_add_u32 v13, 7168, v12
    s_mov_b32 s56, s24
    s_lshl_b32 s55, s56, 7
    s_lshl_b32 s53, s56, 16
    s_waitcnt lgkmcnt(0)
    s_add_u32 s8, s30, 22020096
    s_addc_u32 s9, s31, 0
    s_mov_b32 s10, 4096000
    s_mov_b32 s11, 0x20000
    s_mov_b32 s12, s40
    s_mov_b32 s13, s41
    s_mov_b32 s14, 1048576
    s_mov_b32 s15, 0x20000
    s_mov_b32 s44, s42
    s_mov_b32 s45, s43
    s_mov_b32 s46, 2048000
    s_mov_b32 s47, 0x20000
    s_add_u32 m0, s54, 8192
    s_nop 0
    buffer_load_dwordx4 v14, s[8:11], s55 offen offset:0  lds
    buffer_load_dwordx4 v15, s[8:11], s55 offen offset:1024  lds
    s_add_u32 m0, s52, 0
    s_nop 0
    buffer_load_dwordx4 v12, s[12:15], s53 offen offset:0  lds
    buffer_load_dwordx4 v13, s[12:15], s53 offen offset:1024  lds
    s_add_u32 s56, s56, 1
    s_and_b32 s56, s56, 15
    s_lshl_b32 s55, s56, 7
    s_lshl_b32 s53, s56, 16
    s_add_u32 m0, s54, 24576
    s_nop 0
    buffer_load_dwordx4 v14, s[8:11], s55 offen offset:0  lds
    buffer_load_dwordx4 v15, s[8:11], s55 offen offset:1024  lds
    s_add_u32 m0, s52, 16384
    s_nop 0
    buffer_load_dwordx4 v12, s[12:15], s53 offen offset:0  lds
    buffer_load_dwordx4 v13, s[12:15], s53 offen offset:1024  lds
    s_add_u32 s56, s56, 1
    s_and_b32 s56, s56, 15
    s_lshl_b32 s55, s56, 7
    s_lshl_b32 s53, s56, 16
    s_add_u32 m0, s54, 40960
    s_nop 0
    buffer_load_dwordx4 v14, s[8:11], s55 offen offset:0  lds
    buffer_load_dwordx4 v15, s[8:11], s55 offen offset:1024  lds
    s_add_u32 m0, s52, 32768
    s_nop 0
    buffer_load_dwordx4 v12, s[12:15], s53 offen offset:0  lds
    buffer_load_dwordx4 v13, s[12:15], s53 offen offset:1024  lds
    s_add_u32 s56, s56, 1
    s_and_b32 s56, s56, 15
    s_lshl_b32 s55, s56, 7
    s_lshl_b32 s53, s56, 16
    s_waitcnt vmcnt(8)
    s_barrier
    s_add_u32 m0, s54, 57344
    s_nop 0
    buffer_load_dwordx4 v14, s[8:11], s55 offen offset:0  lds
    buffer_load_dwordx4 v15, s[8:11], s55 offen offset:1024  lds
    s_add_u32 m0, s52, 49152
    s_nop 0
    buffer_load_dwordx4 v12, s[12:15], s53 offen offset:0  lds
    buffer_load_dwordx4 v13, s[12:15], s53 offen offset:1024  lds
    s_add_u32 s56, s56, 1
    s_and_b32 s56, s56, 15
    s_lshl_b32 s55, s56, 7
    s_lshl_b32 s53, s56, 16
    s_cmp_lt_u32 s33, 16
    s_cbranch_scc0 .Lpf7_skip
    s_cmp_eq_u32 s25, 0
    s_cbranch_scc0 .Lpf7_skip
    s_getpc_b64 s[96:97]
.Lpf7_pc:
    s_add_u32 s96, s96, (k4_kernel - .Lpf7_pc) & 0xffffffff
    s_addc_u32 s97, s97, ((k4_kernel - .Lpf7_pc) >> 32) & 0xffffffff
    v_and_b32 v254, 63, v0
    s_lshl_b32 s98, s33, 6
    v_add_u32 v254, s98, v254
    v_lshlrev_b32 v254, 7, v254
    v_min_u32 v254, (k4_exit - k4_kernel - 4), v254
    global_load_dword v255, v254, s[96:97]
.Lpf7_skip:
    s_waitcnt vmcnt(8)
    s_barrier
    s_add_u32 m0, s54, 73728
    s_nop 0
    buffer_load_dwordx4 v14, s[8:11], s55 offen offset:0  lds
    buffer_load_dwordx4 v15, s[8:11], s55 offen offset:1024  lds
    s_add_u32 m0, s52, 65536
    s_nop 0
    buffer_load_dwordx4 v12, s[12:15], s53 offen offset:0  lds
    buffer_load_dwordx4 v13, s[12:15], s53 offen offset:1024  lds
    s_add_u32 s56, s56, 1
    s_and_b32 s56, s56, 15
    s_lshl_b32 s55, s56, 7
    s_lshl_b32 s53, s56, 16
    s_lshl_b32 s57, s26, 10
    s_waitcnt vmcnt(8)
    s_barrier
    s_add_u32 m0, s54, 8192
    s_nop 0
    buffer_load_dwordx4 v14, s[8:11], s55 offen offset:0  lds
    buffer_load_dwordx4 v15, s[8:11], s55 offen offset:1024  lds
    s_add_u32 m0, s52, 0
    s_nop 0
    buffer_load_dwordx4 v12, s[12:15], s53 offen offset:0  lds
    buffer_load_dwordx4 v13, s[12:15], s53 offen offset:1024  lds
    s_add_u32 s56, s56, 1
    s_and_b32 s56, s56, 15
    s_lshl_b32 s55, s56, 7
    s_lshl_b32 s53, s56, 16
    s_waitcnt vmcnt(8)
    s_barrier
    s_add_u32 m0, s54, 24576
    s_nop 0
    buffer_load_dwordx4 v14, s[8:11], s55 offen offset:0  lds
    buffer_load_dwordx4 v15, s[8:11], s55 offen offset:1024  lds
    s_add_u32 m0, s52, 16384
    s_nop 0
    buffer_load_dwordx4 v12, s[12:15], s53 offen offset:0  lds
    buffer_load_dwordx4 v13, s[12:15], s53 offen offset:1024  lds
    s_add_u32 s56, s56, 1
    s_and_b32 s56, s56, 15
    s_lshl_b32 s55, s56, 7
    s_lshl_b32 s53, s56, 16
    s_waitcnt vmcnt(8)
    s_barrier
    s_add_u32 m0, s54, 40960
    s_nop 0
    buffer_load_dwordx4 v14, s[8:11], s55 offen offset:0  lds
    buffer_load_dwordx4 v15, s[8:11], s55 offen offset:1024  lds
    s_add_u32 m0, s52, 32768
    s_nop 0
    buffer_load_dwordx4 v12, s[12:15], s53 offen offset:0  lds
    buffer_load_dwordx4 v13, s[12:15], s53 offen offset:1024  lds
    s_add_u32 s56, s56, 1
    s_and_b32 s56, s56, 15
    s_lshl_b32 s55, s56, 7
    s_lshl_b32 s53, s56, 16
    s_waitcnt vmcnt(8)
    s_barrier
    s_add_u32 m0, s54, 57344
    s_nop 0
    buffer_load_dwordx4 v14, s[8:11], s55 offen offset:0  lds
    buffer_load_dwordx4 v15, s[8:11], s55 offen offset:1024  lds
    s_add_u32 m0, s52, 49152
    s_nop 0
    buffer_load_dwordx4 v12, s[12:15], s53 offen offset:0  lds
    buffer_load_dwordx4 v13, s[12:15], s53 offen offset:1024  lds
    s_add_u32 s56, s56, 1
    s_and_b32 s56, s56, 15
    s_lshl_b32 s55, s56, 7
    s_lshl_b32 s53, s56, 16
    s_waitcnt vmcnt(8)
    s_barrier
    s_add_u32 m0, s54, 73728
    s_nop 0
    buffer_load_dwordx4 v14, s[8:11], s55 offen offset:0  lds
    buffer_load_dwordx4 v15, s[8:11], s55 offen offset:1024  lds
    s_add_u32 m0, s52, 65536
    s_nop 0
    buffer_load_dwordx4 v12, s[12:15], s53 offen offset:0  lds
    buffer_load_dwordx4 v13, s[12:15], s53 offen offset:1024  lds
    s_add_u32 s56, s56, 1
    s_and_b32 s56, s56, 15
    s_lshl_b32 s55, s56, 7
    s_lshl_b32 s53, s56, 16
    s_waitcnt vmcnt(8)
    s_barrier
    s_add_u32 m0, s54, 8192
    s_nop 0
    buffer_load_dwordx4 v14, s[8:11], s55 offen offset:0  lds
    buffer_load_dwordx4 v15, s[8:11], s55 offen offset:1024  lds
    s_add_u32 m0, s52, 0
    s_nop 0
    buffer_load_dwordx4 v12, s[12:15], s53 offen offset:0  lds
    buffer_load_dwordx4 v13, s[12:15], s53 offen offset:1024  lds
    s_add_u32 s56, s56, 1
    s_and_b32 s56, s56, 15
    s_lshl_b32 s55, s56, 7
    s_lshl_b32 s53, s56, 16
    s_waitcnt vmcnt(8)
    s_barrier
    s_add_u32 m0, s54, 24576
    s_nop 0
    buffer_load_dwordx4 v14, s[8:11], s55 offen offset:0  lds
    buffer_load_dwordx4 v15, s[8:11], s55 offen offset:1024  lds
    s_add_u32 m0, s52, 16384
    s_nop 0
    buffer_load_dwordx4 v12, s[12:15], s53 offen offset:0  lds
    buffer_load_dwordx4 v13, s[12:15], s53 offen offset:1024  lds
    s_add_u32 s56, s56, 1
    s_and_b32 s56, s56, 15
    s_lshl_b32 s55, s56, 7
    s_lshl_b32 s53, s56, 16
    s_waitcnt vmcnt(8)
    s_barrier
    s_add_u32 m0, s54, 40960
    s_nop 0
    buffer_load_dwordx4 v14, s[8:11], s55 offen offset:0  lds
    buffer_load_dwordx4 v15, s[8:11], s55 offen offset:1024  lds
    s_add_u32 m0, s52, 32768
    s_nop 0
    buffer_load_dwordx4 v12, s[12:15], s53 offen offset:0  lds
    buffer_load_dwordx4 v13, s[12:15], s53 offen offset:1024  lds
    s_add_u32 s56, s56, 1
    s_and_b32 s56, s56, 15
    s_lshl_b32 s55, s56, 7
    s_lshl_b32 s53, s56, 16
    s_waitcnt vmcnt(8)
    s_barrier
    s_add_u32 m0, s54, 57344
    s_nop 0
    buffer_load_dwordx4 v14, s[8:11], s55 offen offset:0  lds
    buffer_load_dwordx4 v15, s[8:11], s55 offen offset:1024  lds
    s_add_u32 m0, s52, 49152
    s_nop 0
    buffer_load_dwordx4 v12, s[12:15], s53 offen offset:0  lds
    buffer_load_dwordx4 v13, s[12:15], s53 offen offset:1024  lds
    s_add_u32 s56, s56, 1
    s_and_b32 s56, s56, 15
    s_lshl_b32 s55, s56, 7
    s_lshl_b32 s53, s56, 16
    s_waitcnt vmcnt(8)
    s_barrier
    s_add_u32 m0, s54, 73728
    s_nop 0
    buffer_load_dwordx4 v14, s[8:11], s55 offen offset:0  lds
    buffer_load_dwordx4 v15, s[8:11], s55 offen offset:1024  lds
    s_add_u32 m0, s52, 65536
    s_nop 0
    buffer_load_dwordx4 v12, s[12:15], s53 offen offset:0  lds
    buffer_load_dwordx4 v13, s[12:15], s53 offen offset:1024  lds
    s_add_u32 s56, s56, 1
    s_and_b32 s56, s56, 15
    s_lshl_b32 s55, s56, 7
    s_lshl_b32 s53, s56, 16
    s_waitcnt vmcnt(8)
    s_barrier
    s_add_u32 m0, s54, 8192
    s_nop 0
    buffer_load_dwordx4 v14, s[8:11], s55 offen offset:0  lds
    buffer_load_dwordx4 v15, s[8:11], s55 offen offset:1024  lds
    s_add_u32 m0, s52, 0
    s_nop 0
    buffer_load_dwordx4 v12, s[12:15], s53 offen offset:0  lds
    buffer_load_dwordx4 v13, s[12:15], s53 offen offset:1024  lds
    s_add_u32 s56, s56, 1
    s_and_b32 s56, s56, 15
    s_lshl_b32 s55, s56, 7
    s_lshl_b32 s53, s56, 16
    s_waitcnt vmcnt(8)
    s_barrier
    s_waitcnt vmcnt(4)
    s_barrier
    s_waitcnt vmcnt(0)
    s_barrier
    s_barrier
    s_barrier
    s_lshl_b32 s59, s26, 10
    s_add_u32 s59, s59, s27
    v_lshrrev_b32 v5, 3, v1
    v_and_b32 v4, 7, v1
    s_mul_i32 s99, s20, 8
    v_add_u32 v50, s99, v5
    v_mul_u32_u24 v6, 144, v50
    v_lshl_add_u32 v48, v4, 4, v6
    v_mul_u32_u24 v6, 1024, v50
    v_lshl_add_u32 v6, v4, 4, v6
    v_add_u32 v49, s59, v6
    ds_read_b128 v[16:19], v48 offset:0
    s_mov_b32 s58, 0
    s_waitcnt lgkmcnt(0)
    buffer_store_dwordx4 v[16:19], v49, s[44:47], s58 offen
    s_endpgm
k4_exit:
    s_endpgm
.section .rodata,"a"
.p2align 6
.amdhsa_kernel k1_kernel
  .amdhsa_next_free_vgpr 256
  .amdhsa_next_free_sgpr 100
  .amdhsa_accum_offset 256
  .amdhsa_group_segment_fixed_size 0
  .amdhsa_kernarg_size 88
  .amdhsa_user_sgpr_count 2
  .amdhsa_user_sgpr_kernarg_segment_ptr 1
  .amdhsa_system_sgpr_workgroup_id_x 1
.end_amdhsa_kernel
.p2align 6
.amdhsa_kernel k2_kernel
  .amdhsa_next_free_vgpr 256
  .amdhsa_next_free_sgpr 100
  .amdhsa_accum_offset 256
  .amdhsa_group_segment_fixed_size 0
  .amdhsa_kernarg_size 88
  .amdhsa_user_sgpr_count 2
  .amdhsa_user_sgpr_kernarg_segment_ptr 1
  .amdhsa_system_sgpr_workgroup_id_x 1
.end_amdhsa_kernel
.p2align 6
.amdhsa_kernel k3_kernel
  .amdhsa_next_free_vgpr 256
  .amdhsa_next_free_sgpr 100
  .amdhsa_accum_offset 256
  .amdhsa_group_segment_fixed_size 0
  .amdhsa_kernarg_size 88
  .amdhsa_user_sgpr_count 2
  .amdhsa_user_sgpr_kernarg_segment_ptr 1
  .amdhsa_system_sgpr_workgroup_id_x 1
.end_amdhsa_kernel
.p2align 6
.amdhsa_kernel k4_kernel
  .amdhsa_next_free_vgpr 256
  .amdhsa_next_free_sgpr 100
  .amdhsa_accum_offset 256
  .amdhsa_group_segment_fixed_size 0
  .amdhsa_kernarg_size 88
  .amdhsa_user_sgpr_count 2
  .amdhsa_user_sgpr_kernarg_segment_ptr 1
  .amdhsa_system_sgpr_workgroup_id_x 1
.end_amdhsa_kernel
```
